```python
import torch

def _softmax(x, axis=-1):
    return torch.softmax(x, dim=axis)

def _gelu(x):
    return torch.nn.functional.gelu(x, approximate='tanh')

def _silu(x):
    return torch.nn.functional.silu(x)

def _sigmoid(x):
    return torch.sigmoid(x)

def _layernorm(x, axis=-1, eps=1e-05):
    m = x.mean(dim=axis, keepdim=True)
    v = x.var(dim=axis, keepdim=True, unbiased=False)
    return (x - m) / torch.sqrt(v + eps)

def _scatter_add(tgt, idx, src, axis=0):
    return tgt.clone().index_add_(axis, idx, src)

def _segment_sum(src, seg, n):
    out = torch.zeros((n,) + src.shape[1:], dtype=src.dtype)
    return out.index_add_(0, seg, src)

def _pad(x, pw):
    flat = tuple((v for pair in reversed(pw) for v in pair))
    return torch.nn.functional.pad(x, flat)
kernel_name = 'gated_mix__linear_kernel_hedgehog__mixer_gmlp__prompt'

def setup_inputs():

    _w = lambda a: (lambda t: t.to(torch.bfloat16) if t.is_floating_point() else t)(torch.as_tensor(a))

    def _A_setup():
        B, S, D, H = (1, 2048, 448, 16)
        Dh = D // H
        return {'x': _w((lambda *s: torch.randn(*s, dtype=torch.bfloat16) * 0.05)(B, S, D)), 'wqkv': _w((lambda *s: torch.randn(*s, dtype=torch.bfloat16) * 1.6)(D, 3 * D)), 'w_phi': _w((lambda *s: torch.randn(*s, dtype=torch.bfloat16) * 1.6)(H, Dh, Dh) * Dh ** (-0.5)), 'wo': _w((lambda *s: torch.randn(*s, dtype=torch.bfloat16) * 0.1)(D, D))}
    _A_in = _A_setup()

    def _B_setup():
        B, S, D, F = (1, 2048, 448, 1792)
        Fh = F // 2
        return {'x': _w((lambda *s: torch.randn(*s, dtype=torch.bfloat16) * 0.05)(B, S, D)), 'w_in': _w((lambda *s: torch.randn(*s, dtype=torch.bfloat16) * 0.4)(D, 2 * Fh)), 'w_sp': _w(0.01 * (lambda *s: torch.randn(*s, dtype=torch.bfloat16) * 0.4)(S, S)), 'b_sp': _w(1.0 + 0.01 * (lambda *s: torch.randn(*s, dtype=torch.bfloat16) * 0.05)(S)), 'w_out': _w((lambda *s: torch.randn(*s, dtype=torch.bfloat16) * 0.05)(Fh, D))}
    _B_in = _B_setup()
    return {'A_x': _A_in['x'], 'A_wqkv': _A_in['wqkv'], 'A_w_phi': _A_in['w_phi'], 'A_wo': _A_in['wo'], 'B_x': _B_in['x'], 'B_w_in': _B_in['w_in'], 'B_w_sp': _B_in['w_sp'], 'B_b_sp': _B_in['b_sp'], 'B_w_out': _B_in['w_out'], 'gate_w': _w((lambda *s: torch.randn(*s, dtype=torch.bfloat16) * 0.05)(448) * 16.0)}

def reference(A_x, A_wqkv, A_w_phi, A_wo, B_x, B_w_in, B_w_sp, B_b_sp, B_w_out, gate_w):

    def _A_ref(x, wqkv, w_phi, wo):
        B, S, D = x.shape
        H = 16
        Dh = D // H
        qkv = (lambda x, *d: x.permute(*d))((x @ wqkv).reshape(B, S, 3, H, Dh), 2, 0, 3, 1, 4)
        q, k, v = (qkv[0], qkv[1], qkv[2])
        pq = torch.einsum('bhsd,hdf->bhsf', q, w_phi)
        pk = torch.einsum('bhsd,hdf->bhsf', k, w_phi)
        phi_q = torch.concatenate([_softmax(pq, axis=-1), _softmax(-pq, axis=-1)], axis=-1)
        phi_k = torch.concatenate([_softmax(pk, axis=-1), _softmax(-pk, axis=-1)], axis=-1)
        kv = torch.einsum('bhsf,bhsd->bhfd', phi_k, v)
        z = torch.einsum('bhsf->bhf', phi_k)
        num = torch.einsum('bhqf,bhfd->bhqd', phi_q, kv)
        den = torch.einsum('bhqf,bhf->bhq', phi_q, z)[..., None] + 1e-06
        o = num / den
        return (lambda x, *d: x.permute(*d))(o, 0, 2, 1, 3).reshape(B, S, D) @ wo

    def _B_ref(x, w_in, w_sp, b_sp, w_out):
        B, S, D = x.shape
        F = w_in.shape[-1]
        Fh = F // 2
        z = _gelu(torch.einsum('bsd,df->bsf', x, w_in))
        z1 = z[..., :Fh].clone()
        z2 = _layernorm(z[..., Fh:], axis=-1)
        g = torch.einsum('ts,bsf->btf', w_sp, z2) + b_sp[None, :, None]
        return torch.einsum('bsf,fd->bsd', z1 * g, w_out)
    x = A_x
    g = _sigmoid((x * gate_w).sum(-1, keepdims=True))
    a = _A_ref(x, A_wqkv, A_w_phi, A_wo)
    b = _B_ref(x, B_w_in, B_w_sp, B_b_sp, B_w_out)
    return g * a + (1 - g) * b
```

```asm
; @launch grid=(256,1,1) block=(256,1,1) lds=163840
.amdgcn_target "amdgcn-amd-amdhsa--gfx950"
.text
.globl gated_mix__linear_kernel_hedgehog__mixer_gmlp__prompt_kernel
.p2align 8
.type gated_mix__linear_kernel_hedgehog__mixer_gmlp__prompt_kernel,@function
gated_mix__linear_kernel_hedgehog__mixer_gmlp__prompt_kernel:
    s_cmp_ge_u32 s2, 256
    s_cbranch_scc1 Lend
    s_load_dwordx16 s[80:95], s[0:1], 0
    s_load_dwordx4 s[72:75], s[0:1], 64
    s_load_dwordx2 s[76:77], s[0:1], 80
    s_load_dwordx2 s[16:17], s[0:1], 96
    s_getpc_b64 s[46:47]
Lpc:
    s_lshr_b32 s45, s2, 3
    v_lshrrev_b32 v1, 4, v0
    s_lshl_b32 s48, s45, 11
    v_lshl_add_u32 v1, v1, 7, s48
    v_min_u32 v1, Lcode_end-Lpc-4, v1
    global_load_dword v79, v1, s[46:47]
    v_lshrrev_b32 v3, 6, v0
    v_and_b32 v0, 63, v0
    v_readfirstlane_b32 s36, v3
    s_and_b32 s38, s2, 1
    s_and_b32 s39, s45, 7
    s_lshr_b32 s37, s45, 3
    s_lshl_b32 s48, s37, 1
    s_add_u32 s48, s48, s39
    s_and_b32 s45, s2, 6
    s_lshl_b32 s45, s45, 1
    s_add_u32 s37, s37, s45
    s_bfe_u32 s45, s2, 0x10001
    s_add_u32 s48, s48, s45
    s_lshl_b32 s40, s38, 3
    s_add_u32 s40, s40, s39
    s_sub_u32 s41, s40, s38
    s_lshl_b32 s44, s37, 2
    s_add_u32 s44, s44, s36
    s_lshl_b32 s51, s36, 14
    s_and_b32 s48, s2, 6
    s_add_u32 s48, s48, s39
    s_sub_u32 s45, s48, 7
    s_cselect_b32 s48, s48, s45
    s_sub_u32 s45, s48, 7
    s_cselect_b32 s48, s48, s45
    s_mov_b32 s45, s48
    s_lshl_b32 s56, s45, 7
    s_add_u32 s57, s56, 128
    s_cmp_eq_u32 s57, 896
    s_cselect_b32 s57, 0, s57
    s_add_u32 s58, s57, 128
    s_cmp_eq_u32 s58, 896
    s_cselect_b32 s58, 0, s58
    s_add_u32 s59, s58, 128
    s_cmp_eq_u32 s59, 896
    s_cselect_b32 s59, 0, s59
    s_add_u32 s60, s59, 128
    s_cmp_eq_u32 s60, 896
    s_cselect_b32 s60, 0, s60
    s_add_u32 s61, s60, 128
    s_cmp_eq_u32 s61, 896
    s_cselect_b32 s61, 0, s61
    s_add_u32 s62, s61, 128
    s_cmp_eq_u32 s62, 896
    s_cselect_b32 s62, 0, s62
    s_mov_b32 s6, 1835008
    s_mov_b32 s7, 0x20000
    s_mov_b32 s10, 1605632
    s_mov_b32 s11, 0x20000
    s_mov_b32 s18, 22020096
    s_mov_b32 s19, 0x20000
    v_lshrrev_b32 v1, 3, v0
    v_and_b32 v2, 7, v0
    v_lshrrev_b32 v3, 4, v0
    v_lshlrev_b32 v4, 4, v0
    s_lshl_b32 s45, s44, 5
    v_add_u32 v60, s45, v1
    v_mul_u32_u24 v60, 896, v60
    v_xor_b32 v8, v2, v3
    v_lshl_add_u32 v8, v8, 4, v60
    v_xor_b32 v60, 64, v8
    v_add_u32 v9, 6144, v60
    v_add_u32 v10, 12288, v8
    v_add_u32 v11, 18432, v60
    s_cmp_eq_u32 s39, 7
    s_cbranch_scc1 LpathB
    s_lshl_b32 s45, s36, 4
    v_add_u32 v60, s45, v1
    v_mul_u32_u24 v60, 3584, v60
    v_and_b32 v7, 1, v3
    s_and_b32 s45, s36, 1
    s_lshl_b32 s45, s45, 2
    v_lshl_add_u32 v7, v7, 1, s45
    v_xor_b32 v7, v7, v2
    s_lshl_b32 s45, s41, 7
    v_lshl_add_u32 v7, v7, 4, v60
    v_add_u32 v7, s45, v7
    v_add_u32 v16, 27648, v7
    v_add_u32 v17, 1792, v7
    v_add_u32 v18, 29440, v7
    s_lshl_b32 s50, s36, 11
    s_add_u32 s50, s50, 65536
    s_mul_i32 s45, s37, 56
    s_lshl_b32 s46, s41, 2
    s_add_u32 s45, s45, s46
    s_add_u32 s45, s45, s36
    s_mul_i32 s46, s45, 1792
    s_waitcnt lgkmcnt(0)
    s_mov_b64 s[4:5], s[80:81]
    s_mov_b64 s[8:9], s[90:91]
    buffer_load_dwordx4 v[64:67], v4, s[8:11], s46 offen offset:0
    buffer_load_dwordx4 v[68:71], v4, s[8:11], s46 offen offset:768
    s_add_u32 m0, s51, 0
    s_nop 0
    buffer_load_dwordx4 v8, s[4:7], s56 offen lds
    s_nop 0
    s_buffer_load_dword s52, s[16:19], 0
    s_mov_b32 s34, 8388608
    s_mov_b32 s35, 0x20000
    s_mov_b32 s14, 4096
    s_mov_b32 s15, 0x20000
    s_mov_b64 s[32:33], s[92:93]
    s_mov_b64 s[12:13], s[94:95]
    s_mov_b32 s23, 0x20000
    s_mov_b32 s27, 0x20000
    s_mov_b32 s31, 0x20000
    s_mov_b64 s[20:21], s[86:87]
    s_mov_b32 s22, 401408
    buffer_load_dwordx4 v9, s[4:7], s56 offen offset:1024 lds
    s_mov_b64 s[24:25], s[72:73]
    s_mov_b32 s26, 802816
    s_mov_b64 s[28:29], s[76:77]
    s_mov_b32 s30, 1835008
    s_mov_b32 s42, s39
    s_mov_b32 s43, 400000
    s_lshl_b32 s79, s36, 13
    s_add_u32 s79, s79, 131072
    s_mov_b32 s64, 0xc0135761
    s_mov_b32 s65, 0xbdd2d3e8
    s_mov_b32 s66, 0x3fb8aa3b
    s_mov_b32 s67, 0xbfb8aa3b
    s_mov_b32 s68, 0
    buffer_load_dwordx4 v10, s[4:7], s56 offen offset:2048 lds
    s_mov_b32 s69, -1
    s_mul_i32 s46, s40, 98304
    s_mul_i32 s45, s36, 3072
    s_add_u32 s46, s46, s45
    s_add_u32 s46, s46, 1048576
    v_add_u32 v19, s46, v4
    s_mul_i32 s76, s36, 3072
    s_lshl_b32 s75, s36, 11
    s_lshl_b32 s81, s36, 12
    s_lshl_b32 s85, s42, 8
    s_sub_u32 s85, s85, 128
    s_mul_i32 s80, s42, 229376
    s_sub_u32 s80, s80, 229376
    s_xor_b32 s74, s38, 1
    buffer_load_dwordx4 v11, s[4:7], s56 offen offset:3072 lds
    s_mul_i32 s74, s74, 7
    s_add_u32 s74, s74, s39
    s_lshl_b32 s82, s44, 13
    s_add_u32 s82, s82, 65536
    s_add_u32 s83, s82, 4096
    s_mul_i32 s86, s37, 401408
    s_mul_i32 s45, s41, 28672
    s_add_u32 s86, s86, s45
    s_mul_i32 s45, s36, 7168
    s_add_u32 s86, s86, s45
    s_add_u32 s86, s86, 4849664
    s_add_u32 s87, s86, 4096
    s_mul_i32 s72, s44, 57344
    s_lshl_b32 s45, s41, 11
    s_add_u32 s72, s72, s45
    s_mul_i32 s49, s56, 1792
    s_add_u32 m0, s50, 0
    s_nop 0
    buffer_load_dwordx4 v17, s[8:11], s49 offen lds
    s_add_u32 s72, s72, 17301504
    s_add_u32 s73, s72, 28672
    s_lshr_b32 s46, s37, 3
    s_and_b32 s47, s37, 7
    s_lshl_b32 s90, s46, 12
    s_lshl_b32 s45, s36, 10
    s_add_u32 s90, s90, s45
    s_lshl_b32 s45, s39, 7
    s_add_u32 s90, s90, s45
    s_lshl_b32 s45, s47, 3
    s_add_u32 s90, s90, s45
    s_lshl_b32 s45, s38, 2
    s_add_u32 s90, s90, s45
    buffer_load_dwordx4 v18, s[8:11], s49 offen offset:1024 lds
    s_add_u32 s90, s90, 8192
    s_lshl_b32 s92, s44, 8
    s_lshl_b32 s45, s41, 2
    s_add_u32 s92, s92, s45
    s_add_u32 s92, s92, 32896
    s_mul_i32 s84, s37, 401408
    s_mul_i32 s45, s74, 28672
    s_add_u32 s84, s84, s45
    s_mul_i32 s45, s36, 7168
    s_add_u32 s84, s84, s45
    s_add_u32 s84, s84, 4849664
    s_lshl_b32 s91, s44, 8
    s_lshl_b32 s45, s40, 2
    s_add_u32 s91, s91, s45
    s_add_u32 s91, s91, 32768
    s_lshl_b32 s77, s40, 11
    s_add_u32 s77, s77, 589824
    s_mov_b32 s42, s2
    v_and_b32 v60, 15, v0
    v_lshl_add_u32 v60, v60, 7, s51
    v_bfe_u32 v61, v0, 1, 3
    v_bfrev_b32 v62, v3
    v_lshrrev_b32 v62, 30, v62
    v_xor_b32 v61, v61, v62
    v_lshl_add_u32 v12, v61, 4, v60
    v_xor_b32 v13, 64, v12
    v_bfe_u32 v60, v0, 2, 2
    v_lshl_add_u32 v60, v62, 3, v60
    v_lshlrev_b32 v60, 7, v60
    v_and_b32 v33, 15, v0
    s_lshl_b32 s54, s44, 6
    v_lshl_add_u32 v33, v33, 1, s54
    buffer_load_ushort v32, v33, s[12:15], 0 offen
    buffer_load_ushort v33, v33, s[12:15], 0 offen offset:32
    v_bfe_u32 v61, v0, 3, 2
    v_lshl_add_u32 v60, v61, 5, v60
    v_and_b32 v61, 3, v0
    v_lshl_add_u32 v60, v61, 3, v60
    v_add_u32 v20, 65536, v60
    v_xor_b32 v21, 32, v20
    v_xor_b32 v14, 64, v20
    v_xor_b32 v15, 96, v20
    v_add_u32 v22, 65536, v4
    s_lshl_b32 s45, s44, 17
    s_lshl_b32 s46, s38, 11
    s_add_u32 s45, s45, s46
    v_lshl_add_u32 v60, v1, 12, s45
    v_xor_b32 v61, v2, v3
    v_lshl_add_u32 v60, v61, 4, v60
    v_xor_b32 v61, 64, v60
    v_mov_b32 v23, v60
    v_add_u32 v24, 31744, v61
    v_add_u32 v25, 63488, v60
    v_add_u32 v26, 95232, v61
    v_and_b32 v60, 15, v0
    v_bfe_u32 v61, v0, 1, 3
    v_xor_b32 v61, v61, v3
    v_lshl_add_u32 v60, v60, 7, s51
    v_lshl_add_u32 v27, v61, 4, v60
    v_xor_b32 v28, 64, v27
    v_and_b32 v60, 31, v0
    v_mul_u32_u24 v60, 144, v60
    v_lshrrev_b32 v29, 5, v0
    v_lshl_add_u32 v29, v29, 5, v60
    v_add_u32 v29, s79, v29
    s_waitcnt lgkmcnt(0)
    s_mul_i32 s52, s52, 1664525
    s_add_u32 s52, s52, 1013904223
    s_mov_b32 s53, s52
    v_mov_b32 v5, s52
    s_add_u32 m0, s51, 4096
    s_nop 0
    buffer_load_dwordx4 v8, s[4:7], s57 offen lds
    buffer_load_dwordx4 v9, s[4:7], s57 offen offset:1024 lds
    buffer_load_dwordx4 v10, s[4:7], s57 offen offset:2048 lds
    buffer_load_dwordx4 v11, s[4:7], s57 offen offset:3072 lds
    s_mul_i32 s49, s57, 1792
    s_add_u32 m0, s50, 8192
    s_nop 0
    buffer_load_dwordx4 v17, s[8:11], s49 offen lds
    buffer_load_dwordx4 v18, s[8:11], s49 offen offset:1024 lds
    s_add_u32 m0, s51, 8192
    s_nop 0
    buffer_load_dwordx4 v8, s[4:7], s58 offen lds
    buffer_load_dwordx4 v9, s[4:7], s58 offen offset:1024 lds
    s_waitcnt vmcnt(10)
    buffer_load_dwordx4 v10, s[4:7], s58 offen offset:2048 lds
    s_barrier
    ds_read_b128 v[144:147], v12 offset:0
    ds_read_b128 v[148:151], v12 offset:2048
    ds_read_b64_tr_b16 v[36:37], v20 offset:0
    ds_read_b64_tr_b16 v[38:39], v20 offset:512
    ds_read_b64_tr_b16 v[40:41], v21 offset:0
    ds_read_b64_tr_b16 v[42:43], v21 offset:512
    ds_read_b64_tr_b16 v[44:45], v14 offset:0
    ds_read_b64_tr_b16 v[46:47], v14 offset:512
    ds_read_b64_tr_b16 v[48:49], v15 offset:0
    ds_read_b64_tr_b16 v[50:51], v15 offset:512
    s_waitcnt lgkmcnt(6)
    v_mfma_f32_16x16x32_bf16 v[112:115], v[36:39], v[144:147], 0
    buffer_load_dwordx4 v11, s[4:7], s58 offen offset:3072 lds
    s_mul_i32 s49, s58, 1792
    s_add_u32 m0, s50, 16384
    v_mfma_f32_16x16x32_bf16 v[120:123], v[36:39], v[148:151], 0
    s_waitcnt lgkmcnt(4)
    ds_read_b128 v[152:155], v13 offset:0
    ds_read_b128 v[156:159], v13 offset:2048
    ds_read_b64_tr_b16 v[36:37], v20 offset:4096
    v_mfma_f32_16x16x32_bf16 v[116:119], v[40:43], v[144:147], 0
    ds_read_b64_tr_b16 v[38:39], v20 offset:4608
    v_mfma_f32_16x16x32_bf16 v[124:127], v[40:43], v[148:151], 0
    s_waitcnt lgkmcnt(6)
    ds_read_b64_tr_b16 v[40:41], v21 offset:4096
    buffer_load_dwordx4 v17, s[8:11], s49 offen lds
    v_mfma_f32_16x16x32_bf16 v[128:131], v[44:47], v[144:147], 0
    ds_read_b64_tr_b16 v[42:43], v21 offset:4608
    v_mfma_f32_16x16x32_bf16 v[136:139], v[44:47], v[148:151], 0
    s_waitcnt lgkmcnt(6)
    ds_read_b64_tr_b16 v[44:45], v14 offset:4096
    v_mfma_f32_16x16x32_bf16 v[132:135], v[48:51], v[144:147], 0
    ds_read_b64_tr_b16 v[46:47], v14 offset:4608
    v_mfma_f32_16x16x32_bf16 v[140:143], v[48:51], v[148:151], 0
    s_waitcnt lgkmcnt(4)
    ds_read_b64_tr_b16 v[48:49], v15 offset:4096
    buffer_load_dwordx4 v18, s[8:11], s49 offen offset:1024 lds
    s_add_u32 m0, s51, 12288
    v_mfma_f32_16x16x32_bf16 v[112:115], v[36:39], v[152:155], v[112:115]
    ds_read_b64_tr_b16 v[50:51], v15 offset:4608
    v_mfma_f32_16x16x32_bf16 v[120:123], v[36:39], v[156:159], v[120:123]
    s_waitcnt lgkmcnt(4)
    buffer_load_dwordx4 v8, s[4:7], s59 offen lds
    buffer_load_dwordx4 v9, s[4:7], s59 offen offset:1024 lds
    buffer_load_dwordx4 v10, s[4:7], s59 offen offset:2048 lds
    s_waitcnt vmcnt(9)
    buffer_load_dwordx4 v11, s[4:7], s59 offen offset:3072 lds
    s_barrier
    ds_read_b128 v[160:163], v12 offset:4096
    ds_read_b128 v[164:167], v12 offset:6144
    ds_read_b64_tr_b16 v[36:37], v20 offset:8192
    v_mfma_f32_16x16x32_bf16 v[116:119], v[40:43], v[152:155], v[116:119]
    s_mul_i32 s49, s59, 1792
    ds_read_b64_tr_b16 v[38:39], v20 offset:8704
    s_add_u32 m0, s50, 24576
    s_nop 0
    buffer_load_dwordx4 v17, s[8:11], s49 offen lds
    v_mfma_f32_16x16x32_bf16 v[124:127], v[40:43], v[156:159], v[124:127]
    s_waitcnt lgkmcnt(6)
    ds_read_b64_tr_b16 v[40:41], v21 offset:8192
    v_mfma_f32_16x16x32_bf16 v[128:131], v[44:47], v[152:155], v[128:131]
    ds_read_b64_tr_b16 v[42:43], v21 offset:8704
    v_mfma_f32_16x16x32_bf16 v[136:139], v[44:47], v[156:159], v[136:139]
    s_waitcnt lgkmcnt(6)
    ds_read_b64_tr_b16 v[44:45], v14 offset:8192
    v_mfma_f32_16x16x32_bf16 v[132:135], v[48:51], v[152:155], v[132:135]
    ds_read_b64_tr_b16 v[46:47], v14 offset:8704
    v_mfma_f32_16x16x32_bf16 v[140:143], v[48:51], v[156:159], v[140:143]
    s_waitcnt lgkmcnt(4)
    ds_read_b64_tr_b16 v[48:49], v15 offset:8192
    v_mfma_f32_16x16x32_bf16 v[112:115], v[36:39], v[160:163], v[112:115]
    ds_read_b64_tr_b16 v[50:51], v15 offset:8704
    buffer_load_dwordx4 v18, s[8:11], s49 offen offset:1024 lds
    s_add_u32 m0, s51, 0
    v_mfma_f32_16x16x32_bf16 v[120:123], v[36:39], v[164:167], v[120:123]
    s_waitcnt lgkmcnt(4)
    ds_read_b128 v[168:171], v13 offset:4096
    ds_read_b128 v[172:175], v13 offset:6144
    ds_read_b64_tr_b16 v[36:37], v20 offset:12288
    v_mfma_f32_16x16x32_bf16 v[116:119], v[40:43], v[160:163], v[116:119]
    ds_read_b64_tr_b16 v[38:39], v20 offset:12800
    v_mfma_f32_16x16x32_bf16 v[124:127], v[40:43], v[164:167], v[124:127]
    s_waitcnt lgkmcnt(6)
    ds_read_b64_tr_b16 v[40:41], v21 offset:12288
    v_mfma_f32_16x16x32_bf16 v[128:131], v[44:47], v[160:163], v[128:131]
    ds_read_b64_tr_b16 v[42:43], v21 offset:12800
    buffer_load_dwordx4 v8, s[4:7], s60 offen lds
    v_mfma_f32_16x16x32_bf16 v[136:139], v[44:47], v[164:167], v[136:139]
    s_waitcnt lgkmcnt(6)
    ds_read_b64_tr_b16 v[44:45], v14 offset:12288
    v_mfma_f32_16x16x32_bf16 v[132:135], v[48:51], v[160:163], v[132:135]
    ds_read_b64_tr_b16 v[46:47], v14 offset:12800
    v_mfma_f32_16x16x32_bf16 v[140:143], v[48:51], v[164:167], v[140:143]
    s_waitcnt lgkmcnt(4)
    ds_read_b64_tr_b16 v[48:49], v15 offset:12288
    v_mfma_f32_16x16x32_bf16 v[112:115], v[36:39], v[168:171], v[112:115]
    ds_read_b64_tr_b16 v[50:51], v15 offset:12800
    buffer_load_dwordx4 v9, s[4:7], s60 offen offset:1024 lds
    v_mfma_f32_16x16x32_bf16 v[120:123], v[36:39], v[172:175], v[120:123]
    s_waitcnt lgkmcnt(4)
    buffer_load_dwordx4 v10, s[4:7], s60 offen offset:2048 lds
    s_waitcnt vmcnt(9)
    buffer_load_dwordx4 v11, s[4:7], s60 offen offset:3072 lds
    s_barrier
    ds_read_b128 v[176:179], v12 offset:8192
    ds_read_b128 v[180:183], v12 offset:10240
    ds_read_b64_tr_b16 v[36:37], v20 offset:16384
    v_mfma_f32_16x16x32_bf16 v[116:119], v[40:43], v[168:171], v[116:119]
    s_mul_i32 s49, s60, 1792
    ds_read_b64_tr_b16 v[38:39], v20 offset:16896
    s_add_u32 m0, s50, 32768
    s_nop 0
    buffer_load_dwordx4 v17, s[8:11], s49 offen lds
    v_mfma_f32_16x16x32_bf16 v[124:127], v[40:43], v[172:175], v[124:127]
    s_waitcnt lgkmcnt(6)
    ds_read_b64_tr_b16 v[40:41], v21 offset:16384
    v_mfma_f32_16x16x32_bf16 v[128:131], v[44:47], v[168:171], v[128:131]
    ds_read_b64_tr_b16 v[42:43], v21 offset:16896
    v_mfma_f32_16x16x32_bf16 v[136:139], v[44:47], v[172:175], v[136:139]
    s_waitcnt lgkmcnt(6)
    ds_read_b64_tr_b16 v[44:45], v14 offset:16384
    v_mfma_f32_16x16x32_bf16 v[132:135], v[48:51], v[168:171], v[132:135]
    ds_read_b64_tr_b16 v[46:47], v14 offset:16896
    buffer_load_dwordx4 v18, s[8:11], s49 offen offset:1024 lds
    s_add_u32 m0, s51, 4096
    v_mfma_f32_16x16x32_bf16 v[140:143], v[48:51], v[172:175], v[140:143]
    s_waitcnt lgkmcnt(4)
    ds_read_b64_tr_b16 v[48:49], v15 offset:16384
    v_mfma_f32_16x16x32_bf16 v[112:115], v[36:39], v[176:179], v[112:115]
    ds_read_b64_tr_b16 v[50:51], v15 offset:16896
    v_mfma_f32_16x16x32_bf16 v[120:123], v[36:39], v[180:183], v[120:123]
    s_waitcnt lgkmcnt(4)
    ds_read_b128 v[184:187], v13 offset:8192
    ds_read_b128 v[188:191], v13 offset:10240
    ds_read_b64_tr_b16 v[36:37], v20 offset:20480
    buffer_load_dwordx4 v8, s[4:7], s61 offen lds
    v_mfma_f32_16x16x32_bf16 v[116:119], v[40:43], v[176:179], v[116:119]
    ds_read_b64_tr_b16 v[38:39], v20 offset:20992
    v_mfma_f32_16x16x32_bf16 v[124:127], v[40:43], v[180:183], v[124:127]
    s_waitcnt lgkmcnt(6)
    ds_read_b64_tr_b16 v[40:41], v21 offset:20480
    v_mfma_f32_16x16x32_bf16 v[128:131], v[44:47], v[176:179], v[128:131]
    ds_read_b64_tr_b16 v[42:43], v21 offset:20992
    v_mfma_f32_16x16x32_bf16 v[136:139], v[44:47], v[180:183], v[136:139]
    s_waitcnt lgkmcnt(6)
    ds_read_b64_tr_b16 v[44:45], v14 offset:20480
    v_mfma_f32_16x16x32_bf16 v[132:135], v[48:51], v[176:179], v[132:135]
    ds_read_b64_tr_b16 v[46:47], v14 offset:20992
    v_mfma_f32_16x16x32_bf16 v[140:143], v[48:51], v[180:183], v[140:143]
    s_waitcnt lgkmcnt(4)
    ds_read_b64_tr_b16 v[48:49], v15 offset:20480
    buffer_load_dwordx4 v9, s[4:7], s61 offen offset:1024 lds
    v_mfma_f32_16x16x32_bf16 v[112:115], v[36:39], v[184:187], v[112:115]
    ds_read_b64_tr_b16 v[50:51], v15 offset:20992
    v_mfma_f32_16x16x32_bf16 v[120:123], v[36:39], v[188:191], v[120:123]
    s_waitcnt lgkmcnt(4)
    buffer_load_dwordx4 v10, s[4:7], s61 offen offset:2048 lds
    s_waitcnt vmcnt(9)
    buffer_load_dwordx4 v11, s[4:7], s61 offen offset:3072 lds
    s_barrier
    ds_read_b128 v[192:195], v12 offset:12288
    ds_read_b128 v[196:199], v12 offset:14336
    ds_read_b64_tr_b16 v[36:37], v20 offset:24576
    v_mfma_f32_16x16x32_bf16 v[116:119], v[40:43], v[184:187], v[116:119]
    s_mul_i32 s49, s61, 1792
    ds_read_b64_tr_b16 v[38:39], v20 offset:25088
    s_add_u32 m0, s50, 40960
    s_nop 0
    buffer_load_dwordx4 v17, s[8:11], s49 offen lds
    v_mfma_f32_16x16x32_bf16 v[124:127], v[40:43], v[188:191], v[124:127]
    s_waitcnt lgkmcnt(6)
    ds_read_b64_tr_b16 v[40:41], v21 offset:24576
    v_mfma_f32_16x16x32_bf16 v[128:131], v[44:47], v[184:187], v[128:131]
    ds_read_b64_tr_b16 v[42:43], v21 offset:25088
    v_mfma_f32_16x16x32_bf16 v[136:139], v[44:47], v[188:191], v[136:139]
    s_waitcnt lgkmcnt(6)
    ds_read_b64_tr_b16 v[44:45], v14 offset:24576
    v_mfma_f32_16x16x32_bf16 v[132:135], v[48:51], v[184:187], v[132:135]
    ds_read_b64_tr_b16 v[46:47], v14 offset:25088
    buffer_load_dwordx4 v18, s[8:11], s49 offen offset:1024 lds
    s_add_u32 m0, s51, 8192
    v_mfma_f32_16x16x32_bf16 v[140:143], v[48:51], v[188:191], v[140:143]
    s_waitcnt lgkmcnt(4)
    ds_read_b64_tr_b16 v[48:49], v15 offset:24576
    v_mfma_f32_16x16x32_bf16 v[112:115], v[36:39], v[192:195], v[112:115]
    ds_read_b64_tr_b16 v[50:51], v15 offset:25088
    v_mfma_f32_16x16x32_bf16 v[120:123], v[36:39], v[196:199], v[120:123]
    s_waitcnt lgkmcnt(4)
    ds_read_b128 v[200:203], v13 offset:12288
    ds_read_b128 v[204:207], v13 offset:14336
    ds_read_b64_tr_b16 v[36:37], v20 offset:28672
    buffer_load_dwordx4 v8, s[4:7], s62 offen lds
    v_mfma_f32_16x16x32_bf16 v[116:119], v[40:43], v[192:195], v[116:119]
    ds_read_b64_tr_b16 v[38:39], v20 offset:29184
    v_mfma_f32_16x16x32_bf16 v[124:127], v[40:43], v[196:199], v[124:127]
    s_waitcnt lgkmcnt(6)
    ds_read_b64_tr_b16 v[40:41], v21 offset:28672
    v_mfma_f32_16x16x32_bf16 v[128:131], v[44:47], v[192:195], v[128:131]
    ds_read_b64_tr_b16 v[42:43], v21 offset:29184
    v_mfma_f32_16x16x32_bf16 v[136:139], v[44:47], v[196:199], v[136:139]
    s_waitcnt lgkmcnt(6)
    ds_read_b64_tr_b16 v[44:45], v14 offset:28672
    buffer_load_dwordx4 v9, s[4:7], s62 offen offset:1024 lds
    v_mfma_f32_16x16x32_bf16 v[132:135], v[48:51], v[192:195], v[132:135]
    ds_read_b64_tr_b16 v[46:47], v14 offset:29184
    v_mfma_f32_16x16x32_bf16 v[140:143], v[48:51], v[196:199], v[140:143]
    s_waitcnt lgkmcnt(4)
    ds_read_b64_tr_b16 v[48:49], v15 offset:28672
    v_mfma_f32_16x16x32_bf16 v[112:115], v[36:39], v[200:203], v[112:115]
    ds_read_b64_tr_b16 v[50:51], v15 offset:29184
    v_mfma_f32_16x16x32_bf16 v[120:123], v[36:39], v[204:207], v[120:123]
    s_waitcnt lgkmcnt(4)
    buffer_load_dwordx4 v10, s[4:7], s62 offen offset:2048 lds
    s_waitcnt vmcnt(9)
    buffer_load_dwordx4 v11, s[4:7], s62 offen offset:3072 lds
    s_barrier
    ds_read_b128 v[208:211], v12 offset:0
    ds_read_b128 v[212:215], v12 offset:2048
    ds_read_b64_tr_b16 v[36:37], v20 offset:32768
    v_mfma_f32_16x16x32_bf16 v[116:119], v[40:43], v[200:203], v[116:119]
    s_mul_i32 s49, s62, 1792
    ds_read_b64_tr_b16 v[38:39], v20 offset:33280
    s_add_u32 m0, s50, 49152
    s_nop 0
    buffer_load_dwordx4 v17, s[8:11], s49 offen lds
    v_mfma_f32_16x16x32_bf16 v[124:127], v[40:43], v[204:207], v[124:127]
    s_waitcnt lgkmcnt(6)
    ds_read_b64_tr_b16 v[40:41], v21 offset:32768
    v_mfma_f32_16x16x32_bf16 v[128:131], v[44:47], v[200:203], v[128:131]
    ds_read_b64_tr_b16 v[42:43], v21 offset:33280
    v_mfma_f32_16x16x32_bf16 v[136:139], v[44:47], v[204:207], v[136:139]
    s_waitcnt lgkmcnt(6)
    ds_read_b64_tr_b16 v[44:45], v14 offset:32768
    v_mfma_f32_16x16x32_bf16 v[132:135], v[48:51], v[200:203], v[132:135]
    ds_read_b64_tr_b16 v[46:47], v14 offset:33280
    buffer_load_dwordx4 v18, s[8:11], s49 offen offset:1024 lds
    s_mul_i32 s49, s56, 1792
    s_add_u32 m0, s50, 57344
    v_mfma_f32_16x16x32_bf16 v[140:143], v[48:51], v[204:207], v[140:143]
    s_waitcnt lgkmcnt(4)
    ds_read_b64_tr_b16 v[48:49], v15 offset:32768
    v_mfma_f32_16x16x32_bf16 v[112:115], v[36:39], v[208:211], v[112:115]
    ds_read_b64_tr_b16 v[50:51], v15 offset:33280
    v_mfma_f32_16x16x32_bf16 v[120:123], v[36:39], v[212:215], v[120:123]
    s_waitcnt lgkmcnt(4)
    ds_read_b128 v[216:219], v13 offset:0
    ds_read_b128 v[220:223], v13 offset:2048
    ds_read_b64_tr_b16 v[36:37], v20 offset:36864
    buffer_load_dwordx4 v7, s[8:11], s49 offen lds
    v_mfma_f32_16x16x32_bf16 v[116:119], v[40:43], v[208:211], v[116:119]
    ds_read_b64_tr_b16 v[38:39], v20 offset:37376
    v_mfma_f32_16x16x32_bf16 v[124:127], v[40:43], v[212:215], v[124:127]
    s_waitcnt lgkmcnt(6)
    ds_read_b64_tr_b16 v[40:41], v21 offset:36864
    v_mfma_f32_16x16x32_bf16 v[128:131], v[44:47], v[208:211], v[128:131]
    ds_read_b64_tr_b16 v[42:43], v21 offset:37376
    v_mfma_f32_16x16x32_bf16 v[136:139], v[44:47], v[212:215], v[136:139]
    s_waitcnt lgkmcnt(6)
    ds_read_b64_tr_b16 v[44:45], v14 offset:36864
    buffer_load_dwordx4 v16, s[8:11], s49 offen offset:1024 lds
    s_mul_i32 s49, s57, 1792
    s_add_u32 m0, s50, 0
    v_mfma_f32_16x16x32_bf16 v[132:135], v[48:51], v[208:211], v[132:135]
    ds_read_b64_tr_b16 v[46:47], v14 offset:37376
    v_mfma_f32_16x16x32_bf16 v[140:143], v[48:51], v[212:215], v[140:143]
    s_waitcnt lgkmcnt(4)
    ds_read_b64_tr_b16 v[48:49], v15 offset:36864
    v_mfma_f32_16x16x32_bf16 v[112:115], v[36:39], v[216:219], v[112:115]
    ds_read_b64_tr_b16 v[50:51], v15 offset:37376
    v_mfma_f32_16x16x32_bf16 v[120:123], v[36:39], v[220:223], v[120:123]
    s_waitcnt lgkmcnt(4)
    buffer_load_dwordx4 v7, s[8:11], s49 offen lds
    s_waitcnt vmcnt(9)
    buffer_load_dwordx4 v16, s[8:11], s49 offen offset:1024 lds
    s_barrier
    ds_read_b128 v[224:227], v12 offset:4096
    ds_read_b128 v[228:231], v12 offset:6144
    ds_read_b64_tr_b16 v[36:37], v20 offset:40960
    v_mfma_f32_16x16x32_bf16 v[116:119], v[40:43], v[216:219], v[116:119]
    s_mul_i32 s49, s58, 1792
    ds_read_b64_tr_b16 v[38:39], v20 offset:41472
    s_add_u32 m0, s50, 8192
    s_nop 0
    buffer_load_dwordx4 v7, s[8:11], s49 offen lds
    v_mfma_f32_16x16x32_bf16 v[124:127], v[40:43], v[220:223], v[124:127]
    s_waitcnt lgkmcnt(6)
    ds_read_b64_tr_b16 v[40:41], v21 offset:40960
    v_mfma_f32_16x16x32_bf16 v[128:131], v[44:47], v[216:219], v[128:131]
    ds_read_b64_tr_b16 v[42:43], v21 offset:41472
    v_mfma_f32_16x16x32_bf16 v[136:139], v[44:47], v[220:223], v[136:139]
    s_waitcnt lgkmcnt(6)
    ds_read_b64_tr_b16 v[44:45], v14 offset:40960
    v_mfma_f32_16x16x32_bf16 v[132:135], v[48:51], v[216:219], v[132:135]
    ds_read_b64_tr_b16 v[46:47], v14 offset:41472
    v_mfma_f32_16x16x32_bf16 v[140:143], v[48:51], v[220:223], v[140:143]
    s_waitcnt lgkmcnt(4)
    v_mfma_f32_16x16x32_bf16 v[112:115], v[36:39], v[224:227], v[112:115]
    v_mfma_f32_16x16x32_bf16 v[120:123], v[36:39], v[228:231], v[120:123]
    s_waitcnt lgkmcnt(2)
    buffer_load_dwordx4 v16, s[8:11], s49 offen offset:1024 lds
    s_mul_i32 s49, s59, 1792
    s_add_u32 m0, s50, 16384
    v_mfma_f32_16x16x32_bf16 v[116:119], v[40:43], v[224:227], v[116:119]
    v_mfma_f32_16x16x32_bf16 v[124:127], v[40:43], v[228:231], v[124:127]
    s_waitcnt lgkmcnt(0)
    ds_read_b64_tr_b16 v[48:49], v15 offset:40960
    ds_read_b64_tr_b16 v[50:51], v15 offset:41472
    v_mfma_f32_16x16x32_bf16 v[128:131], v[44:47], v[224:227], v[128:131]
    v_mfma_f32_16x16x32_bf16 v[136:139], v[44:47], v[228:231], v[136:139]
    s_waitcnt lgkmcnt(0)
    buffer_load_dwordx4 v7, s[8:11], s49 offen lds
    ds_read_b128 v[232:235], v13 offset:4096
    ds_read_b128 v[236:239], v13 offset:6144
    ds_read_b64_tr_b16 v[36:37], v20 offset:45056
    ds_read_b64_tr_b16 v[38:39], v20 offset:45568
    v_mfma_f32_16x16x32_bf16 v[132:135], v[48:51], v[224:227], v[132:135]
    v_mfma_f32_16x16x32_bf16 v[140:143], v[48:51], v[228:231], v[140:143]
    s_waitcnt lgkmcnt(0)
    buffer_load_dwordx4 v16, s[8:11], s49 offen offset:1024 lds
    s_add_u32 s85, s85, 128
    s_and_b32 s85, s85, 2047
    s_add_u32 m0, s51, 12288
    s_nop 0
    buffer_load_dwordx4 v23, s[32:35], s85 offen lds
    ds_read_b64_tr_b16 v[40:41], v21 offset:45056
    ds_read_b64_tr_b16 v[42:43], v21 offset:45568
    v_mfma_f32_16x16x32_bf16 v[112:115], v[36:39], v[232:235], v[112:115]
    v_mfma_f32_16x16x32_bf16 v[120:123], v[36:39], v[236:239], v[120:123]
    s_waitcnt lgkmcnt(0)
    buffer_load_dwordx4 v24, s[32:35], s85 offen offset:1024 lds
    ds_read_b64_tr_b16 v[44:45], v14 offset:45056
    ds_read_b64_tr_b16 v[46:47], v14 offset:45568
    v_mfma_f32_16x16x32_bf16 v[116:119], v[40:43], v[232:235], v[116:119]
    v_mfma_f32_16x16x32_bf16 v[124:127], v[40:43], v[236:239], v[124:127]
    s_waitcnt lgkmcnt(0)
    buffer_load_dwordx4 v25, s[32:35], s85 offen offset:2048 lds
    ds_read_b64_tr_b16 v[48:49], v15 offset:45056
    ds_read_b64_tr_b16 v[50:51], v15 offset:45568
    v_mfma_f32_16x16x32_bf16 v[128:131], v[44:47], v[232:235], v[128:131]
    v_mfma_f32_16x16x32_bf16 v[136:139], v[44:47], v[236:239], v[136:139]
    s_waitcnt lgkmcnt(0)
    buffer_load_dwordx4 v26, s[32:35], s85 offen offset:3072 lds
    s_waitcnt vmcnt(12)
    s_add_u32 s85, s85, 128
    s_and_b32 s85, s85, 2047
    s_add_u32 m0, s51, 0
    s_nop 0
    buffer_load_dwordx4 v23, s[32:35], s85 offen lds
    s_barrier
    ds_read_b128 v[240:243], v12 offset:8192
    ds_read_b128 v[244:247], v12 offset:10240
    ds_read_b64_tr_b16 v[36:37], v20 offset:49152
    ds_read_b64_tr_b16 v[38:39], v20 offset:49664
    buffer_load_dwordx4 v24, s[32:35], s85 offen offset:1024 lds
    v_mfma_f32_16x16x32_bf16 v[132:135], v[48:51], v[232:235], v[132:135]
    v_mfma_f32_16x16x32_bf16 v[140:143], v[48:51], v[236:239], v[140:143]
    s_waitcnt lgkmcnt(0)
    buffer_load_dwordx4 v25, s[32:35], s85 offen offset:2048 lds
    ds_read_b64_tr_b16 v[40:41], v21 offset:49152
    ds_read_b64_tr_b16 v[42:43], v21 offset:49664
    v_mfma_f32_16x16x32_bf16 v[112:115], v[36:39], v[240:243], v[112:115]
    v_mfma_f32_16x16x32_bf16 v[120:123], v[36:39], v[244:247], v[120:123]
    s_waitcnt lgkmcnt(0)
    buffer_load_dwordx4 v26, s[32:35], s85 offen offset:3072 lds
    ds_read_b64_tr_b16 v[44:45], v14 offset:49152
    ds_read_b64_tr_b16 v[46:47], v14 offset:49664
    v_mfma_f32_16x16x32_bf16 v[116:119], v[40:43], v[240:243], v[116:119]
    v_mfma_f32_16x16x32_bf16 v[124:127], v[40:43], v[244:247], v[124:127]
    s_waitcnt lgkmcnt(0)
    ds_read_b64_tr_b16 v[48:49], v15 offset:49152
    ds_read_b64_tr_b16 v[50:51], v15 offset:49664
    v_mfma_f32_16x16x32_bf16 v[128:131], v[44:47], v[240:243], v[128:131]
    v_mfma_f32_16x16x32_bf16 v[136:139], v[44:47], v[244:247], v[136:139]
    s_waitcnt lgkmcnt(0)
    ds_read_b128 v[248:251], v13 offset:8192
    ds_read_b128 v[252:255], v13 offset:10240
    ds_read_b64_tr_b16 v[36:37], v20 offset:53248
    ds_read_b64_tr_b16 v[38:39], v20 offset:53760
    v_mfma_f32_16x16x32_bf16 v[132:135], v[48:51], v[240:243], v[132:135]
    v_mfma_f32_16x16x32_bf16 v[140:143], v[48:51], v[244:247], v[140:143]
    s_waitcnt lgkmcnt(0)
    ds_read_b64_tr_b16 v[40:41], v21 offset:53248
    ds_read_b64_tr_b16 v[42:43], v21 offset:53760
    v_mfma_f32_16x16x32_bf16 v[112:115], v[36:39], v[248:251], v[112:115]
    v_mfma_f32_16x16x32_bf16 v[120:123], v[36:39], v[252:255], v[120:123]
    s_waitcnt lgkmcnt(0)
    ds_read_b64_tr_b16 v[44:45], v14 offset:53248
    ds_read_b64_tr_b16 v[46:47], v14 offset:53760
    v_mfma_f32_16x16x32_bf16 v[116:119], v[40:43], v[248:251], v[116:119]
    v_mfma_f32_16x16x32_bf16 v[124:127], v[40:43], v[252:255], v[124:127]
    s_waitcnt lgkmcnt(0)
    ds_read_b64_tr_b16 v[48:49], v15 offset:53248
    ds_read_b64_tr_b16 v[50:51], v15 offset:53760
    v_mfma_f32_16x16x32_bf16 v[128:131], v[44:47], v[248:251], v[128:131]
    v_mfma_f32_16x16x32_bf16 v[136:139], v[44:47], v[252:255], v[136:139]
    s_waitcnt lgkmcnt(0)
    v_mfma_f32_16x16x32_bf16 v[132:135], v[48:51], v[248:251], v[132:135]
    v_mfma_f32_16x16x32_bf16 v[140:143], v[48:51], v[252:255], v[140:143]
    s_barrier
    v_pk_mul_f32 v[64:65], v[112:113], v[112:113]
    v_pk_mul_f32 v[66:67], v[114:115], v[114:115]
    v_pk_mul_f32 v[68:69], v[116:117], v[116:117]
    v_pk_mul_f32 v[70:71], v[118:119], v[118:119]
    v_pk_fma_f32 v[64:65], v[64:65], s[64:65], s[64:65] op_sel:[0,1,0] op_sel_hi:[1,1,0]
    v_pk_fma_f32 v[66:67], v[66:67], s[64:65], s[64:65] op_sel:[0,1,0] op_sel_hi:[1,1,0]
    v_pk_fma_f32 v[68:69], v[68:69], s[64:65], s[64:65] op_sel:[0,1,0] op_sel_hi:[1,1,0]
    v_pk_fma_f32 v[70:71], v[70:71], s[64:65], s[64:65] op_sel:[0,1,0] op_sel_hi:[1,1,0]
    v_pk_mul_f32 v[64:65], v[64:65], v[112:113]
    v_pk_mul_f32 v[66:67], v[66:67], v[114:115]
    v_pk_mul_f32 v[68:69], v[68:69], v[116:117]
    v_pk_mul_f32 v[70:71], v[70:71], v[118:119]
    v_exp_f32 v64, v64
    v_exp_f32 v65, v65
    v_exp_f32 v66, v66
    v_exp_f32 v67, v67
    v_exp_f32 v68, v68
    v_exp_f32 v69, v69
    v_exp_f32 v70, v70
    v_exp_f32 v71, v71
    v_pk_add_f32 v[64:65], v[64:65], 1.0 op_sel_hi:[1,0]
    v_pk_add_f32 v[66:67], v[66:67], 1.0 op_sel_hi:[1,0]
    v_pk_add_f32 v[68:69], v[68:69], 1.0 op_sel_hi:[1,0]
    v_pk_add_f32 v[70:71], v[70:71], 1.0 op_sel_hi:[1,0]
    v_rcp_f32 v64, v64
    v_rcp_f32 v65, v65
    v_rcp_f32 v66, v66
    v_rcp_f32 v67, v67
    v_rcp_f32 v68, v68
    v_rcp_f32 v69, v69
    v_rcp_f32 v70, v70
    v_rcp_f32 v71, v71
    v_pk_mul_f32 v[112:113], v[112:113], v[64:65]
    v_pk_mul_f32 v[114:115], v[114:115], v[66:67]
    v_pk_mul_f32 v[116:117], v[116:117], v[68:69]
    v_pk_mul_f32 v[118:119], v[118:119], v[70:71]
    v_pk_mul_f32 v[64:65], v[120:121], v[120:121]
    v_pk_mul_f32 v[66:67], v[122:123], v[122:123]
    v_pk_mul_f32 v[68:69], v[124:125], v[124:125]
    v_pk_mul_f32 v[70:71], v[126:127], v[126:127]
    v_pk_fma_f32 v[64:65], v[64:65], s[64:65], s[64:65] op_sel:[0,1,0] op_sel_hi:[1,1,0]
    v_pk_fma_f32 v[66:67], v[66:67], s[64:65], s[64:65] op_sel:[0,1,0] op_sel_hi:[1,1,0]
    v_pk_fma_f32 v[68:69], v[68:69], s[64:65], s[64:65] op_sel:[0,1,0] op_sel_hi:[1,1,0]
    v_pk_fma_f32 v[70:71], v[70:71], s[64:65], s[64:65] op_sel:[0,1,0] op_sel_hi:[1,1,0]
    v_pk_mul_f32 v[64:65], v[64:65], v[120:121]
    v_pk_mul_f32 v[66:67], v[66:67], v[122:123]
    v_pk_mul_f32 v[68:69], v[68:69], v[124:125]
    v_pk_mul_f32 v[70:71], v[70:71], v[126:127]
    v_exp_f32 v64, v64
    v_exp_f32 v65, v65
    v_exp_f32 v66, v66
    v_exp_f32 v67, v67
    v_exp_f32 v68, v68
    v_exp_f32 v69, v69
    v_exp_f32 v70, v70
    v_exp_f32 v71, v71
    v_pk_add_f32 v[64:65], v[64:65], 1.0 op_sel_hi:[1,0]
    v_pk_add_f32 v[66:67], v[66:67], 1.0 op_sel_hi:[1,0]
    v_pk_add_f32 v[68:69], v[68:69], 1.0 op_sel_hi:[1,0]
    v_pk_add_f32 v[70:71], v[70:71], 1.0 op_sel_hi:[1,0]
    v_rcp_f32 v64, v64
    v_rcp_f32 v65, v65
    v_rcp_f32 v66, v66
    v_rcp_f32 v67, v67
    v_rcp_f32 v68, v68
    v_rcp_f32 v69, v69
    v_rcp_f32 v70, v70
    v_rcp_f32 v71, v71
    v_pk_mul_f32 v[120:121], v[120:121], v[64:65]
    v_pk_mul_f32 v[122:123], v[122:123], v[66:67]
    v_pk_mul_f32 v[124:125], v[124:125], v[68:69]
    v_pk_mul_f32 v[126:127], v[126:127], v[70:71]
    v_pk_mul_f32 v[64:65], v[128:129], v[128:129]
    v_pk_mul_f32 v[66:67], v[130:131], v[130:131]
    v_pk_mul_f32 v[68:69], v[132:133], v[132:133]
    v_pk_mul_f32 v[70:71], v[134:135], v[134:135]
    v_pk_fma_f32 v[64:65], v[64:65], s[64:65], s[64:65] op_sel:[0,1,0] op_sel_hi:[1,1,0]
    v_pk_fma_f32 v[66:67], v[66:67], s[64:65], s[64:65] op_sel:[0,1,0] op_sel_hi:[1,1,0]
    v_pk_fma_f32 v[68:69], v[68:69], s[64:65], s[64:65] op_sel:[0,1,0] op_sel_hi:[1,1,0]
    v_pk_fma_f32 v[70:71], v[70:71], s[64:65], s[64:65] op_sel:[0,1,0] op_sel_hi:[1,1,0]
    v_pk_mul_f32 v[64:65], v[64:65], v[128:129]
    v_pk_mul_f32 v[66:67], v[66:67], v[130:131]
    v_pk_mul_f32 v[68:69], v[68:69], v[132:133]
    v_pk_mul_f32 v[70:71], v[70:71], v[134:135]
    v_exp_f32 v64, v64
    v_exp_f32 v65, v65
    v_exp_f32 v66, v66
    v_exp_f32 v67, v67
    v_exp_f32 v68, v68
    v_exp_f32 v69, v69
    v_exp_f32 v70, v70
    v_exp_f32 v71, v71
    v_pk_add_f32 v[64:65], v[64:65], 1.0 op_sel_hi:[1,0]
    v_pk_add_f32 v[66:67], v[66:67], 1.0 op_sel_hi:[1,0]
    v_pk_add_f32 v[68:69], v[68:69], 1.0 op_sel_hi:[1,0]
    v_pk_add_f32 v[70:71], v[70:71], 1.0 op_sel_hi:[1,0]
    v_rcp_f32 v64, v64
    v_rcp_f32 v65, v65
    v_rcp_f32 v66, v66
    v_rcp_f32 v67, v67
    v_rcp_f32 v68, v68
    v_rcp_f32 v69, v69
    v_rcp_f32 v70, v70
    v_rcp_f32 v71, v71
    v_pk_mul_f32 v[128:129], v[128:129], v[64:65]
    v_pk_mul_f32 v[130:131], v[130:131], v[66:67]
    v_pk_mul_f32 v[132:133], v[132:133], v[68:69]
    v_pk_mul_f32 v[134:135], v[134:135], v[70:71]
    v_pk_mul_f32 v[64:65], v[136:137], v[136:137]
    v_pk_mul_f32 v[66:67], v[138:139], v[138:139]
    v_pk_mul_f32 v[68:69], v[140:141], v[140:141]
    v_pk_mul_f32 v[70:71], v[142:143], v[142:143]
    v_pk_fma_f32 v[64:65], v[64:65], s[64:65], s[64:65] op_sel:[0,1,0] op_sel_hi:[1,1,0]
    v_pk_fma_f32 v[66:67], v[66:67], s[64:65], s[64:65] op_sel:[0,1,0] op_sel_hi:[1,1,0]
    v_pk_fma_f32 v[68:69], v[68:69], s[64:65], s[64:65] op_sel:[0,1,0] op_sel_hi:[1,1,0]
    v_pk_fma_f32 v[70:71], v[70:71], s[64:65], s[64:65] op_sel:[0,1,0] op_sel_hi:[1,1,0]
    v_pk_mul_f32 v[64:65], v[64:65], v[136:137]
    v_pk_mul_f32 v[66:67], v[66:67], v[138:139]
    v_pk_mul_f32 v[68:69], v[68:69], v[140:141]
    v_pk_mul_f32 v[70:71], v[70:71], v[142:143]
    v_exp_f32 v64, v64
    v_exp_f32 v65, v65
    v_exp_f32 v66, v66
    v_exp_f32 v67, v67
    v_exp_f32 v68, v68
    v_exp_f32 v69, v69
    v_exp_f32 v70, v70
    v_exp_f32 v71, v71
    v_pk_add_f32 v[64:65], v[64:65], 1.0 op_sel_hi:[1,0]
    v_pk_add_f32 v[66:67], v[66:67], 1.0 op_sel_hi:[1,0]
    v_pk_add_f32 v[68:69], v[68:69], 1.0 op_sel_hi:[1,0]
    v_pk_add_f32 v[70:71], v[70:71], 1.0 op_sel_hi:[1,0]
    v_rcp_f32 v64, v64
    v_rcp_f32 v65, v65
    v_rcp_f32 v66, v66
    v_rcp_f32 v67, v67
    v_rcp_f32 v68, v68
    v_rcp_f32 v69, v69
    v_rcp_f32 v70, v70
    v_rcp_f32 v71, v71
    v_pk_mul_f32 v[136:137], v[136:137], v[64:65]
    v_pk_mul_f32 v[138:139], v[138:139], v[66:67]
    v_pk_mul_f32 v[140:141], v[140:141], v[68:69]
    v_pk_mul_f32 v[142:143], v[142:143], v[70:71]
    v_pk_add_f32 v[64:65], v[112:113], v[114:115]
    v_pk_mul_f32 v[66:67], v[112:113], v[112:113]
    v_pk_fma_f32 v[66:67], v[114:115], v[114:115], v[66:67]
    v_pk_add_f32 v[64:65], v[64:65], v[116:117]
    v_pk_fma_f32 v[66:67], v[116:117], v[116:117], v[66:67]
    v_pk_add_f32 v[64:65], v[64:65], v[118:119]
    v_pk_fma_f32 v[66:67], v[118:119], v[118:119], v[66:67]
    v_pk_add_f32 v[64:65], v[64:65], v[128:129]
    v_pk_fma_f32 v[66:67], v[128:129], v[128:129], v[66:67]
    v_pk_add_f32 v[64:65], v[64:65], v[130:131]
    v_pk_fma_f32 v[66:67], v[130:131], v[130:131], v[66:67]
    v_pk_add_f32 v[64:65], v[64:65], v[132:133]
    v_pk_fma_f32 v[66:67], v[132:133], v[132:133], v[66:67]
    v_pk_add_f32 v[64:65], v[64:65], v[134:135]
    v_pk_fma_f32 v[66:67], v[134:135], v[134:135], v[66:67]
    v_pk_add_f32 v[68:69], v[120:121], v[122:123]
    v_pk_mul_f32 v[70:71], v[120:121], v[120:121]
    v_pk_fma_f32 v[70:71], v[122:123], v[122:123], v[70:71]
    v_pk_add_f32 v[68:69], v[68:69], v[124:125]
    v_pk_fma_f32 v[70:71], v[124:125], v[124:125], v[70:71]
    v_pk_add_f32 v[68:69], v[68:69], v[126:127]
    v_pk_fma_f32 v[70:71], v[126:127], v[126:127], v[70:71]
    v_pk_add_f32 v[68:69], v[68:69], v[136:137]
    v_pk_fma_f32 v[70:71], v[136:137], v[136:137], v[70:71]
    v_pk_add_f32 v[68:69], v[68:69], v[138:139]
    v_pk_fma_f32 v[70:71], v[138:139], v[138:139], v[70:71]
    v_pk_add_f32 v[68:69], v[68:69], v[140:141]
    v_pk_fma_f32 v[70:71], v[140:141], v[140:141], v[70:71]
    v_pk_add_f32 v[68:69], v[68:69], v[142:143]
    v_pk_fma_f32 v[70:71], v[142:143], v[142:143], v[70:71]
    v_add_f32 v64, v64, v65
    v_add_f32 v68, v68, v69
    v_add_f32 v66, v66, v67
    v_add_f32 v70, v70, v71
    v_and_b32 v72, 15, v0
    v_permlane32_swap_b32 v64, v68
    v_permlane32_swap_b32 v66, v70
    v_add_f32 v64, v64, v68
    v_add_f32 v66, v66, v70
    v_lshlrev_b32 v72, 4, v72
    v_lshl_add_u32 v72, v3, 7, v72
    v_permlane16_swap_b32 v64, v66
    v_add_f32 v64, v64, v66
    v_mov_b32 v66, s52
    v_mov_b32 v67, s52
    v_permlane16_swap_b32 v64, v65
    s_lshl_b32 s45, s41, 9
    s_add_u32 s45, s45, s82
    s_mov_b32 exec_lo, 0xffff
    s_mov_b32 exec_hi, 0xffff
    buffer_store_dwordx4 v[64:67], v72, s[16:19], s45 offen sc1
    s_mov_b64 exec, -1
    s_mul_i32 s49, s60, 1792
    s_add_u32 m0, s50, 24576
    s_nop 0
    buffer_load_dwordx4 v7, s[8:11], s49 offen lds
    buffer_load_dwordx4 v16, s[8:11], s49 offen offset:1024 lds
    s_mul_i32 s49, s61, 1792
    s_add_u32 m0, s50, 32768
    s_nop 0
    buffer_load_dwordx4 v7, s[8:11], s49 offen lds
    v_bfe_u32 v17, v0, 2, 2
    v_lshl_add_u32 v17, v3, 3, v17
    v_mul_u32_u24 v17, 144, v17
    v_and_b32 v18, 3, v0
    v_lshl_add_u32 v17, v18, 4, v17
    v_add_u32 v17, s79, v17
    v_and_b32 v18, 15, v0
    v_mul_u32_u24 v18, 144, v18
    buffer_load_dwordx4 v16, s[8:11], s49 offen offset:1024 lds
    v_lshl_add_u32 v18, v3, 4, v18
    s_waitcnt vmcnt(9)
    ds_read_b128 a[0:3], v27 offset:12288
    ds_read_b128 a[4:7], v27 offset:14336
    ds_read_b128 a[8:11], v28 offset:12288
    ds_read_b128 a[12:15], v28 offset:14336
    v_add_u32 v18, s79, v18
    s_mul_i32 s45, s44, 57344
    s_mul_i32 s49, s62, 1792
    s_add_u32 m0, s50, 40960
    s_nop 0
    buffer_load_dwordx4 v7, s[8:11], s49 offen lds
    s_lshl_b32 s46, s41, 12
    s_add_u32 s45, s45, s46
    s_add_u32 s45, s45, 11403264
    buffer_load_dwordx4 v16, s[8:11], s49 offen offset:1024 lds
    s_add_u32 s85, s85, 128
    s_and_b32 s85, s85, 2047
    s_add_u32 m0, s51, 4096
    s_nop 0
    buffer_load_dwordx4 v23, s[32:35], s85 offen lds
    buffer_load_dwordx4 v24, s[32:35], s85 offen offset:1024 lds
    s_waitcnt vmcnt(9)
    ds_read_b128 a[16:19], v27 offset:0
    ds_read_b128 a[20:23], v27 offset:2048
    ds_read_b128 a[24:27], v28 offset:0
    ds_read_b128 a[28:31], v28 offset:2048
    buffer_load_dwordx4 v25, s[32:35], s85 offen offset:2048 lds
    s_barrier
    ds_read_b64_tr_b16 v[36:37], v20 offset:57344
    ds_read_b64_tr_b16 v[38:39], v20 offset:57856
    ds_read_b64_tr_b16 v[40:41], v21 offset:57344
    ds_read_b64_tr_b16 v[42:43], v21 offset:57856
    buffer_load_dwordx4 v26, s[32:35], s85 offen offset:3072 lds
    ds_read_b64_tr_b16 v[44:45], v14 offset:57344
    ds_read_b64_tr_b16 v[46:47], v14 offset:57856
    ds_read_b64_tr_b16 v[48:49], v15 offset:57344
    ds_read_b64_tr_b16 v[50:51], v15 offset:57856
    s_waitcnt lgkmcnt(6)
    v_mfma_f32_16x16x32_bf16 v[80:83], v[36:39], v[144:147], 0
    s_add_u32 s85, s85, 128
    s_and_b32 s85, s85, 2047
    s_add_u32 m0, s51, 8192
    s_nop 0
    buffer_load_dwordx4 v23, s[32:35], s85 offen lds
    v_mfma_f32_16x16x32_bf16 v[88:91], v[36:39], v[148:151], 0
    s_waitcnt lgkmcnt(4)
    ds_read_b64_tr_b16 v[36:37], v20 offset:61440
    v_mfma_f32_16x16x32_bf16 v[84:87], v[40:43], v[144:147], 0
    ds_read_b64_tr_b16 v[38:39], v20 offset:61952
    v_mfma_f32_16x16x32_bf16 v[92:95], v[40:43], v[148:151], 0
    s_waitcnt lgkmcnt(4)
    ds_read_b64_tr_b16 v[40:41], v21 offset:61440
    v_mfma_f32_16x16x32_bf16 v[96:99], v[44:47], v[144:147], 0
    ds_read_b64_tr_b16 v[42:43], v21 offset:61952
    buffer_load_dwordx4 v24, s[32:35], s85 offen offset:1024 lds
    v_mfma_f32_16x16x32_bf16 v[104:107], v[44:47], v[148:151], 0
    s_waitcnt lgkmcnt(4)
    ds_read_b64_tr_b16 v[44:45], v14 offset:61440
    v_mfma_f32_16x16x32_bf16 v[100:103], v[48:51], v[144:147], 0
    ds_read_b64_tr_b16 v[46:47], v14 offset:61952
    v_mfma_f32_16x16x32_bf16 v[108:111], v[48:51], v[148:151], 0
    s_waitcnt lgkmcnt(4)
    ds_read_b64_tr_b16 v[48:49], v15 offset:61440
    v_permlane16_swap_b32 v144, v148
    v_mfma_f32_16x16x32_bf16 v[80:83], v[36:39], v[152:155], v[80:83]
    ds_read_b64_tr_b16 v[50:51], v15 offset:61952
    buffer_load_dwordx4 v25, s[32:35], s85 offen offset:2048 lds
    v_mfma_f32_16x16x32_bf16 v[88:91], v[36:39], v[156:159], v[88:91]
    s_waitcnt lgkmcnt(4)
    ds_read_b64_tr_b16 v[36:37], v20 offset:0
    v_permlane16_swap_b32 v145, v149
    v_mfma_f32_16x16x32_bf16 v[84:87], v[40:43], v[152:155], v[84:87]
    ds_read_b64_tr_b16 v[38:39], v20 offset:512
    v_permlane16_swap_b32 v146, v150
    v_mfma_f32_16x16x32_bf16 v[92:95], v[40:43], v[156:159], v[92:95]
    s_waitcnt lgkmcnt(4)
    ds_read_b64_tr_b16 v[40:41], v21 offset:0
    v_permlane16_swap_b32 v147, v151
    v_mfma_f32_16x16x32_bf16 v[96:99], v[44:47], v[152:155], v[96:99]
    ds_read_b64_tr_b16 v[42:43], v21 offset:512
    buffer_load_dwordx4 v26, s[32:35], s85 offen offset:3072 lds
    s_add_u32 s85, s85, 128
    s_and_b32 s85, s85, 2047
    s_add_u32 m0, s51, 12288
    v_mfma_f32_16x16x32_bf16 v[104:107], v[44:47], v[156:159], v[104:107]
    s_waitcnt lgkmcnt(4)
    ds_read_b64_tr_b16 v[44:45], v14 offset:0
    v_mfma_f32_16x16x32_bf16 v[100:103], v[48:51], v[152:155], v[100:103]
    ds_read_b64_tr_b16 v[46:47], v14 offset:512
    v_mfma_f32_16x16x32_bf16 v[108:111], v[48:51], v[156:159], v[108:111]
    s_waitcnt lgkmcnt(4)
    ds_read_b64_tr_b16 v[48:49], v15 offset:0
    buffer_load_dwordx4 v23, s[32:35], s85 offen lds
    v_mfma_f32_16x16x32_bf16 v[80:83], v[36:39], v[160:163], v[80:83]
    ds_read_b64_tr_b16 v[50:51], v15 offset:512
    v_permlane16_swap_b32 v152, v156
    v_mfma_f32_16x16x32_bf16 v[88:91], v[36:39], v[164:167], v[88:91]
    s_waitcnt lgkmcnt(4)
    ds_read_b64_tr_b16 v[36:37], v20 offset:4096
    v_permlane16_swap_b32 v153, v157
    v_mfma_f32_16x16x32_bf16 v[84:87], v[40:43], v[160:163], v[84:87]
    ds_read_b64_tr_b16 v[38:39], v20 offset:4608
    v_permlane16_swap_b32 v154, v158
    v_mfma_f32_16x16x32_bf16 v[92:95], v[40:43], v[164:167], v[92:95]
    s_waitcnt lgkmcnt(4)
    ds_read_b64_tr_b16 v[40:41], v21 offset:4096
    buffer_load_dwordx4 v24, s[32:35], s85 offen offset:1024 lds
    v_mfma_f32_16x16x32_bf16 v[96:99], v[44:47], v[160:163], v[96:99]
    ds_read_b64_tr_b16 v[42:43], v21 offset:4608
    v_permlane16_swap_b32 v155, v159
    v_mfma_f32_16x16x32_bf16 v[104:107], v[44:47], v[164:167], v[104:107]
    s_waitcnt lgkmcnt(4)
    ds_read_b64_tr_b16 v[44:45], v14 offset:4096
    v_mfma_f32_16x16x32_bf16 v[100:103], v[48:51], v[160:163], v[100:103]
    ds_read_b64_tr_b16 v[46:47], v14 offset:4608
    v_mfma_f32_16x16x32_bf16 v[108:111], v[48:51], v[164:167], v[108:111]
    s_waitcnt lgkmcnt(4)
    ds_read_b64_tr_b16 v[48:49], v15 offset:4096
    buffer_load_dwordx4 v25, s[32:35], s85 offen offset:2048 lds
    v_mfma_f32_16x16x32_bf16 v[80:83], v[36:39], v[168:171], v[80:83]
    ds_read_b64_tr_b16 v[50:51], v15 offset:4608
    v_permlane16_swap_b32 v160, v164
    v_mfma_f32_16x16x32_bf16 v[88:91], v[36:39], v[172:175], v[88:91]
    s_waitcnt lgkmcnt(4)
    ds_read_b64_tr_b16 v[36:37], v20 offset:8192
    v_permlane16_swap_b32 v161, v165
    v_mfma_f32_16x16x32_bf16 v[84:87], v[40:43], v[168:171], v[84:87]
    ds_read_b64_tr_b16 v[38:39], v20 offset:8704
    v_permlane16_swap_b32 v162, v166
    v_mfma_f32_16x16x32_bf16 v[92:95], v[40:43], v[172:175], v[92:95]
    s_waitcnt lgkmcnt(4)
    ds_read_b64_tr_b16 v[40:41], v21 offset:8192
    buffer_load_dwordx4 v26, s[32:35], s85 offen offset:3072 lds
    s_add_u32 s85, s85, 128
    s_and_b32 s85, s85, 2047
    s_add_u32 m0, s51, 0
    v_mfma_f32_16x16x32_bf16 v[96:99], v[44:47], v[168:171], v[96:99]
    ds_read_b64_tr_b16 v[42:43], v21 offset:8704
    v_permlane16_swap_b32 v163, v167
    v_mfma_f32_16x16x32_bf16 v[104:107], v[44:47], v[172:175], v[104:107]
    s_waitcnt lgkmcnt(4)
    ds_read_b64_tr_b16 v[44:45], v14 offset:8192
    s_lshl_b32 s70, s36, 7
    s_add_u32 s70, s70, 4096
    s_lshl_b32 s71, s36, 10
    s_not_b64 s[4:5], s[52:53]
    s_not_b64 s[6:7], s[52:53]
    s_not_b64 s[8:9], s[52:53]
    s_not_b64 s[10:11], s[52:53]
    s_buffer_load_dwordx8 s[4:11], s[16:19], s70 offset:0
    buffer_load_dwordx4 v23, s[32:35], s85 offen lds
    v_mfma_f32_16x16x32_bf16 v[100:103], v[48:51], v[168:171], v[100:103]
    ds_read_b64_tr_b16 v[46:47], v14 offset:8704
    v_mfma_f32_16x16x32_bf16 v[108:111], v[48:51], v[172:175], v[108:111]
    s_waitcnt lgkmcnt(4)
    ds_read_b64_tr_b16 v[48:49], v15 offset:8192
    v_permlane16_swap_b32 v168, v172
    v_mfma_f32_16x16x32_bf16 v[80:83], v[36:39], v[176:179], v[80:83]
    ds_read_b64_tr_b16 v[50:51], v15 offset:8704
    v_permlane16_swap_b32 v169, v173
    v_mfma_f32_16x16x32_bf16 v[88:91], v[36:39], v[180:183], v[88:91]
    s_waitcnt lgkmcnt(4)
    ds_read_b64_tr_b16 v[36:37], v20 offset:12288
    buffer_load_dwordx4 v24, s[32:35], s85 offen offset:1024 lds
    v_mfma_f32_16x16x32_bf16 v[84:87], v[40:43], v[176:179], v[84:87]
    ds_read_b64_tr_b16 v[38:39], v20 offset:12800
    v_permlane16_swap_b32 v170, v174
    v_mfma_f32_16x16x32_bf16 v[92:95], v[40:43], v[180:183], v[92:95]
    s_waitcnt lgkmcnt(4)
    ds_read_b64_tr_b16 v[40:41], v21 offset:12288
    v_permlane16_swap_b32 v171, v175
    v_mfma_f32_16x16x32_bf16 v[96:99], v[44:47], v[176:179], v[96:99]
    ds_read_b64_tr_b16 v[42:43], v21 offset:12800
    v_mfma_f32_16x16x32_bf16 v[104:107], v[44:47], v[180:183], v[104:107]
    s_waitcnt lgkmcnt(4)
    ds_read_b64_tr_b16 v[44:45], v14 offset:12288
    buffer_load_dwordx4 v25, s[32:35], s85 offen offset:2048 lds
    v_mfma_f32_16x16x32_bf16 v[100:103], v[48:51], v[176:179], v[100:103]
    ds_read_b64_tr_b16 v[46:47], v14 offset:12800
    v_mfma_f32_16x16x32_bf16 v[108:111], v[48:51], v[180:183], v[108:111]
    s_waitcnt lgkmcnt(4)
    ds_read_b64_tr_b16 v[48:49], v15 offset:12288
    v_permlane16_swap_b32 v176, v180
    v_mfma_f32_16x16x32_bf16 v[80:83], v[36:39], v[184:187], v[80:83]
    ds_read_b64_tr_b16 v[50:51], v15 offset:12800
    s_waitcnt vmcnt(11)
    ds_read_b128 a[32:35], v27 offset:4096
    ds_read_b128 a[36:39], v27 offset:6144
    v_mfma_f32_16x16x32_bf16 v[88:91], v[36:39], v[188:191], v[88:91]
    s_waitcnt lgkmcnt(6)
    s_barrier
    buffer_load_dwordx4 v[52:55], v4, s[16:19], s82 offen offset:0 sc1
    ds_read_b64_tr_b16 v[36:37], v20 offset:16384
    ds_read_b128 a[40:43], v28 offset:4096
    ds_read_b128 a[44:47], v28 offset:6144
    v_mfma_f32_16x16x32_bf16 v[84:87], v[40:43], v[184:187], v[84:87]
    ds_read_b64_tr_b16 v[38:39], v20 offset:16896
    v_permlane16_swap_b32 v177, v181
    v_mfma_f32_16x16x32_bf16 v[92:95], v[40:43], v[188:191], v[92:95]
    s_waitcnt lgkmcnt(8)
    ds_read_b64_tr_b16 v[40:41], v21 offset:16384
    buffer_load_dwordx4 v[56:59], v4, s[16:19], s82 offen offset:1024 sc1
    v_mfma_f32_16x16x32_bf16 v[96:99], v[44:47], v[184:187], v[96:99]
    ds_read_b64_tr_b16 v[42:43], v21 offset:16896
    v_permlane16_swap_b32 v178, v182
    v_mfma_f32_16x16x32_bf16 v[104:107], v[44:47], v[188:191], v[104:107]
    s_waitcnt lgkmcnt(8)
    ds_read_b64_tr_b16 v[44:45], v14 offset:16384
    v_permlane16_swap_b32 v179, v183
    v_mfma_f32_16x16x32_bf16 v[100:103], v[48:51], v[184:187], v[100:103]
    ds_read_b64_tr_b16 v[46:47], v14 offset:16896
    v_mfma_f32_16x16x32_bf16 v[108:111], v[48:51], v[188:191], v[108:111]
    s_waitcnt lgkmcnt(4)
    ds_read_b64_tr_b16 v[48:49], v15 offset:16384
    buffer_load_dwordx4 v[60:63], v4, s[16:19], s82 offen offset:2048 sc1
    v_mfma_f32_16x16x32_bf16 v[80:83], v[36:39], v[192:195], v[80:83]
    ds_read_b64_tr_b16 v[50:51], v15 offset:16896
    v_permlane16_swap_b32 v184, v188
    v_mfma_f32_16x16x32_bf16 v[88:91], v[36:39], v[196:199], v[88:91]
    s_waitcnt lgkmcnt(4)
    ds_read_b64_tr_b16 v[36:37], v20 offset:20480
    v_permlane16_swap_b32 v185, v189
    v_mfma_f32_16x16x32_bf16 v[84:87], v[40:43], v[192:195], v[84:87]
    ds_read_b64_tr_b16 v[38:39], v20 offset:20992
    s_waitcnt vmcnt(10)
    ds_read_b128 a[48:51], v27 offset:8192
    buffer_load_dwordx4 v[64:67], v4, s[16:19], s82 offen offset:3072 sc1
    v_mfma_f32_16x16x32_bf16 v[92:95], v[40:43], v[196:199], v[92:95]
    s_waitcnt lgkmcnt(5)
    ds_read_b64_tr_b16 v[40:41], v21 offset:20480
    ds_read_b128 a[52:55], v27 offset:10240
    v_mfma_f32_16x16x32_bf16 v[96:99], v[44:47], v[192:195], v[96:99]
    ds_read_b64_tr_b16 v[42:43], v21 offset:20992
    ds_read_b128 a[56:59], v28 offset:8192
    buffer_load_dwordx4 v[68:71], v4, s[16:19], s83 offen offset:0 sc1
    v_mfma_f32_16x16x32_bf16 v[104:107], v[44:47], v[196:199], v[104:107]
    s_waitcnt lgkmcnt(7)
    ds_read_b64_tr_b16 v[44:45], v14 offset:20480
    ds_read_b128 a[60:63], v28 offset:10240
    v_mfma_f32_16x16x32_bf16 v[100:103], v[48:51], v[192:195], v[100:103]
    ds_read_b64_tr_b16 v[46:47], v14 offset:20992
    v_permlane16_swap_b32 v186, v190
    v_mfma_f32_16x16x32_bf16 v[108:111], v[48:51], v[196:199], v[108:111]
    s_waitcnt lgkmcnt(8)
    ds_read_b64_tr_b16 v[48:49], v15 offset:20480
    buffer_load_dwordx4 v[72:75], v4, s[16:19], s83 offen offset:1024 sc1
    v_mfma_f32_16x16x32_bf16 v[80:83], v[36:39], v[200:203], v[80:83]
    ds_read_b64_tr_b16 v[50:51], v15 offset:20992
    v_permlane16_swap_b32 v187, v191
    v_mfma_f32_16x16x32_bf16 v[88:91], v[36:39], v[204:207], v[88:91]
    s_waitcnt lgkmcnt(6)
    s_barrier
    buffer_load_dwordx4 v[76:79], v4, s[16:19], s83 offen offset:2048 sc1
    ds_read_b64_tr_b16 v[36:37], v20 offset:24576
    v_mfma_f32_16x16x32_bf16 v[84:87], v[40:43], v[200:203], v[84:87]
    ds_read_b64_tr_b16 v[38:39], v20 offset:25088
    v_permlane16_swap_b32 v192, v196
    v_mfma_f32_16x16x32_bf16 v[92:95], v[40:43], v[204:207], v[92:95]
    s_waitcnt lgkmcnt(4)
    ds_read_b64_tr_b16 v[40:41], v21 offset:24576
    v_permlane16_swap_b32 v193, v197
    v_mfma_f32_16x16x32_bf16 v[96:99], v[44:47], v[200:203], v[96:99]
    ds_read_b64_tr_b16 v[42:43], v21 offset:25088
    buffer_load_dwordx4 v26, s[32:35], s85 offen offset:3072 lds
    s_add_u32 s85, s85, 128
    s_and_b32 s85, s85, 2047
    s_add_u32 m0, s51, 4096
    v_mfma_f32_16x16x32_bf16 v[104:107], v[44:47], v[204:207], v[104:107]
    s_waitcnt lgkmcnt(4)
    ds_read_b64_tr_b16 v[44:45], v14 offset:24576
    s_waitcnt vmcnt(11)
    ds_read_b128 a[64:67], v27 offset:12288
    ds_read_b128 a[68:71], v27 offset:14336
    v_mfma_f32_16x16x32_bf16 v[100:103], v[48:51], v[200:203], v[100:103]
    ds_read_b64_tr_b16 v[46:47], v14 offset:25088
    ds_read_b128 a[72:75], v28 offset:12288
    ds_read_b128 a[76:79], v28 offset:14336
    v_mfma_f32_16x16x32_bf16 v[108:111], v[48:51], v[204:207], v[108:111]
    s_waitcnt lgkmcnt(8)
    ds_read_b64_tr_b16 v[48:49], v15 offset:24576
    s_cmp_eq_u64 s[4:5], s[52:53]
    s_cbranch_scc0 Lslow_1
    s_cmp_eq_u64 s[6:7], s[52:53]
    s_cbranch_scc0 Lslow_1
    s_cmp_eq_u64 s[8:9], s[52:53]
    s_cbranch_scc0 Lslow_1
    s_cmp_eq_u64 s[10:11], s[52:53]
    s_cbranch_scc0 Lslow_1
Lback_2:
    s_nop 0
    buffer_load_dwordx4 v23, s[32:35], s85 offen lds
    v_mfma_f32_16x16x32_bf16 v[80:83], v[36:39], v[208:211], v[80:83]
    ds_read_b64_tr_b16 v[50:51], v15 offset:25088
    v_permlane16_swap_b32 v194, v198
    v_mfma_f32_16x16x32_bf16 v[88:91], v[36:39], v[212:215], v[88:91]
    s_waitcnt lgkmcnt(8)
    ds_read_b64_tr_b16 v[36:37], v20 offset:28672
    v_permlane16_swap_b32 v195, v199
    v_mfma_f32_16x16x32_bf16 v[84:87], v[40:43], v[208:211], v[84:87]
    ds_read_b64_tr_b16 v[38:39], v20 offset:29184
    v_permlane16_swap_b32 v200, v204
    v_mfma_f32_16x16x32_bf16 v[92:95], v[40:43], v[212:215], v[92:95]
    s_waitcnt lgkmcnt(6)
    ds_read_b64_tr_b16 v[40:41], v21 offset:28672
    buffer_load_dwordx4 v24, s[32:35], s85 offen offset:1024 lds
    v_mfma_f32_16x16x32_bf16 v[96:99], v[44:47], v[208:211], v[96:99]
    ds_read_b64_tr_b16 v[42:43], v21 offset:29184
    v_permlane16_swap_b32 v201, v205
    v_mfma_f32_16x16x32_bf16 v[104:107], v[44:47], v[212:215], v[104:107]
    s_waitcnt lgkmcnt(4)
    ds_read_b64_tr_b16 v[44:45], v14 offset:28672
    v_permlane16_swap_b32 v202, v206
    v_mfma_f32_16x16x32_bf16 v[100:103], v[48:51], v[208:211], v[100:103]
    ds_read_b64_tr_b16 v[46:47], v14 offset:29184
    v_permlane16_swap_b32 v203, v207
    v_mfma_f32_16x16x32_bf16 v[108:111], v[48:51], v[212:215], v[108:111]
    s_waitcnt lgkmcnt(4)
    ds_read_b64_tr_b16 v[48:49], v15 offset:28672
    buffer_load_dwordx4 v25, s[32:35], s85 offen offset:2048 lds
    v_mfma_f32_16x16x32_bf16 v[80:83], v[36:39], v[216:219], v[80:83]
    ds_read_b64_tr_b16 v[50:51], v15 offset:29184
    v_permlane16_swap_b32 v208, v212
    v_mfma_f32_16x16x32_bf16 v[88:91], v[36:39], v[220:223], v[88:91]
    s_waitcnt lgkmcnt(4)
    ds_read_b64_tr_b16 v[36:37], v20 offset:32768
    v_permlane16_swap_b32 v209, v213
    v_mfma_f32_16x16x32_bf16 v[84:87], v[40:43], v[216:219], v[84:87]
    ds_read_b64_tr_b16 v[38:39], v20 offset:33280
    v_permlane16_swap_b32 v210, v214
    v_mfma_f32_16x16x32_bf16 v[92:95], v[40:43], v[220:223], v[92:95]
    s_waitcnt lgkmcnt(4)
    ds_read_b64_tr_b16 v[40:41], v21 offset:32768
    buffer_load_dwordx4 v26, s[32:35], s85 offen offset:3072 lds
    s_mul_i32 s49, s56, 96
    s_add_u32 m0, s71, 63488
    v_mfma_f32_16x16x32_bf16 v[96:99], v[44:47], v[216:219], v[96:99]
    ds_read_b64_tr_b16 v[42:43], v21 offset:33280
    v_permlane16_swap_b32 v211, v215
    v_mfma_f32_16x16x32_bf16 v[104:107], v[44:47], v[220:223], v[104:107]
    s_waitcnt lgkmcnt(4)
    ds_read_b64_tr_b16 v[44:45], v14 offset:32768
    v_mfma_f32_16x16x32_bf16 v[100:103], v[48:51], v[216:219], v[100:103]
    ds_read_b64_tr_b16 v[46:47], v14 offset:33280
    buffer_load_dwordx4 v19, s[16:19], s49 offen offset:2048 sc1 lds
    s_mul_i32 s49, s57, 96
    s_add_u32 m0, s71, 67584
    v_mfma_f32_16x16x32_bf16 v[108:111], v[48:51], v[220:223], v[108:111]
    s_waitcnt lgkmcnt(4)
    ds_read_b64_tr_b16 v[48:49], v15 offset:32768
    v_permlane16_swap_b32 v216, v220
    v_mfma_f32_16x16x32_bf16 v[80:83], v[36:39], v[224:227], v[80:83]
    ds_read_b64_tr_b16 v[50:51], v15 offset:33280
    v_permlane16_swap_b32 v217, v221
    v_mfma_f32_16x16x32_bf16 v[88:91], v[36:39], v[228:231], v[88:91]
    s_waitcnt lgkmcnt(4)
    ds_read_b64_tr_b16 v[36:37], v20 offset:36864
    buffer_load_dwordx4 v19, s[16:19], s49 offen offset:2048 sc1 lds
    s_mul_i32 s49, s58, 96
    s_add_u32 m0, s71, 71680
    v_mfma_f32_16x16x32_bf16 v[84:87], v[40:43], v[224:227], v[84:87]
    ds_read_b64_tr_b16 v[38:39], v20 offset:37376
    v_permlane16_swap_b32 v218, v222
    v_mfma_f32_16x16x32_bf16 v[92:95], v[40:43], v[228:231], v[92:95]
    s_waitcnt lgkmcnt(4)
    ds_read_b64_tr_b16 v[40:41], v21 offset:36864
    v_permlane16_swap_b32 v219, v223
    v_mfma_f32_16x16x32_bf16 v[96:99], v[44:47], v[224:227], v[96:99]
    ds_read_b64_tr_b16 v[42:43], v21 offset:37376
    buffer_load_dwordx4 v19, s[16:19], s49 offen offset:2048 sc1 lds
    s_mul_i32 s49, s59, 96
    s_add_u32 m0, s71, 75776
    v_mfma_f32_16x16x32_bf16 v[104:107], v[44:47], v[228:231], v[104:107]
    s_waitcnt lgkmcnt(4)
    ds_read_b64_tr_b16 v[44:45], v14 offset:36864
    v_mfma_f32_16x16x32_bf16 v[100:103], v[48:51], v[224:227], v[100:103]
    ds_read_b64_tr_b16 v[46:47], v14 offset:37376
    v_mfma_f32_16x16x32_bf16 v[108:111], v[48:51], v[228:231], v[108:111]
    s_waitcnt lgkmcnt(4)
    ds_read_b64_tr_b16 v[48:49], v15 offset:36864
    buffer_load_dwordx4 v19, s[16:19], s49 offen offset:2048 sc1 lds
    s_add_u32 s85, s85, 128
    s_and_b32 s85, s85, 2047
    s_add_u32 m0, s51, 8192
    v_mfma_f32_16x16x32_bf16 v[80:83], v[36:39], v[232:235], v[80:83]
    ds_read_b64_tr_b16 v[50:51], v15 offset:37376
    v_permlane16_swap_b32 v224, v228
    v_mfma_f32_16x16x32_bf16 v[88:91], v[36:39], v[236:239], v[88:91]
    s_waitcnt lgkmcnt(4)
    s_barrier
    buffer_load_dwordx4 v23, s[32:35], s85 offen lds
    ds_read_b64_tr_b16 v[36:37], v20 offset:40960
    v_mfma_f32_16x16x32_bf16 v[84:87], v[40:43], v[232:235], v[84:87]
    ds_read_b64_tr_b16 v[38:39], v20 offset:41472
    v_permlane16_swap_b32 v225, v229
    v_mfma_f32_16x16x32_bf16 v[92:95], v[40:43], v[236:239], v[92:95]
    s_waitcnt lgkmcnt(4)
    ds_read_b64_tr_b16 v[40:41], v21 offset:40960
    v_permlane16_swap_b32 v226, v230
    v_mfma_f32_16x16x32_bf16 v[96:99], v[44:47], v[232:235], v[96:99]
    ds_read_b64_tr_b16 v[42:43], v21 offset:41472
    buffer_load_dwordx4 v24, s[32:35], s85 offen offset:1024 lds
    v_mfma_f32_16x16x32_bf16 v[104:107], v[44:47], v[236:239], v[104:107]
    s_waitcnt lgkmcnt(4)
    ds_read_b64_tr_b16 v[44:45], v14 offset:40960
    v_permlane16_swap_b32 v227, v231
    v_mfma_f32_16x16x32_bf16 v[100:103], v[48:51], v[232:235], v[100:103]
    ds_read_b64_tr_b16 v[46:47], v14 offset:41472
    v_mfma_f32_16x16x32_bf16 v[108:111], v[48:51], v[236:239], v[108:111]
    s_waitcnt lgkmcnt(4)
    ds_read_b64_tr_b16 v[48:49], v15 offset:40960
    v_permlane16_swap_b32 v232, v236
    v_mfma_f32_16x16x32_bf16 v[80:83], v[36:39], v[240:243], v[80:83]
    ds_read_b64_tr_b16 v[50:51], v15 offset:41472
    buffer_load_dwordx4 v25, s[32:35], s85 offen offset:2048 lds
    v_mfma_f32_16x16x32_bf16 v[88:91], v[36:39], v[244:247], v[88:91]
    s_waitcnt lgkmcnt(4)
    ds_read_b64_tr_b16 v[36:37], v20 offset:45056
    v_permlane16_swap_b32 v233, v237
    v_mfma_f32_16x16x32_bf16 v[84:87], v[40:43], v[240:243], v[84:87]
    ds_read_b64_tr_b16 v[38:39], v20 offset:45568
    v_permlane16_swap_b32 v234, v238
    v_mfma_f32_16x16x32_bf16 v[92:95], v[40:43], v[244:247], v[92:95]
    s_waitcnt lgkmcnt(4)
    ds_read_b64_tr_b16 v[40:41], v21 offset:45056
    s_waitcnt vmcnt(11)
    ds_read_b128 a[80:83], v27 offset:0
    ds_read_b128 a[84:87], v27 offset:2048
    v_mfma_f32_16x16x32_bf16 v[96:99], v[44:47], v[240:243], v[96:99]
    ds_read_b64_tr_b16 v[42:43], v21 offset:45568
    ds_read_b128 a[88:91], v28 offset:0
    ds_read_b128 a[92:95], v28 offset:2048
    v_mfma_f32_16x16x32_bf16 v[104:107], v[44:47], v[244:247], v[104:107]
    s_waitcnt lgkmcnt(8)
    ds_read_b64_tr_b16 v[44:45], v14 offset:45056
    buffer_load_dwordx4 v26, s[32:35], s85 offen offset:3072 lds
    s_mul_i32 s49, s60, 96
    s_add_u32 m0, s71, 79872
    v_mfma_f32_16x16x32_bf16 v[100:103], v[48:51], v[240:243], v[100:103]
    ds_read_b64_tr_b16 v[46:47], v14 offset:45568
    v_permlane16_swap_b32 v235, v239
    v_mfma_f32_16x16x32_bf16 v[108:111], v[48:51], v[244:247], v[108:111]
    s_waitcnt lgkmcnt(8)
    ds_read_b64_tr_b16 v[48:49], v15 offset:45056
    v_permlane16_swap_b32 v240, v244
    v_mfma_f32_16x16x32_bf16 v[80:83], v[36:39], v[248:251], v[80:83]
    ds_read_b64_tr_b16 v[50:51], v15 offset:45568
    buffer_load_dwordx4 v19, s[16:19], s49 offen offset:2048 sc1 lds
    s_mul_i32 s49, s61, 96
    s_add_u32 m0, s71, 83968
    v_mfma_f32_16x16x32_bf16 v[88:91], v[36:39], v[252:255], v[88:91]
    s_waitcnt lgkmcnt(6)
    v_permlane16_swap_b32 v241, v245
    v_permlane16_swap_b32 v242, v246
    v_mfma_f32_16x16x32_bf16 v[84:87], v[40:43], v[248:251], v[84:87]
    v_permlane16_swap_b32 v243, v247
    v_mfma_f32_16x16x32_bf16 v[92:95], v[40:43], v[252:255], v[92:95]
    s_waitcnt lgkmcnt(2)
    v_mfma_f32_16x16x32_bf16 v[96:99], v[44:47], v[248:251], v[96:99]
    buffer_load_dwordx4 v19, s[16:19], s49 offen offset:2048 sc1 lds
    s_mul_i32 s49, s62, 96
    s_add_u32 m0, s71, 88064
    v_mfma_f32_16x16x32_bf16 v[104:107], v[44:47], v[252:255], v[104:107]
    s_waitcnt lgkmcnt(0)
    v_mfma_f32_16x16x32_bf16 v[100:103], v[48:51], v[248:251], v[100:103]
    v_mfma_f32_16x16x32_bf16 v[108:111], v[48:51], v[252:255], v[108:111]
    s_barrier
    v_min3_u32 v36, v55, v59, v63
    buffer_load_dwordx4 v19, s[16:19], s49 offen offset:2048 sc1 lds
    s_mul_i32 s49, s56, 96
    s_add_u32 m0, s75, 94208
    s_nop 0
    buffer_load_dwordx4 v19, s[16:19], s49 offen sc1 lds
    v_max3_u32 v37, v55, v59, v63
    s_waitcnt vmcnt(12)
    ds_read_b128 a[96:99], v27 offset:4096
    ds_read_b128 a[100:103], v27 offset:6144
    ds_read_b128 a[104:107], v28 offset:4096
    ds_read_b128 a[108:111], v28 offset:6144
    v_min3_u32 v36, v36, v67, v71
    v_max3_u32 v37, v37, v67, v71
    buffer_load_dwordx4 v19, s[16:19], s49 offen offset:1024 sc1 lds
    v_min3_u32 v36, v36, v75, v79
    v_max3_u32 v37, v37, v75, v79
    v_xor_b32 v36, s52, v36
    v_xor_b32 v37, s52, v37
    v_or_b32 v36, v36, v37
    v_cmp_ne_u32 s[54:55], 0, v36
    s_nop 0
    s_cmp_eq_u64 s[54:55], 0
    s_cbranch_scc0 Lslow_5
Lback_6:
    s_nop 0
    s_mul_i32 s49, s57, 96
    s_add_u32 m0, s75, 102400
    s_nop 0
    buffer_load_dwordx4 v19, s[16:19], s49 offen sc1 lds
    v_pk_add_f32 v[52:53], v[52:53], v[56:57]
    v_pk_add_f32 v[52:53], v[52:53], v[60:61]
    v_pk_add_f32 v[52:53], v[52:53], v[64:65]
    v_pk_add_f32 v[52:53], v[52:53], v[68:69]
    v_pk_add_f32 v[52:53], v[52:53], v[72:73]
    v_pk_add_f32 v[52:53], v[52:53], v[76:77]
    s_nop 1
    v_permlane32_swap_b32 v52, v53
    v_add_f32 v52, v52, v53
    v_mul_f32 v52, 0x3a924925, v52
    buffer_load_dwordx4 v19, s[16:19], s49 offen offset:1024 sc1 lds
    v_mov_b32 v54, v52
    s_nop 1
    v_permlane32_swap_b32 v52, v54
    v_fma_f32 v54, -v52, v52, v54
    v_max_f32 v54, 0, v54
    v_add_f32 v54, 0x3727c5ac, v54
    v_rsq_f32 v54, v54
    s_nop 0
    v_mul_f32_e64 v55, -v52, v54
    v_mov_b32 v56, v54
    s_mul_i32 s49, s58, 96
    s_add_u32 m0, s75, 110592
    s_nop 0
    buffer_load_dwordx4 v19, s[16:19], s49 offen sc1 lds
    v_mov_b32 v57, v55
    v_permlane16_swap_b32 v54, v56
    s_nop 0
    v_permlane16_swap_b32 v55, v57
    v_pk_fma_f32 v[112:113], v[112:113], v[54:55], v[54:55] op_sel:[0,0,1] op_sel_hi:[1,0,1]
    v_pk_fma_f32 v[114:115], v[114:115], v[54:55], v[54:55] op_sel:[0,0,1] op_sel_hi:[1,0,1]
    v_pk_fma_f32 v[116:117], v[116:117], v[54:55], v[54:55] op_sel:[0,0,1] op_sel_hi:[1,0,1]
    v_pk_fma_f32 v[118:119], v[118:119], v[54:55], v[54:55] op_sel:[0,0,1] op_sel_hi:[1,0,1]
    v_cvt_pk_bf16_f32 v112, v112, v113
    v_cvt_pk_bf16_f32 v113, v114, v115
    buffer_load_dwordx4 v19, s[16:19], s49 offen offset:1024 sc1 lds
    v_cvt_pk_bf16_f32 v114, v116, v117
    v_cvt_pk_bf16_f32 v115, v118, v119
    ds_write_b128 v18, v[112:115] offset:0
    v_pk_fma_f32 v[120:121], v[120:121], v[56:57], v[56:57] op_sel:[0,0,1] op_sel_hi:[1,0,1]
    v_pk_fma_f32 v[122:123], v[122:123], v[56:57], v[56:57] op_sel:[0,0,1] op_sel_hi:[1,0,1]
    v_pk_fma_f32 v[124:125], v[124:125], v[56:57], v[56:57] op_sel:[0,0,1] op_sel_hi:[1,0,1]
    v_pk_fma_f32 v[126:127], v[126:127], v[56:57], v[56:57] op_sel:[0,0,1] op_sel_hi:[1,0,1]
    v_cvt_pk_bf16_f32 v120, v120, v121
    s_mul_i32 s49, s59, 96
    s_add_u32 m0, s75, 118784
    s_nop 0
    buffer_load_dwordx4 v19, s[16:19], s49 offen sc1 lds
    v_cvt_pk_bf16_f32 v121, v122, v123
    v_cvt_pk_bf16_f32 v122, v124, v125
    v_cvt_pk_bf16_f32 v123, v126, v127
    ds_write_b128 v18, v[120:123] offset:2304
    ds_read_b64_tr_b16 v[60:61], v17 offset:0
    ds_read_b64_tr_b16 v[62:63], v17 offset:576
    buffer_load_dwordx4 v19, s[16:19], s49 offen offset:1024 sc1 lds
    ds_read_b64_tr_b16 v[64:65], v17 offset:8
    ds_read_b64_tr_b16 v[66:67], v17 offset:584
    v_pk_fma_f32 v[128:129], v[128:129], v[54:55], v[54:55] op_sel:[0,0,1] op_sel_hi:[1,0,1]
    v_pk_fma_f32 v[130:131], v[130:131], v[54:55], v[54:55] op_sel:[0,0,1] op_sel_hi:[1,0,1]
    v_pk_fma_f32 v[132:133], v[132:133], v[54:55], v[54:55] op_sel:[0,0,1] op_sel_hi:[1,0,1]
    v_pk_fma_f32 v[134:135], v[134:135], v[54:55], v[54:55] op_sel:[0,0,1] op_sel_hi:[1,0,1]
    v_cvt_pk_bf16_f32 v128, v128, v129
    v_cvt_pk_bf16_f32 v129, v130, v131
    v_cvt_pk_bf16_f32 v130, v132, v133
    v_cvt_pk_bf16_f32 v131, v134, v135
    buffer_load_dwordx4 v[8:11], v4, s[16:19], s77 offen offset:0 sc1
    ds_write_b128 v18, v[128:131] offset:64
    s_waitcnt vmcnt(12)
    ds_read_b128 a[112:115], v27 offset:8192
    ds_read_b128 a[116:119], v27 offset:10240
    ds_read_b128 a[120:123], v28 offset:8192
    ds_read_b128 a[124:127], v28 offset:10240
    v_pk_fma_f32 v[136:137], v[136:137], v[56:57], v[56:57] op_sel:[0,0,1] op_sel_hi:[1,0,1]
    buffer_load_dwordx4 v[12:15], v4, s[16:19], s77 offen offset:1024 sc1
    v_pk_fma_f32 v[138:139], v[138:139], v[56:57], v[56:57] op_sel:[0,0,1] op_sel_hi:[1,0,1]
    v_pk_fma_f32 v[140:141], v[140:141], v[56:57], v[56:57] op_sel:[0,0,1] op_sel_hi:[1,0,1]
    v_pk_fma_f32 v[142:143], v[142:143], v[56:57], v[56:57] op_sel:[0,0,1] op_sel_hi:[1,0,1]
    v_cvt_pk_bf16_f32 v136, v136, v137
    v_cvt_pk_bf16_f32 v137, v138, v139
    v_cvt_pk_bf16_f32 v138, v140, v141
    s_add_u32 s85, s85, 128
    s_and_b32 s85, s85, 2047
    s_add_u32 m0, s51, 12288
    s_nop 0
    buffer_load_dwordx4 v23, s[32:35], s85 offen lds
    v_cvt_pk_bf16_f32 v139, v142, v143
    ds_write_b128 v18, v[136:139] offset:2368
    ds_read_b64_tr_b16 v[68:69], v17 offset:64
    ds_read_b64_tr_b16 v[70:71], v17 offset:640
    ds_read_b64_tr_b16 v[72:73], v17 offset:72
    buffer_load_dwordx4 v24, s[32:35], s85 offen offset:1024 lds
    ds_read_b64_tr_b16 v[74:75], v17 offset:648
    s_waitcnt lgkmcnt(12)
    buffer_store_dwordx4 v[60:63], v4, s[16:19], s45 offen offset:0 sc1
    s_waitcnt lgkmcnt(10)
    buffer_store_dwordx4 v[64:67], v4, s[16:19], s45 offen offset:1024 sc1
    s_waitcnt lgkmcnt(2)
    buffer_store_dwordx4 v[68:71], v4, s[16:19], s45 offen offset:2048 sc1
    s_waitcnt lgkmcnt(0)
    buffer_store_dwordx4 v[72:75], v4, s[16:19], s45 offen offset:3072 sc1
    s_barrier
    ds_read_b128 v[36:39], v22 offset:0
    ds_read_b128 v[40:43], v22 offset:1024
    ds_read_b128 v[44:47], v22 offset:2048
    ds_read_b128 v[48:51], v22 offset:3072
    v_permlane16_swap_b32 v248, v252
    v_permlane16_swap_b32 v249, v253
    v_permlane16_swap_b32 v250, v254
    v_permlane16_swap_b32 v251, v255
    s_lshl_b32 s88, s38, 12
    s_lshl_b32 s89, s36, 10
    s_add_u32 s88, s88, s89
    s_lshl_b32 s89, s39, 7
    s_add_u32 s88, s88, s89
    s_add_u32 s88, s88, 8192
    v_and_b32 v30, 15, v0
    buffer_load_dwordx4 v25, s[32:35], s85 offen offset:2048 lds
    s_waitcnt lgkmcnt(3)
    v_mfma_f32_32x32x16_bf16 v[128:143], v[36:39], v[144:147], 0
    s_waitcnt lgkmcnt(2)
    ds_read_b128 v[36:39], v22 offset:4096
    v_lshl_add_u32 v30, v30, 2, s88
    s_mul_i32 s88, s38, 1835008
    s_mul_i32 s89, s36, 57344
    s_add_u32 s88, s88, s89
    s_lshl_b32 s89, s74, 12
    v_mfma_f32_32x32x16_bf16 v[128:143], v[40:43], v[148:151], v[128:143]
    s_waitcnt lgkmcnt(2)
    ds_read_b128 v[40:43], v22 offset:5120
    s_add_u32 s88, s88, s89
    buffer_load_dwordx4 v26, s[32:35], s85 offen offset:3072 lds
    s_add_u32 s85, s85, 128
    s_and_b32 s85, s85, 2047
    s_add_u32 m0, s51, 0
    v_mfma_f32_32x32x16_bf16 v[128:143], v[44:47], v[152:155], v[128:143]
    s_waitcnt lgkmcnt(2)
    ds_read_b128 v[44:47], v22 offset:6144
    s_add_u32 s88, s88, 11403264
    v_add_u32 v7, s88, v4
    s_mul_i32 s88, s38, 1835008
    s_mul_i32 s89, s36, 57344
    s_add_u32 s88, s88, s89
    v_mfma_f32_32x32x16_bf16 v[128:143], v[48:51], v[156:159], v[128:143]
    s_waitcnt lgkmcnt(2)
    ds_read_b128 v[48:51], v22 offset:7168
    buffer_load_dwordx4 v23, s[32:35], s85 offen lds
    s_lshl_b32 s89, s41, 12
    s_add_u32 s88, s88, s89
    s_add_u32 s88, s88, 11403264
    v_add_u32 v20, s88, v4
    v_mfma_f32_32x32x16_bf16 v[128:143], v[36:39], v[160:163], v[128:143]
    s_waitcnt lgkmcnt(2)
    ds_read_b128 v[36:39], v22 offset:8192
    v_add_u32 v21, 131072, v4
    v_mov_b32 v34, s64
    v_mul_f32 v60, v80, v80
    v_mul_f32 v61, v81, v81
    v_mul_f32 v62, v82, v82
    v_mfma_f32_32x32x16_bf16 v[128:143], v[40:43], v[164:167], v[128:143]
    s_waitcnt lgkmcnt(2)
    ds_read_b128 v[40:43], v22 offset:9216
    buffer_load_dwordx4 v24, s[32:35], s85 offen offset:1024 lds
    v_mul_f32 v63, v83, v83
    v_fma_f32 v60, v60, s65, v34
    v_mfma_f32_32x32x16_bf16 v[128:143], v[44:47], v[168:171], v[128:143]
    s_waitcnt lgkmcnt(2)
    ds_read_b128 v[44:47], v22 offset:10240
    v_fma_f32 v61, v61, s65, v34
    v_fma_f32 v62, v62, s65, v34
    v_fma_f32 v63, v63, s65, v34
    v_mul_f32 v60, v60, v80
    v_mul_f32 v61, v61, v81
    v_mfma_f32_32x32x16_bf16 v[128:143], v[48:51], v[172:175], v[128:143]
    s_waitcnt lgkmcnt(2)
    ds_read_b128 v[48:51], v22 offset:11264
    buffer_load_dwordx4 v25, s[32:35], s85 offen offset:2048 lds
    v_mul_f32 v62, v62, v82
    v_mul_f32 v63, v63, v83
    v_mfma_f32_32x32x16_bf16 v[128:143], v[36:39], v[176:179], v[128:143]
    s_waitcnt lgkmcnt(2)
    ds_read_b128 v[36:39], v22 offset:12288
    v_exp_f32 v60, v60
    v_exp_f32 v61, v61
    v_mfma_f32_32x32x16_bf16 v[128:143], v[40:43], v[180:183], v[128:143]
    s_waitcnt lgkmcnt(2)
    ds_read_b128 v[40:43], v22 offset:13312
    buffer_load_dwordx4 v26, s[32:35], s85 offen offset:3072 lds
    s_add_u32 s85, s85, 128
    s_and_b32 s85, s85, 2047
    s_add_u32 m0, s51, 4096
    v_mfma_f32_32x32x16_bf16 v[128:143], v[44:47], v[184:187], v[128:143]
    s_waitcnt lgkmcnt(2)
    ds_read_b128 v[44:47], v22 offset:14336
    v_exp_f32 v62, v62
    v_exp_f32 v63, v63
    v_add_f32 v60, 1.0, v60
    v_mfma_f32_32x32x16_bf16 v[128:143], v[48:51], v[188:191], v[128:143]
    s_waitcnt lgkmcnt(2)
    ds_read_b128 v[48:51], v22 offset:15360
    buffer_load_dwordx4 v23, s[32:35], s85 offen lds
    v_add_f32 v61, 1.0, v61
    v_add_f32 v62, 1.0, v62
    v_mfma_f32_32x32x16_bf16 v[128:143], v[36:39], v[192:195], v[128:143]
    s_waitcnt lgkmcnt(2)
    s_waitcnt vmcnt(23)
    s_barrier
    ds_read_b128 v[36:39], v22 offset:16384
    buffer_load_dwordx4 v24, s[32:35], s85 offen offset:1024 lds
    v_mfma_f32_32x32x16_bf16 v[128:143], v[40:43], v[196:199], v[128:143]
    s_waitcnt lgkmcnt(2)
    ds_read_b128 v[40:43], v22 offset:17408
    v_add_f32 v63, 1.0, v63
    v_rcp_f32 v60, v60
    v_rcp_f32 v61, v61
    v_mfma_f32_32x32x16_bf16 v[128:143], v[44:47], v[200:203], v[128:143]
    s_waitcnt lgkmcnt(2)
    ds_read_b128 v[44:47], v22 offset:18432
    v_rcp_f32 v62, v62
    v_rcp_f32 v63, v63
    v_mul_f32 v80, v80, v60
    v_mfma_f32_32x32x16_bf16 v[128:143], v[48:51], v[204:207], v[128:143]
    s_waitcnt lgkmcnt(2)
    ds_read_b128 v[48:51], v22 offset:19456
    buffer_load_dwordx4 v25, s[32:35], s85 offen offset:2048 lds
    v_mul_f32 v81, v81, v61
    v_mul_f32 v82, v82, v62
    v_mfma_f32_32x32x16_bf16 v[128:143], v[36:39], v[208:211], v[128:143]
    s_waitcnt lgkmcnt(2)
    ds_read_b128 v[36:39], v22 offset:20480
    v_mul_f32 v83, v83, v63
    v_mul_f32 v60, v84, v84
    v_mul_f32 v61, v85, v85
    v_mul_f32 v62, v86, v86
    v_mul_f32 v63, v87, v87
    v_mfma_f32_32x32x16_bf16 v[128:143], v[40:43], v[212:215], v[128:143]
    s_waitcnt lgkmcnt(2)
    ds_read_b128 v[40:43], v22 offset:21504
    v_fma_f32 v60, v60, s65, v34
    v_fma_f32 v61, v61, s65, v34
    v_fma_f32 v62, v62, s65, v34
    v_fma_f32 v63, v63, s65, v34
    v_mul_f32 v60, v60, v84
    v_mfma_f32_32x32x16_bf16 v[128:143], v[44:47], v[216:219], v[128:143]
    s_waitcnt lgkmcnt(2)
    ds_read_b128 v[44:47], v22 offset:22528
    v_mul_f32 v61, v61, v85
    v_mul_f32 v62, v62, v86
    v_mul_f32 v63, v63, v87
    v_exp_f32 v60, v60
    v_mfma_f32_32x32x16_bf16 v[128:143], v[48:51], v[220:223], v[128:143]
    s_waitcnt lgkmcnt(2)
    ds_read_b128 v[48:51], v22 offset:23552
    buffer_load_dwordx4 v26, s[32:35], s85 offen offset:3072 lds
    s_add_u32 s85, s85, 128
    s_and_b32 s85, s85, 2047
    s_add_u32 m0, s51, 8192
    v_mfma_f32_32x32x16_bf16 v[128:143], v[36:39], v[224:227], v[128:143]
    s_waitcnt lgkmcnt(2)
    ds_read_b128 v[36:39], v22 offset:24576
    v_exp_f32 v61, v61
    v_exp_f32 v62, v62
    v_mfma_f32_32x32x16_bf16 v[128:143], v[40:43], v[228:231], v[128:143]
    s_waitcnt lgkmcnt(2)
    ds_read_b128 v[40:43], v22 offset:25600
    buffer_load_dwordx4 v23, s[32:35], s85 offen lds
    v_exp_f32 v63, v63
    v_mfma_f32_32x32x16_bf16 v[128:143], v[44:47], v[232:235], v[128:143]
    s_waitcnt lgkmcnt(2)
    ds_read_b128 v[44:47], v22 offset:26624
    v_add_f32 v60, 1.0, v60
    v_add_f32 v61, 1.0, v61
    v_add_f32 v62, 1.0, v62
    v_add_f32 v63, 1.0, v63
    v_mfma_f32_32x32x16_bf16 v[128:143], v[48:51], v[236:239], v[128:143]
    s_waitcnt lgkmcnt(2)
    ds_read_b128 v[48:51], v22 offset:27648
    buffer_load_dwordx4 v24, s[32:35], s85 offen offset:1024 lds
    v_rcp_f32 v60, v60
    v_mfma_f32_32x32x16_bf16 v[128:143], v[36:39], v[240:243], v[128:143]
    s_waitcnt lgkmcnt(2)
    s_waitcnt vmcnt(24)
    s_barrier
    ds_read_b128 v[36:39], v22 offset:28672
    buffer_load_dwordx4 v25, s[32:35], s85 offen offset:2048 lds
    v_mfma_f32_32x32x16_bf16 v[128:143], v[40:43], v[244:247], v[128:143]
    s_waitcnt lgkmcnt(2)
    ds_read_b128 v[40:43], v22 offset:29696
    v_rcp_f32 v61, v61
    v_rcp_f32 v62, v62
    v_mfma_f32_32x32x16_bf16 v[128:143], v[44:47], v[248:251], v[128:143]
    s_waitcnt lgkmcnt(2)
    ds_read_b128 v[44:47], v22 offset:30720
    v_rcp_f32 v63, v63
    v_mul_f32 v84, v84, v60
    v_mul_f32 v85, v85, v61
    v_mul_f32 v86, v86, v62
    v_mfma_f32_32x32x16_bf16 v[128:143], v[48:51], v[252:255], v[128:143]
    s_waitcnt lgkmcnt(2)
    ds_read_b128 v[48:51], v22 offset:31744
    buffer_load_dwordx4 v26, s[32:35], s85 offen offset:3072 lds
    s_mul_i32 s49, s60, 96
    s_add_u32 m0, s75, 65536
    v_mul_f32 v87, v87, v63
    v_mfma_f32_32x32x16_bf16 v[64:79], v[144:147], v[36:39], 0
    s_waitcnt lgkmcnt(2)
    ds_read_b128 v[36:39], v22 offset:32768
    v_mfma_f32_32x32x16_bf16 v[112:127], v[40:43], v[144:147], 0
    s_waitcnt lgkmcnt(2)
    ds_read_b128 v[40:43], v22 offset:33792
    buffer_load_dwordx4 v19, s[16:19], s49 offen sc1 lds
    v_cvt_pk_bf16_f32 v52, v128, v129
    v_cvt_pk_bf16_f32 v53, v130, v131
    v_mfma_f32_32x32x16_bf16 v[64:79], v[148:151], v[44:47], v[64:79]
    s_waitcnt lgkmcnt(2)
    ds_read_b128 v[44:47], v22 offset:34816
    v_cvt_pk_bf16_f32 v54, v132, v133
    v_cvt_pk_bf16_f32 v55, v134, v135
    v_cvt_pk_bf16_f32 v56, v136, v137
    v_cvt_pk_bf16_f32 v57, v138, v139
    v_cvt_pk_bf16_f32 v58, v140, v141
    v_mfma_f32_32x32x16_bf16 v[112:127], v[48:51], v[148:151], v[112:127]
    s_waitcnt lgkmcnt(2)
    ds_read_b128 v[48:51], v22 offset:35840
    buffer_load_dwordx4 v19, s[16:19], s49 offen offset:1024 sc1 lds
    s_mul_i32 s49, s61, 96
    s_add_u32 m0, s75, 73728
    v_cvt_pk_bf16_f32 v59, v142, v143
    s_waitcnt vmcnt(23)
    v_mfma_f32_32x32x16_bf16 v[128:143], v[8:11], v[52:55], 0
    s_waitcnt vmcnt(22)
    v_mfma_f32_32x32x16_bf16 v[128:143], v[12:15], v[56:59], v[128:143]
    v_mfma_f32_32x32x16_bf16 v[64:79], v[152:155], v[36:39], v[64:79]
    s_waitcnt lgkmcnt(2)
    ds_read_b128 v[36:39], v22 offset:36864
    buffer_load_dwordx4 v19, s[16:19], s49 offen sc1 lds
    v_mfma_f32_32x32x16_bf16 v[112:127], v[40:43], v[152:155], v[112:127]
    s_waitcnt lgkmcnt(2)
    ds_read_b128 v[40:43], v22 offset:37888
    v_mfma_f32_32x32x16_bf16 v[64:79], v[156:159], v[44:47], v[64:79]
    s_waitcnt lgkmcnt(2)
    ds_read_b128 v[44:47], v22 offset:38912
    buffer_load_dwordx4 v19, s[16:19], s49 offen offset:1024 sc1 lds
    v_mfma_f32_32x32x16_bf16 v[112:127], v[48:51], v[156:159], v[112:127]
    s_waitcnt lgkmcnt(2)
    ds_read_b128 v[48:51], v22 offset:39936
    v_max3_f32 v60, v128, v129, v130
    v_max3_f32 v62, -v128, -v129, -v130
    v_max3_f32 v60, v60, v131, v132
    v_max3_f32 v62, v62, -v131, -v132
    v_max3_f32 v60, v60, v133, v134
    v_mfma_f32_32x32x16_bf16 v[64:79], v[160:163], v[36:39], v[64:79]
    s_waitcnt lgkmcnt(2)
    ds_read_b128 v[36:39], v22 offset:40960
    v_max3_f32 v62, v62, -v133, -v134
    v_max3_f32 v60, v60, v135, v136
    v_max3_f32 v62, v62, -v135, -v136
    v_max3_f32 v60, v60, v137, v138
    v_max3_f32 v62, v62, -v137, -v138
    v_mfma_f32_32x32x16_bf16 v[112:127], v[40:43], v[160:163], v[112:127]
    s_waitcnt lgkmcnt(2)
    ds_read_b128 v[40:43], v22 offset:41984
    v_max3_f32 v60, v60, v139, v140
    v_max3_f32 v62, v62, -v139, -v140
    v_max3_f32 v60, v60, v141, v141
    v_max3_f32 v62, v62, -v141, -v141
    v_mfma_f32_32x32x16_bf16 v[64:79], v[164:167], v[44:47], v[64:79]
    s_waitcnt lgkmcnt(2)
    ds_read_b128 v[44:47], v22 offset:43008
    v_permlane32_swap_b32 v60, v62
    v_max_f32 v60, v60, v62
    v_mul_f32 v60, s67, v60
    v_mov_b32 v62, v60
    v_mfma_f32_32x32x16_bf16 v[112:127], v[48:51], v[164:167], v[112:127]
    s_waitcnt lgkmcnt(2)
    ds_read_b128 v[48:51], v22 offset:44032
    v_permlane32_swap_b32 v60, v62
    v_fma_f32 v144, v128, s67, v62
    v_fma_f32 v128, v128, s66, v60
    v_fma_f32 v145, v129, s67, v62
    v_fma_f32 v129, v129, s66, v60
    v_mfma_f32_32x32x16_bf16 v[64:79], v[168:171], v[36:39], v[64:79]
    s_waitcnt lgkmcnt(2)
    s_barrier
    ds_read_b128 v[36:39], v22 offset:45056
    s_mul_i32 s49, s62, 96
    v_mfma_f32_32x32x16_bf16 v[112:127], v[40:43], v[168:171], v[112:127]
    s_waitcnt lgkmcnt(2)
    ds_read_b128 v[40:43], v22 offset:46080
    s_add_u32 m0, s75, 81920
    s_nop 0
    buffer_load_dwordx4 v19, s[16:19], s49 offen sc1 lds
    v_mfma_f32_32x32x16_bf16 v[64:79], v[172:175], v[44:47], v[64:79]
    s_waitcnt lgkmcnt(2)
    ds_read_b128 v[44:47], v22 offset:47104
    v_fma_f32 v146, v130, s67, v62
    v_fma_f32 v130, v130, s66, v60
    v_fma_f32 v147, v131, s67, v62
    v_fma_f32 v131, v131, s66, v60
    v_fma_f32 v148, v132, s67, v62
    v_mfma_f32_32x32x16_bf16 v[112:127], v[48:51], v[172:175], v[112:127]
    s_waitcnt lgkmcnt(2)
    ds_read_b128 v[48:51], v22 offset:48128
    buffer_load_dwordx4 v19, s[16:19], s49 offen offset:1024 sc1 lds
    v_fma_f32 v132, v132, s66, v60
    v_fma_f32 v149, v133, s67, v62
    v_mfma_f32_32x32x16_bf16 v[64:79], v[176:179], v[36:39], v[64:79]
    s_waitcnt lgkmcnt(2)
    ds_read_b128 v[36:39], v22 offset:49152
    v_fma_f32 v133, v133, s66, v60
    v_fma_f32 v150, v134, s67, v62
    v_fma_f32 v134, v134, s66, v60
    v_fma_f32 v151, v135, s67, v62
    v_fma_f32 v135, v135, s66, v60
    v_mfma_f32_32x32x16_bf16 v[112:127], v[40:43], v[176:179], v[112:127]
    s_waitcnt lgkmcnt(2)
    ds_read_b128 v[40:43], v22 offset:50176
    v_bfe_u32 v176, v0, 2, 3
    v_lshrrev_b32 v178, 5, v0
    v_lshl_add_u32 v176, v178, 4, v176
    v_mul_u32_u24 v176, 144, v176
    v_and_b32 v35, 15, v0
    v_mfma_f32_32x32x16_bf16 v[64:79], v[180:183], v[44:47], v[64:79]
    s_waitcnt lgkmcnt(2)
    ds_read_b128 v[44:47], v22 offset:51200
    v_lshlrev_b32 v35, 4, v35
    v_lshl_add_u32 v35, v3, 9, v35
    v_and_b32 v178, 1, v0
    v_lshl_add_u32 v176, v178, 5, v176
    v_bfe_u32 v178, v0, 1, 1
    v_mfma_f32_32x32x16_bf16 v[112:127], v[48:51], v[180:183], v[112:127]
    s_waitcnt lgkmcnt(2)
    ds_read_b128 v[48:51], v22 offset:52224
    v_lshl_add_u32 v176, v178, 3, v176
    s_lshr_b32 s45, s36, 1
    s_and_b32 s47, s36, 1
    s_lshl_b32 s45, s45, 6
    s_lshl_b32 s46, s47, 4
    v_mfma_f32_32x32x16_bf16 v[64:79], v[184:187], v[36:39], v[64:79]
    s_waitcnt lgkmcnt(2)
    ds_read_b128 v[36:39], v22 offset:53248
    s_add_u32 s45, s45, s46
    s_add_u32 s45, s45, 131072
    v_add_u32 v176, s45, v176
    v_add_u32 v177, s79, v4
    v_add_u32 v178, 136192, v35
    v_mfma_f32_32x32x16_bf16 v[112:127], v[40:43], v[184:187], v[112:127]
    s_waitcnt lgkmcnt(2)
    ds_read_b128 v[40:43], v22 offset:54272
    v_mov_b32 v179, 0x3f803f80
    s_mov_b32 s70, 0x10000000
    s_mov_b32 s71, 0x10000000
    s_mul_i32 s45, s40, 133120
    s_mul_i32 s46, s37, 8320
    v_mfma_f32_32x32x16_bf16 v[64:79], v[188:191], v[44:47], v[64:79]
    s_waitcnt lgkmcnt(2)
    ds_read_b128 v[44:47], v22 offset:55296
    s_add_u32 s45, s45, s46
    s_lshl_b32 s46, s36, 11
    s_add_u32 s45, s45, s46
    s_add_u32 s45, s45, 2621440
    s_waitcnt vmcnt(20)
    s_buffer_atomic_swap s52, s[16:19], s90
    v_mfma_f32_32x32x16_bf16 v[112:127], v[48:51], v[188:191], v[112:127]
    s_waitcnt lgkmcnt(2)
    ds_read_b128 v[48:51], v22 offset:56320
    v_fma_f32 v152, v136, s67, v62
    v_fma_f32 v136, v136, s66, v60
    v_mfma_f32_32x32x16_bf16 v[64:79], v[192:195], v[36:39], v[64:79]
    s_waitcnt lgkmcnt(2)
    ds_read_b128 v[36:39], v22 offset:57344
    s_waitcnt vmcnt(18)
    ds_read_b128 a[128:131], v27 offset:12288
    ds_read_b128 a[132:135], v27 offset:14336
    v_mfma_f32_32x32x16_bf16 v[112:127], v[40:43], v[192:195], v[112:127]
    s_waitcnt lgkmcnt(4)
    ds_read_b128 v[40:43], v22 offset:58368
    ds_read_b128 a[136:139], v28 offset:12288
    v_mfma_f32_32x32x16_bf16 v[64:79], v[196:199], v[44:47], v[64:79]
    s_waitcnt lgkmcnt(5)
    ds_read_b128 v[44:47], v22 offset:59392
    ds_read_b128 a[140:143], v28 offset:14336
    s_waitcnt vmcnt(14)
    ds_read_b128 a[144:147], v27 offset:0
    v_mfma_f32_32x32x16_bf16 v[112:127], v[48:51], v[196:199], v[112:127]
    s_waitcnt lgkmcnt(7)
    ds_read_b128 v[48:51], v22 offset:60416
    ds_read_b128 a[148:151], v27 offset:2048
    ds_read_b128 a[152:155], v28 offset:0
    ds_read_b128 a[156:159], v28 offset:2048
    v_mfma_f32_32x32x16_bf16 v[64:79], v[200:203], v[36:39], v[64:79]
    s_waitcnt lgkmcnt(8)
    s_waitcnt vmcnt(4)
    s_barrier
    ds_read_b128 v[36:39], v22 offset:0
    ds_read_b128 a[160:163], v27 offset:4096
    ds_read_b128 a[164:167], v27 offset:6144
    ds_read_b128 a[168:171], v28 offset:4096
    ds_read_b128 a[172:175], v28 offset:6144
    v_mfma_f32_32x32x16_bf16 v[112:127], v[40:43], v[200:203], v[112:127]
    s_waitcnt lgkmcnt(11)
    ds_read_b128 v[40:43], v22 offset:1024
    ds_read_b128 a[176:179], v27 offset:8192
    ds_read_b128 a[180:183], v27 offset:10240
    v_mfma_f32_32x32x16_bf16 v[64:79], v[204:207], v[44:47], v[64:79]
    s_waitcnt lgkmcnt(11)
    ds_read_b128 v[44:47], v22 offset:2048
    ds_read_b128 a[184:187], v28 offset:8192
    ds_read_b128 a[188:191], v28 offset:10240
    v_mfma_f32_32x32x16_bf16 v[112:127], v[48:51], v[204:207], v[112:127]
    s_waitcnt lgkmcnt(10)
    ds_read_b128 v[48:51], v22 offset:3072
    s_add_u32 s85, s85, 128
    s_and_b32 s85, s85, 2047
    s_add_u32 m0, s51, 12288
    s_nop 0
    buffer_load_dwordx4 v23, s[32:35], s85 offen lds
    v_mfma_f32_32x32x16_bf16 v[64:79], v[208:211], v[36:39], v[64:79]
    s_waitcnt lgkmcnt(6)
    ds_read_b128 v[36:39], v22 offset:4096
    v_fma_f32 v153, v137, s67, v62
    v_fma_f32 v137, v137, s66, v60
    v_fma_f32 v154, v138, s67, v62
    v_fma_f32 v138, v138, s66, v60
    v_fma_f32 v155, v139, s67, v62
    v_mfma_f32_32x32x16_bf16 v[112:127], v[40:43], v[208:211], v[112:127]
    s_waitcnt lgkmcnt(4)
    ds_read_b128 v[40:43], v22 offset:5120
    buffer_load_dwordx4 v24, s[32:35], s85 offen offset:1024 lds
    v_mfma_f32_32x32x16_bf16 v[64:79], v[212:215], v[44:47], v[64:79]
    s_waitcnt lgkmcnt(2)
    ds_read_b128 v[44:47], v22 offset:6144
    v_mfma_f32_32x32x16_bf16 v[112:127], v[48:51], v[212:215], v[112:127]
    s_waitcnt lgkmcnt(2)
    ds_read_b128 v[48:51], v22 offset:7168
    buffer_load_dwordx4 v25, s[32:35], s85 offen offset:2048 lds
    v_mfma_f32_32x32x16_bf16 v[64:79], v[216:219], v[36:39], v[64:79]
    s_waitcnt lgkmcnt(2)
    s_waitcnt vmcnt(5)
    s_barrier
    buffer_load_dwordx4 v26, s[32:35], s85 offen offset:3072 lds
    s_add_u32 s85, s85, 128
    s_and_b32 s85, s85, 2047
    s_add_u32 m0, s51, 0
    s_nop 0
    buffer_load_dwordx4 v23, s[32:35], s85 offen lds
    ds_read_b128 v[36:39], v22 offset:8192
    v_mfma_f32_32x32x16_bf16 v[112:127], v[40:43], v[216:219], v[112:127]
    s_waitcnt lgkmcnt(2)
    ds_read_b128 v[40:43], v22 offset:9216
    v_fma_f32 v139, v139, s66, v60
    v_fma_f32 v156, v140, s67, v62
    v_fma_f32 v140, v140, s66, v60
    v_fma_f32 v157, v141, s67, v62
    v_fma_f32 v141, v141, s66, v60
    v_mfma_f32_32x32x16_bf16 v[64:79], v[220:223], v[44:47], v[64:79]
    s_waitcnt lgkmcnt(2)
    ds_read_b128 v[44:47], v22 offset:10240
    buffer_load_dwordx4 v24, s[32:35], s85 offen offset:1024 lds
    v_exp_f32 v128, v128
    v_mfma_f32_32x32x16_bf16 v[112:127], v[48:51], v[220:223], v[112:127]
    s_waitcnt lgkmcnt(2)
    ds_read_b128 v[48:51], v22 offset:11264
    v_exp_f32 v144, v144
    v_exp_f32 v129, v129
    v_mfma_f32_32x32x16_bf16 v[64:79], v[224:227], v[36:39], v[64:79]
    s_waitcnt lgkmcnt(2)
    ds_read_b128 v[36:39], v22 offset:12288
    buffer_load_dwordx4 v25, s[32:35], s85 offen offset:2048 lds
    v_exp_f32 v145, v145
    v_mfma_f32_32x32x16_bf16 v[112:127], v[40:43], v[224:227], v[112:127]
    s_waitcnt lgkmcnt(2)
    ds_read_b128 v[40:43], v22 offset:13312
    v_exp_f32 v130, v130
    v_exp_f32 v146, v146
    v_mfma_f32_32x32x16_bf16 v[64:79], v[228:231], v[44:47], v[64:79]
    s_waitcnt lgkmcnt(2)
    ds_read_b128 v[44:47], v22 offset:14336
    buffer_load_dwordx4 v26, s[32:35], s85 offen offset:3072 lds
    s_add_u32 s85, s85, 128
    s_and_b32 s85, s85, 2047
    s_add_u32 m0, s51, 4096
    v_mfma_f32_32x32x16_bf16 v[112:127], v[48:51], v[228:231], v[112:127]
    s_waitcnt lgkmcnt(2)
    ds_read_b128 v[48:51], v22 offset:15360
    v_exp_f32 v131, v131
    v_exp_f32 v147, v147
    v_mfma_f32_32x32x16_bf16 v[64:79], v[232:235], v[36:39], v[64:79]
    s_waitcnt lgkmcnt(2)
    s_waitcnt vmcnt(8)
    s_barrier
    ds_read_b128 v[36:39], v22 offset:16384
    buffer_load_dwordx4 v23, s[32:35], s85 offen lds
    v_mfma_f32_32x32x16_bf16 v[112:127], v[40:43], v[232:235], v[112:127]
    s_waitcnt lgkmcnt(2)
    ds_read_b128 v[40:43], v22 offset:17408
    v_exp_f32 v132, v132
    v_exp_f32 v148, v148
    v_mfma_f32_32x32x16_bf16 v[64:79], v[236:239], v[44:47], v[64:79]
    s_waitcnt lgkmcnt(2)
    ds_read_b128 v[44:47], v22 offset:18432
    v_exp_f32 v133, v133
    v_exp_f32 v149, v149
    v_mfma_f32_32x32x16_bf16 v[112:127], v[48:51], v[236:239], v[112:127]
    s_waitcnt lgkmcnt(2)
    ds_read_b128 v[48:51], v22 offset:19456
    buffer_load_dwordx4 v24, s[32:35], s85 offen offset:1024 lds
    v_exp_f32 v134, v134
    v_mfma_f32_32x32x16_bf16 v[64:79], v[240:243], v[36:39], v[64:79]
    s_waitcnt lgkmcnt(2)
    ds_read_b128 v[36:39], v22 offset:20480
    v_exp_f32 v150, v150
    v_exp_f32 v135, v135
    v_mfma_f32_32x32x16_bf16 v[112:127], v[40:43], v[240:243], v[112:127]
    s_waitcnt lgkmcnt(2)
    ds_read_b128 v[40:43], v22 offset:21504
    buffer_load_dwordx4 v25, s[32:35], s85 offen offset:2048 lds
    v_exp_f32 v151, v151
    v_mfma_f32_32x32x16_bf16 v[64:79], v[244:247], v[44:47], v[64:79]
    s_waitcnt lgkmcnt(2)
    ds_read_b128 v[44:47], v22 offset:22528
    v_exp_f32 v136, v136
    v_exp_f32 v152, v152
    v_mfma_f32_32x32x16_bf16 v[112:127], v[48:51], v[244:247], v[112:127]
    s_waitcnt lgkmcnt(2)
    ds_read_b128 v[48:51], v22 offset:23552
    buffer_load_dwordx4 v26, s[32:35], s85 offen offset:3072 lds
    s_add_u32 s85, s85, 128
    s_and_b32 s85, s85, 2047
    s_add_u32 m0, s51, 8192
    v_mfma_f32_32x32x16_bf16 v[64:79], v[248:251], v[36:39], v[64:79]
    s_waitcnt lgkmcnt(2)
    v_exp_f32 v137, v137
    v_exp_f32 v153, v153
    v_exp_f32 v138, v138
    v_mfma_f32_32x32x16_bf16 v[112:127], v[40:43], v[248:251], v[112:127]
    s_waitcnt lgkmcnt(1)
    v_exp_f32 v154, v154
    v_exp_f32 v139, v139
    v_exp_f32 v155, v155
    v_mfma_f32_32x32x16_bf16 v[64:79], v[252:255], v[44:47], v[64:79]
    s_waitcnt lgkmcnt(0)
    v_exp_f32 v140, v140
    v_exp_f32 v156, v156
    v_exp_f32 v141, v141
    v_mfma_f32_32x32x16_bf16 v[112:127], v[48:51], v[252:255], v[112:127]
    s_waitcnt vmcnt(8)
    ds_read_b128 a[192:195], v27 offset:12288
    ds_read_b128 a[196:199], v27 offset:14336
    ds_read_b128 a[200:203], v28 offset:12288
    ds_read_b128 a[204:207], v28 offset:14336
    buffer_load_dwordx4 v23, s[32:35], s85 offen lds
    buffer_load_dwordx4 v24, s[32:35], s85 offen offset:1024 lds
    buffer_load_dwordx4 v25, s[32:35], s85 offen offset:2048 lds
    v_exp_f32 v157, v157
    v_add_f32 v60, v128, v129
    v_add_f32 v62, v144, v145
    v_add_f32 v60, v60, v130
    v_add_f32 v62, v62, v146
    v_add_f32 v60, v60, v131
    v_add_f32 v62, v62, v147
    v_add_f32 v60, v60, v132
    buffer_load_dwordx4 v26, s[32:35], s85 offen offset:3072 lds
    v_add_f32 v62, v62, v148
    v_add_f32 v60, v60, v133
    v_add_f32 v62, v62, v149
    v_add_f32 v60, v60, v134
    v_add_f32 v62, v62, v150
    v_add_f32 v60, v60, v135
    v_add_f32 v62, v62, v151
    v_add_f32 v60, v60, v136
    v_add_f32 v62, v62, v152
    v_add_f32 v60, v60, v137
    v_add_f32 v62, v62, v153
    v_add_f32 v60, v60, v138
    v_add_f32 v62, v62, v154
    v_add_f32 v60, v60, v139
    v_add_f32 v62, v62, v155
    v_add_f32 v60, v60, v140
    v_add_f32 v62, v62, v156
    v_add_f32 v60, v60, v141
    v_add_f32 v62, v62, v157
    s_nop 1
    v_permlane32_swap_b32 v60, v62
    v_add_f32 v60, v60, v62
    v_rcp_f32 v60, v60
    s_nop 0
    v_mov_b32 v62, v60
    s_nop 1
    v_permlane32_swap_b32 v60, v62
    v_mov_b32 v167, 0
    v_mov_b32 v175, 0
    v_pk_mul_f32 v[128:129], v[128:129], v[60:61] op_sel_hi:[1,0]
    v_pk_mul_f32 v[130:131], v[130:131], v[60:61] op_sel_hi:[1,0]
    v_pk_mul_f32 v[132:133], v[132:133], v[60:61] op_sel_hi:[1,0]
    v_pk_mul_f32 v[134:135], v[134:135], v[60:61] op_sel_hi:[1,0]
    v_cvt_pk_bf16_f32 v160, v128, v129
    s_waitcnt vmcnt(8)
    ds_read_b128 a[208:211], v27 offset:0
    ds_read_b128 a[212:215], v27 offset:2048
    ds_read_b128 a[216:219], v28 offset:0
    ds_read_b128 a[220:223], v28 offset:2048
    v_cvt_pk_bf16_f32 v161, v130, v131
    buffer_load_dword v31, v30, s[16:19], 0 offen offset:0 sc1
    v_cvt_pk_bf16_f32 v162, v132, v133
    v_cvt_pk_bf16_f32 v163, v134, v135
    ds_write_b128 v29, v[160:163] offset:0
    v_pk_mul_f32 v[136:137], v[136:137], v[60:61] op_sel_hi:[1,0]
    v_pk_mul_f32 v[138:139], v[138:139], v[60:61] op_sel_hi:[1,0]
    v_pk_mul_f32 v[140:141], v[140:141], v[60:61] op_sel_hi:[1,0]
    v_cvt_pk_bf16_f32 v164, v136, v137
    v_cvt_pk_bf16_f32 v165, v138, v139
    v_cvt_pk_bf16_f32 v166, v140, v141
    ds_write_b128 v29, v[164:167] offset:16
    v_pk_mul_f32 v[144:145], v[144:145], v[62:63] op_sel_hi:[1,0]
    v_pk_mul_f32 v[146:147], v[146:147], v[62:63] op_sel_hi:[1,0]
    v_pk_mul_f32 v[148:149], v[148:149], v[62:63] op_sel_hi:[1,0]
    v_pk_mul_f32 v[150:151], v[150:151], v[62:63] op_sel_hi:[1,0]
    v_cvt_pk_bf16_f32 v168, v144, v145
    v_cvt_pk_bf16_f32 v169, v146, v147
    v_cvt_pk_bf16_f32 v170, v148, v149
    v_cvt_pk_bf16_f32 v171, v150, v151
    ds_write_b128 v29, v[168:171] offset:64
    v_pk_mul_f32 v[152:153], v[152:153], v[62:63] op_sel_hi:[1,0]
    v_pk_mul_f32 v[154:155], v[154:155], v[62:63] op_sel_hi:[1,0]
    v_pk_mul_f32 v[156:157], v[156:157], v[62:63] op_sel_hi:[1,0]
    v_cvt_pk_bf16_f32 v172, v152, v153
    v_cvt_pk_bf16_f32 v173, v154, v155
    v_cvt_pk_bf16_f32 v174, v156, v157
    ds_write_b128 v29, v[172:175] offset:80
    v_cvt_pk_bf16_f32 v232, v64, v65
    v_cvt_pk_bf16_f32 v233, v66, v67
    v_cvt_pk_bf16_f32 v234, v68, v69
    v_cvt_pk_bf16_f32 v235, v70, v71
    v_cvt_pk_bf16_f32 v236, v72, v73
    v_cvt_pk_bf16_f32 v237, v74, v75
    v_cvt_pk_bf16_f32 v238, v76, v77
    s_waitcnt vmcnt(5)
    ds_read_b128 a[224:227], v27 offset:4096
    ds_read_b128 a[228:231], v27 offset:6144
    ds_read_b128 a[232:235], v28 offset:4096
    ds_read_b128 a[236:239], v28 offset:6144
    v_cvt_pk_bf16_f32 v239, v78, v79
    v_cndmask_b32_e64 v232, v232, v179, s[70:71]
    v_cndmask_b32_e64 v233, v233, v179, s[70:71]
    v_cndmask_b32_e64 v234, v234, v179, s[70:71]
    v_cndmask_b32_e64 v235, v235, v179, s[70:71]
    ds_write_b128 v177, v[232:235] offset:5120
    v_cndmask_b32_e64 v236, v236, v179, s[70:71]
    v_cndmask_b32_e64 v237, v237, v179, s[70:71]
    v_cndmask_b32_e64 v238, v238, v179, s[70:71]
    v_cndmask_b32_e64 v239, v239, v179, s[70:71]
    ds_write_b128 v177, v[236:239] offset:6144
    v_mov_b32 v50, v124
    v_mov_b32 v54, v124
    s_nop 1
    v_permlane32_swap_b32 v50, v54
    v_cvt_pk_bf16_f32 v224, v112, v113
    v_cvt_pk_bf16_f32 v225, v114, v115
    v_cvt_pk_bf16_f32 v226, v116, v117
    v_cvt_pk_bf16_f32 v227, v118, v119
    v_cvt_pk_bf16_f32 v228, v120, v121
    v_cvt_pk_bf16_f32 v229, v122, v123
    v_cvt_pk_bf16_f32 v230, v124, v125
    v_cvt_pk_bf16_f32 v231, v126, v127
    v_mfma_f32_32x32x16_bf16 v[112:127], v[8:11], v[224:227], 0
    s_nop 0
    v_mfma_f32_32x32x16_bf16 v[112:127], v[12:15], v[228:231], v[112:127]
    s_waitcnt lgkmcnt(0)
    s_barrier
    ds_read_b64_tr_b16 v[240:241], v176 offset:0
    ds_read_b64_tr_b16 v[242:243], v176 offset:1152
    ds_read_b128 v[128:131], v178 offset:0
    ds_read_b128 v[64:67], v178 offset:256
    ds_read_b64_tr_b16 v[244:245], v176 offset:8192
    ds_read_b64_tr_b16 v[246:247], v176 offset:9344
    ds_read_b128 v[132:135], v178 offset:8192
    ds_read_b128 v[68:71], v178 offset:8448
    s_waitcnt vmcnt(1)
    ds_read_b128 a[240:243], v27 offset:8192
    ds_read_b128 a[244:247], v27 offset:10240
    ds_read_b128 a[248:251], v28 offset:8192
    ds_read_b128 a[252:255], v28 offset:10240
    ds_read_b64_tr_b16 v[248:249], v176 offset:16384
    ds_read_b64_tr_b16 v[250:251], v176 offset:17536
    ds_read_b128 v[136:139], v178 offset:16384
    ds_read_b128 v[72:75], v178 offset:16640
    ds_read_b64_tr_b16 v[252:253], v176 offset:24576
    ds_read_b64_tr_b16 v[254:255], v176 offset:25728
    ds_read_b128 v[140:143], v178 offset:24576
    ds_read_b128 v[76:79], v178 offset:24832
    s_waitcnt lgkmcnt(8)
    s_barrier
    v_mul_f32 v54, s67, v54
    v_exp_f32 v54, v54
    s_nop 0
    v_add_f32 v54, 1.0, v54
    v_rcp_f32 v54, v54
    s_nop 0
    v_sub_f32 v56, 1.0, v54
    v_sub_f32 v57, 1.0, v54
    s_waitcnt vmcnt(0)
    v_cmp_ne_u32 s[54:55], s52, v31
    s_nop 0
    s_cmp_eq_u64 s[54:55], 0
    s_cbranch_scc0 Lslow_7
Lback_8:
    s_nop 0
    v_permlane16_swap_b32 v56, v57
    s_add_u32 s80, s80, 229376
    s_cmp_eq_u32 s80, 1835008
    s_cselect_b32 s80, 0, s80
    s_add_u32 m0, s81, 65536
    s_nop 0
    buffer_load_dwordx4 v7, s[16:19], s80 offen sc1 lds
    v_mfma_f32_16x16x32_bf16 v[144:147], v[240:243], v[128:131], 0
    v_mfma_f32_16x16x32_bf16 v[148:151], v[240:243], v[64:67], 0
    v_mfma_f32_16x16x32_bf16 v[144:147], v[244:247], v[132:135], v[144:147]
    v_mfma_f32_16x16x32_bf16 v[148:151], v[244:247], v[68:71], v[148:151]
    buffer_load_dwordx4 v7, s[16:19], s80 offen offset:1024 sc1 lds
    s_waitcnt lgkmcnt(5)
    v_mfma_f32_16x16x32_bf16 v[144:147], v[248:251], v[136:139], v[144:147]
    s_waitcnt lgkmcnt(4)
    v_mfma_f32_16x16x32_bf16 v[148:151], v[248:251], v[72:75], v[148:151]
    s_waitcnt lgkmcnt(1)
    v_mfma_f32_16x16x32_bf16 v[144:147], v[252:255], v[140:143], v[144:147]
    s_waitcnt lgkmcnt(0)
    v_mfma_f32_16x16x32_bf16 v[148:151], v[252:255], v[76:79], v[148:151]
    v_pk_mul_f32 v[192:193], v[88:89], v[88:89]
    v_pk_mul_f32 v[194:195], v[90:91], v[90:91]
    buffer_load_dwordx4 v7, s[16:19], s80 offen offset:2048 sc1 lds
    v_pk_mul_f32 v[196:197], v[92:93], v[92:93]
    v_pk_mul_f32 v[198:199], v[94:95], v[94:95]
    s_mov_b32 s89, 0x07060500
    v_perm_b32 v144, v144, v5, s89
    v_pk_fma_f32 v[192:193], v[192:193], s[64:65], s[64:65] op_sel:[0,1,0] op_sel_hi:[1,1,0]
    v_perm_b32 v148, v148, v5, s89
    v_pk_fma_f32 v[194:195], v[194:195], s[64:65], s[64:65] op_sel:[0,1,0] op_sel_hi:[1,1,0]
    s_mov_b32 s89, 0x07060501
    v_perm_b32 v145, v145, v5, s89
    v_pk_fma_f32 v[196:197], v[196:197], s[64:65], s[64:65] op_sel:[0,1,0] op_sel_hi:[1,1,0]
    v_perm_b32 v149, v149, v5, s89
    v_pk_fma_f32 v[198:199], v[198:199], s[64:65], s[64:65] op_sel:[0,1,0] op_sel_hi:[1,1,0]
    s_mov_b32 s89, 0x07060502
    v_perm_b32 v146, v146, v5, s89
    v_pk_mul_f32 v[192:193], v[192:193], v[88:89]
    v_perm_b32 v150, v150, v5, s89
    v_pk_mul_f32 v[194:195], v[194:195], v[90:91]
    s_mov_b32 s89, 0x07060503
    v_perm_b32 v147, v147, v5, s89
    v_pk_mul_f32 v[196:197], v[196:197], v[92:93]
    v_perm_b32 v151, v151, v5, s89
    v_pk_mul_f32 v[198:199], v[198:199], v[94:95]
    buffer_store_dwordx4 v[144:147], v35, s[16:19], s45 offen offset:0 sc1
    v_exp_f32 v192, v192
    buffer_store_dwordx4 v[148:151], v35, s[16:19], s45 offen offset:256 sc1
    v_exp_f32 v193, v193
    buffer_load_dwordx4 v7, s[16:19], s80 offen offset:3072 sc1 lds
    s_add_u32 s80, s80, 229376
    s_cmp_eq_u32 s80, 1835008
    s_cselect_b32 s80, 0, s80
    s_add_u32 m0, s81, 81920
    s_nop 0
    buffer_load_dwordx4 v7, s[16:19], s80 offen sc1 lds
    v_exp_f32 v194, v194
    v_exp_f32 v195, v195
    v_exp_f32 v196, v196
    v_exp_f32 v197, v197
    v_exp_f32 v198, v198
    v_exp_f32 v199, v199
    buffer_load_dwordx4 v7, s[16:19], s80 offen offset:1024 sc1 lds
    v_pk_add_f32 v[192:193], v[192:193], 1.0 op_sel_hi:[1,0]
    v_pk_add_f32 v[194:195], v[194:195], 1.0 op_sel_hi:[1,0]
    v_pk_add_f32 v[196:197], v[196:197], 1.0 op_sel_hi:[1,0]
    v_pk_add_f32 v[198:199], v[198:199], 1.0 op_sel_hi:[1,0]
    v_rcp_f32 v192, v192
    v_rcp_f32 v193, v193
    v_rcp_f32 v194, v194
    v_rcp_f32 v195, v195
    buffer_load_dwordx4 v7, s[16:19], s80 offen offset:2048 sc1 lds
    v_rcp_f32 v196, v196
    v_rcp_f32 v197, v197
    v_rcp_f32 v198, v198
    v_rcp_f32 v199, v199
    v_pk_mul_f32 v[88:89], v[88:89], v[192:193]
    v_pk_mul_f32 v[90:91], v[90:91], v[194:195]
    v_pk_mul_f32 v[92:93], v[92:93], v[196:197]
    buffer_load_dwordx4 v7, s[16:19], s80 offen offset:3072 sc1 lds
    s_add_u32 s80, s80, 229376
    s_cmp_eq_u32 s80, 1835008
    s_cselect_b32 s80, 0, s80
    s_add_u32 m0, s76, 98304
    s_nop 0
    buffer_load_dwordx4 v7, s[16:19], s80 offen sc1 lds
    v_pk_mul_f32 v[94:95], v[94:95], v[198:199]
    v_pk_mul_f32 v[192:193], v[96:97], v[96:97]
    v_pk_mul_f32 v[194:195], v[98:99], v[98:99]
    v_pk_mul_f32 v[196:197], v[100:101], v[100:101]
    v_pk_mul_f32 v[198:199], v[102:103], v[102:103]
    v_pk_fma_f32 v[192:193], v[192:193], s[64:65], s[64:65] op_sel:[0,1,0] op_sel_hi:[1,1,0]
    v_pk_fma_f32 v[194:195], v[194:195], s[64:65], s[64:65] op_sel:[0,1,0] op_sel_hi:[1,1,0]
    v_pk_fma_f32 v[196:197], v[196:197], s[64:65], s[64:65] op_sel:[0,1,0] op_sel_hi:[1,1,0]
    v_pk_fma_f32 v[198:199], v[198:199], s[64:65], s[64:65] op_sel:[0,1,0] op_sel_hi:[1,1,0]
    v_pk_mul_f32 v[192:193], v[192:193], v[96:97]
    buffer_load_dwordx4 v7, s[16:19], s80 offen offset:1024 sc1 lds
    v_pk_mul_f32 v[194:195], v[194:195], v[98:99]
    v_pk_mul_f32 v[196:197], v[196:197], v[100:101]
    v_pk_mul_f32 v[198:199], v[198:199], v[102:103]
    v_exp_f32 v192, v192
    v_exp_f32 v193, v193
    v_exp_f32 v194, v194
    v_exp_f32 v195, v195
    buffer_load_dwordx4 v7, s[16:19], s80 offen offset:2048 sc1 lds
    s_add_u32 s80, s80, 229376
    s_cmp_eq_u32 s80, 1835008
    s_cselect_b32 s80, 0, s80
    s_add_u32 m0, s76, 110592
    s_nop 0
    buffer_load_dwordx4 v7, s[16:19], s80 offen sc1 lds
    v_exp_f32 v196, v196
    v_exp_f32 v197, v197
    v_exp_f32 v198, v198
    v_exp_f32 v199, v199
    v_pk_add_f32 v[192:193], v[192:193], 1.0 op_sel_hi:[1,0]
    v_pk_add_f32 v[194:195], v[194:195], 1.0 op_sel_hi:[1,0]
    v_pk_add_f32 v[196:197], v[196:197], 1.0 op_sel_hi:[1,0]
    buffer_load_dwordx4 v7, s[16:19], s80 offen offset:1024 sc1 lds
    v_pk_add_f32 v[198:199], v[198:199], 1.0 op_sel_hi:[1,0]
    v_rcp_f32 v192, v192
    v_rcp_f32 v193, v193
    v_rcp_f32 v194, v194
    v_rcp_f32 v195, v195
    v_rcp_f32 v196, v196
    v_rcp_f32 v197, v197
    buffer_load_dwordx4 v7, s[16:19], s80 offen offset:2048 sc1 lds
    v_rcp_f32 v198, v198
    v_rcp_f32 v199, v199
    v_pk_mul_f32 v[96:97], v[96:97], v[192:193]
    v_pk_mul_f32 v[98:99], v[98:99], v[194:195]
    v_pk_mul_f32 v[100:101], v[100:101], v[196:197]
    v_pk_mul_f32 v[102:103], v[102:103], v[198:199]
    v_pk_mul_f32 v[192:193], v[104:105], v[104:105]
    v_pk_mul_f32 v[194:195], v[106:107], v[106:107]
    v_pk_mul_f32 v[196:197], v[108:109], v[108:109]
    v_pk_mul_f32 v[198:199], v[110:111], v[110:111]
    v_pk_fma_f32 v[192:193], v[192:193], s[64:65], s[64:65] op_sel:[0,1,0] op_sel_hi:[1,1,0]
    v_pk_fma_f32 v[194:195], v[194:195], s[64:65], s[64:65] op_sel:[0,1,0] op_sel_hi:[1,1,0]
    v_pk_fma_f32 v[196:197], v[196:197], s[64:65], s[64:65] op_sel:[0,1,0] op_sel_hi:[1,1,0]
    v_pk_fma_f32 v[198:199], v[198:199], s[64:65], s[64:65] op_sel:[0,1,0] op_sel_hi:[1,1,0]
    v_pk_mul_f32 v[192:193], v[192:193], v[104:105]
    v_pk_mul_f32 v[194:195], v[194:195], v[106:107]
    v_pk_mul_f32 v[196:197], v[196:197], v[108:109]
    v_pk_mul_f32 v[198:199], v[198:199], v[110:111]
    v_exp_f32 v192, v192
    v_exp_f32 v193, v193
    v_exp_f32 v194, v194
    v_exp_f32 v195, v195
    v_exp_f32 v196, v196
    v_exp_f32 v197, v197
    v_exp_f32 v198, v198
    v_exp_f32 v199, v199
    v_pk_add_f32 v[192:193], v[192:193], 1.0 op_sel_hi:[1,0]
    v_pk_add_f32 v[194:195], v[194:195], 1.0 op_sel_hi:[1,0]
    v_pk_add_f32 v[196:197], v[196:197], 1.0 op_sel_hi:[1,0]
    v_pk_add_f32 v[198:199], v[198:199], 1.0 op_sel_hi:[1,0]
    v_rcp_f32 v192, v192
    v_rcp_f32 v193, v193
    v_rcp_f32 v194, v194
    v_rcp_f32 v195, v195
    v_rcp_f32 v196, v196
    v_rcp_f32 v197, v197
    v_rcp_f32 v198, v198
    v_rcp_f32 v199, v199
    v_pk_mul_f32 v[104:105], v[104:105], v[192:193]
    v_pk_mul_f32 v[106:107], v[106:107], v[194:195]
    v_pk_mul_f32 v[108:109], v[108:109], v[196:197]
    v_pk_mul_f32 v[110:111], v[110:111], v[198:199]
    v_pk_mul_f32 v[80:81], v[80:81], v[56:57] op_sel_hi:[1,0]
    v_pk_mul_f32 v[82:83], v[82:83], v[56:57] op_sel_hi:[1,0]
    v_pk_mul_f32 v[84:85], v[84:85], v[56:57] op_sel_hi:[1,0]
    v_pk_mul_f32 v[86:87], v[86:87], v[56:57] op_sel_hi:[1,0]
    v_pk_mul_f32 v[88:89], v[88:89], v[56:57] op_sel:[0,1]
    v_pk_mul_f32 v[90:91], v[90:91], v[56:57] op_sel:[0,1]
    v_pk_mul_f32 v[92:93], v[92:93], v[56:57] op_sel:[0,1]
    v_pk_mul_f32 v[94:95], v[94:95], v[56:57] op_sel:[0,1]
    v_pk_mul_f32 v[96:97], v[96:97], v[56:57] op_sel_hi:[1,0]
    v_pk_mul_f32 v[98:99], v[98:99], v[56:57] op_sel_hi:[1,0]
    v_pk_mul_f32 v[100:101], v[100:101], v[56:57] op_sel_hi:[1,0]
    v_pk_mul_f32 v[102:103], v[102:103], v[56:57] op_sel_hi:[1,0]
    v_pk_mul_f32 v[104:105], v[104:105], v[56:57] op_sel:[0,1]
    v_pk_mul_f32 v[106:107], v[106:107], v[56:57] op_sel:[0,1]
    v_pk_mul_f32 v[108:109], v[108:109], v[56:57] op_sel:[0,1]
    v_pk_mul_f32 v[110:111], v[110:111], v[56:57] op_sel:[0,1]
    v_lshrrev_b32 v29, 2, v0
    v_mul_u32_u24 v29, 8320, v29
    v_and_b32 v34, 3, v0
    v_lshl_add_u32 v29, v34, 4, v29
    s_lshr_b32 s88, s37, 2
    s_lshl_b32 s88, s88, 10
    s_lshl_b32 s89, s44, 6
    s_add_u32 s88, s88, s89
    s_mul_i32 s89, s40, 133120
    s_add_u32 s88, s88, s89
    s_add_u32 s88, s88, 2621440
    v_and_b32 v58, 3, v0
    v_lshlrev_b32 v58, 4, v58
    v_lshrrev_b32 v34, 5, v0
    v_lshl_add_u32 v58, v34, 10, v58
    s_lshr_b32 s82, s37, 2
    s_lshl_b32 s82, s82, 10
    s_lshl_b32 s89, s44, 6
    s_add_u32 s82, s82, s89
    s_lshl_b32 s89, s40, 13
    s_add_u32 s82, s82, s89
    s_add_u32 s82, s82, 655360
    s_lshl_b32 s83, s40, 13
    s_lshl_b32 s89, s36, 11
    s_add_u32 s83, s83, s89
    s_add_u32 s83, s83, 655360
    s_mov_b32 s89, 0x0c0c0400
    v_lshlrev_b32 v168, 16, v32
    v_lshlrev_b32 v169, 16, v32
    v_lshlrev_b32 v170, 16, v32
    v_lshlrev_b32 v171, 16, v32
    v_lshlrev_b32 v172, 16, v33
    v_lshlrev_b32 v173, 16, v33
    s_waitcnt vmcnt(10)
    s_barrier
    s_add_u32 s80, s80, 229376
    s_cmp_eq_u32 s80, 1835008
    s_cselect_b32 s80, 0, s80
    s_add_u32 m0, s76, 122880
    s_nop 0
    buffer_load_dwordx4 v7, s[16:19], s80 offen sc1 lds
    ds_read_b128 v[224:227], v22 offset:0
    ds_read_b128 v[228:231], v22 offset:4096
    ds_read_b128 v[232:235], v22 offset:8192
    ds_read_b128 v[236:239], v22 offset:12288
    ds_read_b128 v[240:243], v22 offset:1024
    ds_read_b128 v[244:247], v22 offset:5120
    ds_read_b128 v[248:251], v22 offset:9216
    buffer_load_dwordx4 v7, s[16:19], s80 offen offset:1024 sc1 lds
    ds_read_b128 v[252:255], v22 offset:13312
    s_waitcnt lgkmcnt(7)
    v_mfma_f32_16x16x32_bf16 v[192:195], v[224:227], a[0:3], 0
    v_lshlrev_b32 v174, 16, v33
    v_lshlrev_b32 v175, 16, v33
    s_waitcnt lgkmcnt(6)
    v_mfma_f32_16x16x32_bf16 v[192:195], v[228:231], a[8:11], v[192:195]
    s_waitcnt lgkmcnt(4)
    v_mfma_f32_16x16x32_bf16 v[192:195], v[232:235], a[16:19], v[192:195]
    v_lshlrev_b32 v62, 1, v3
    v_xor_b32 v62, v62, v2
    v_mfma_f32_16x16x32_bf16 v[192:195], v[236:239], a[24:27], v[192:195]
    v_mul_u32_u24 v55, 896, v1
    v_lshl_add_u32 v55, v62, 4, v55
    v_mfma_f32_16x16x32_bf16 v[196:199], v[224:227], a[4:7], 0
    s_lshl_b32 s95, s39, 7
    ds_read_b128 v[224:227], v22 offset:2048
    buffer_load_dwordx4 v7, s[16:19], s80 offen offset:2048 sc1 lds
    s_add_u32 s80, s80, 229376
    s_cmp_eq_u32 s80, 1835008
    s_cselect_b32 s80, 0, s80
    v_mfma_f32_16x16x32_bf16 v[196:199], v[228:231], a[12:15], v[196:199]
    s_add_u32 m0, s76, 135168
    v_add_u32 v55, s95, v55
    v_add_u32 v62, 6144, v55
    v_mfma_f32_16x16x32_bf16 v[196:199], v[232:235], a[20:23], v[196:199]
    ds_read_b128 v[228:231], v22 offset:6144
    v_add_u32 v63, 12288, v55
    v_mfma_f32_16x16x32_bf16 v[196:199], v[236:239], a[28:31], v[196:199]
    s_waitcnt lgkmcnt(4)
    v_add_u32 v18, 18432, v55
    v_max3_f32 v50, v112, v113, v114
    v_mfma_f32_16x16x32_bf16 v[200:203], v[240:243], a[0:3], 0
    ds_read_b128 v[232:235], v22 offset:10240
    buffer_load_dwordx4 v7, s[16:19], s80 offen sc1 lds
    v_mfma_f32_16x16x32_bf16 v[200:203], v[244:247], a[8:11], v[200:203]
    s_waitcnt lgkmcnt(3)
    v_max3_f32 v52, -v112, -v113, -v114
    v_max3_f32 v50, v50, v115, v116
    v_mfma_f32_16x16x32_bf16 v[200:203], v[248:251], a[16:19], v[200:203]
    ds_read_b128 v[236:239], v22 offset:14336
    v_max3_f32 v52, v52, -v115, -v116
    v_mfma_f32_16x16x32_bf16 v[200:203], v[252:255], a[24:27], v[200:203]
    v_max3_f32 v50, v50, v117, v118
    v_max3_f32 v52, v52, -v117, -v118
    v_mfma_f32_16x16x32_bf16 v[204:207], v[240:243], a[4:7], 0
    ds_read_b128 v[240:243], v22 offset:3072
    buffer_load_dwordx4 v7, s[16:19], s80 offen offset:1024 sc1 lds
    v_mfma_f32_16x16x32_bf16 v[204:207], v[244:247], a[12:15], v[204:207]
    v_max3_f32 v50, v50, v119, v120
    v_max3_f32 v52, v52, -v119, -v120
    v_mfma_f32_16x16x32_bf16 v[204:207], v[248:251], a[20:23], v[204:207]
    ds_read_b128 v[244:247], v22 offset:7168
    v_max3_f32 v50, v50, v121, v122
    v_mfma_f32_16x16x32_bf16 v[204:207], v[252:255], a[28:31], v[204:207]
    s_waitcnt lgkmcnt(4)
    v_max3_f32 v52, v52, -v121, -v122
    v_max3_f32 v50, v50, v123, v124
    v_mfma_f32_16x16x32_bf16 v[208:211], v[224:227], a[0:3], 0
    ds_read_b128 v[248:251], v22 offset:11264
    buffer_load_dwordx4 v7, s[16:19], s80 offen offset:2048 sc1 lds
    s_add_u32 s80, s80, 229376
    s_cmp_eq_u32 s80, 1835008
    s_cselect_b32 s80, 0, s80
    v_mfma_f32_16x16x32_bf16 v[208:211], v[228:231], a[8:11], v[208:211]
    s_waitcnt lgkmcnt(3)
    s_add_u32 m0, s76, 147456
    v_max3_f32 v52, v52, -v123, -v124
    v_mfma_f32_16x16x32_bf16 v[208:211], v[232:235], a[16:19], v[208:211]
    ds_read_b128 v[252:255], v22 offset:15360
    v_max3_f32 v50, v50, v125, v125
    v_mfma_f32_16x16x32_bf16 v[208:211], v[236:239], a[24:27], v[208:211]
    v_max3_f32 v52, v52, -v125, -v125
    v_mfma_f32_16x16x32_bf16 v[212:215], v[224:227], a[4:7], 0
    s_waitcnt vmcnt(9)
    s_barrier
    buffer_load_dwordx4 v7, s[16:19], s80 offen sc1 lds
    ds_read_b128 v[224:227], v22 offset:16384
    v_mfma_f32_16x16x32_bf16 v[212:215], v[228:231], a[12:15], v[212:215]
    v_permlane32_swap_b32 v50, v52
    v_max_f32 v50, v50, v52
    v_mfma_f32_16x16x32_bf16 v[212:215], v[232:235], a[20:23], v[212:215]
    ds_read_b128 v[228:231], v22 offset:20480
    v_mul_f32 v50, s67, v50
    v_mfma_f32_16x16x32_bf16 v[212:215], v[236:239], a[28:31], v[212:215]
    s_waitcnt lgkmcnt(4)
    s_add_u32 s59, s84, 4096
    v_and_b32 v64, 15, v0
    v_mfma_f32_16x16x32_bf16 v[216:219], v[240:243], a[0:3], 0
    ds_read_b128 v[232:235], v22 offset:24576
    buffer_load_dwordx4 v7, s[16:19], s80 offen offset:1024 sc1 lds
    v_mfma_f32_16x16x32_bf16 v[216:219], v[244:247], a[8:11], v[216:219]
    s_waitcnt lgkmcnt(3)
    v_lshlrev_b32 v65, 2, v3
    v_sub_u32 v64, v64, v65
    v_mfma_f32_16x16x32_bf16 v[216:219], v[248:251], a[16:19], v[216:219]
    ds_read_b128 v[236:239], v22 offset:28672
    v_and_b32 v65, 1, v64
    v_mfma_f32_16x16x32_bf16 v[216:219], v[252:255], a[24:27], v[216:219]
    v_lshlrev_b32 v65, 4, v65
    v_mov_b32 v66, 0x3f80
    v_mfma_f32_16x16x32_bf16 v[220:223], v[240:243], a[4:7], 0
    ds_read_b128 v[240:243], v22 offset:17408
    buffer_load_dwordx4 v[128:131], v29, s[16:19], s88 offen offset:0 sc1
    v_mfma_f32_16x16x32_bf16 v[220:223], v[244:247], a[12:15], v[220:223]
    v_lshlrev_b32 v65, v65, v66
    v_lshrrev_b32 v64, 1, v64
    v_mfma_f32_16x16x32_bf16 v[220:223], v[248:251], a[20:23], v[220:223]
    ds_read_b128 v[244:247], v22 offset:21504
    v_cmp_eq_u32 vcc, 0, v64
    v_mfma_f32_16x16x32_bf16 v[220:223], v[252:255], a[28:31], v[220:223]
    s_waitcnt lgkmcnt(4)
    v_mov_b32 v67, s52
    v_mov_b32 v71, s52
    v_mfma_f32_16x16x32_bf16 v[192:195], v[224:227], a[32:35], v[192:195]
    ds_read_b128 v[248:251], v22 offset:25600
    buffer_load_dwordx4 v[132:135], v29, s[16:19], s88 offen offset:1024 sc1
    v_mfma_f32_16x16x32_bf16 v[192:195], v[228:231], a[40:43], v[192:195]
    s_waitcnt lgkmcnt(3)
    v_cndmask_b32 v60, 0, v65, vcc
    v_cmp_eq_u32 vcc, 1, v64
    v_mfma_f32_16x16x32_bf16 v[192:195], v[232:235], a[48:51], v[192:195]
    ds_read_b128 v[252:255], v22 offset:29696
    v_mov_b32 v75, s52
    v_mfma_f32_16x16x32_bf16 v[192:195], v[236:239], a[56:59], v[192:195]
    v_mov_b32 v79, s52
    v_cndmask_b32 v61, 0, v65, vcc
    v_mfma_f32_16x16x32_bf16 v[196:199], v[236:239], a[60:63], v[196:199]
    ds_read_b128 v[236:239], v22 offset:18432
    buffer_load_dwordx4 v7, s[16:19], s80 offen offset:2048 sc1 lds
    s_add_u32 s80, s80, 229376
    s_cmp_eq_u32 s80, 1835008
    s_cselect_b32 s80, 0, s80
    v_mfma_f32_16x16x32_bf16 v[196:199], v[232:235], a[52:55], v[196:199]
    s_add_u32 m0, s76, 0
    v_mov_b32 v52, v50
    v_mfma_f32_16x16x32_bf16 v[196:199], v[228:231], a[44:47], v[196:199]
    ds_read_b128 v[232:235], v22 offset:22528
    v_permlane32_swap_b32 v50, v52
    v_mfma_f32_16x16x32_bf16 v[196:199], v[224:227], a[36:39], v[196:199]
    s_waitcnt lgkmcnt(4)
    v_fma_f32 v36, v112, s67, v52
    v_fma_f32 v112, v112, s66, v50
    v_mfma_f32_16x16x32_bf16 v[200:203], v[240:243], a[32:35], v[200:203]
    ds_read_b128 v[228:231], v22 offset:26624
    buffer_load_dwordx4 v7, s[16:19], s80 offen sc1 lds
    v_mfma_f32_16x16x32_bf16 v[200:203], v[244:247], a[40:43], v[200:203]
    s_waitcnt lgkmcnt(3)
    v_fma_f32 v37, v113, s67, v52
    v_fma_f32 v113, v113, s66, v50
    v_mfma_f32_16x16x32_bf16 v[200:203], v[248:251], a[48:51], v[200:203]
    ds_read_b128 v[224:227], v22 offset:30720
    v_fma_f32 v38, v114, s67, v52
    v_mfma_f32_16x16x32_bf16 v[200:203], v[252:255], a[56:59], v[200:203]
    v_fma_f32 v114, v114, s66, v50
    v_fma_f32 v39, v115, s67, v52
    v_mfma_f32_16x16x32_bf16 v[204:207], v[252:255], a[60:63], v[204:207]
    ds_read_b128 v[252:255], v22 offset:19456
    buffer_load_dwordx4 v7, s[16:19], s80 offen offset:1024 sc1 lds
    v_mfma_f32_16x16x32_bf16 v[204:207], v[248:251], a[52:55], v[204:207]
    v_fma_f32 v115, v115, s66, v50
    v_fma_f32 v40, v116, s67, v52
    v_mfma_f32_16x16x32_bf16 v[204:207], v[244:247], a[44:47], v[204:207]
    ds_read_b128 v[248:251], v22 offset:23552
    v_fma_f32 v116, v116, s66, v50
    v_mfma_f32_16x16x32_bf16 v[204:207], v[240:243], a[36:39], v[204:207]
    s_waitcnt lgkmcnt(4)
    v_fma_f32 v41, v117, s67, v52
    v_fma_f32 v117, v117, s66, v50
    v_mfma_f32_16x16x32_bf16 v[208:211], v[236:239], a[32:35], v[208:211]
    ds_read_b128 v[244:247], v22 offset:27648
    buffer_load_dwordx4 v7, s[16:19], s80 offen offset:2048 sc1 lds
    s_add_u32 s80, s80, 229376
    s_cmp_eq_u32 s80, 1835008
    s_cselect_b32 s80, 0, s80
    v_mfma_f32_16x16x32_bf16 v[208:211], v[232:235], a[40:43], v[208:211]
    s_waitcnt lgkmcnt(3)
    s_add_u32 m0, s81, 16384
    v_fma_f32 v42, v118, s67, v52
    v_mfma_f32_16x16x32_bf16 v[208:211], v[228:231], a[48:51], v[208:211]
    ds_read_b128 v[240:243], v22 offset:31744
    v_fma_f32 v118, v118, s66, v50
    v_mfma_f32_16x16x32_bf16 v[208:211], v[224:227], a[56:59], v[208:211]
    v_fma_f32 v43, v119, s67, v52
    v_fma_f32 v119, v119, s66, v50
    v_mfma_f32_16x16x32_bf16 v[212:215], v[224:227], a[60:63], v[212:215]
    ds_read_b128 v[224:227], v22 offset:32768
    buffer_load_dwordx4 v20, s[16:19], s80 offen sc1 lds
    v_mfma_f32_16x16x32_bf16 v[212:215], v[228:231], a[52:55], v[212:215]
    v_fma_f32 v44, v120, s67, v52
    v_fma_f32 v120, v120, s66, v50
    v_mfma_f32_16x16x32_bf16 v[212:215], v[232:235], a[44:47], v[212:215]
    ds_read_b128 v[228:231], v22 offset:35840
    v_fma_f32 v45, v121, s67, v52
    v_mfma_f32_16x16x32_bf16 v[212:215], v[236:239], a[36:39], v[212:215]
    s_waitcnt lgkmcnt(4)
    v_fma_f32 v121, v121, s66, v50
    v_fma_f32 v46, v122, s67, v52
    v_mfma_f32_16x16x32_bf16 v[216:219], v[252:255], a[32:35], v[216:219]
    ds_read_b128 v[232:235], v22 offset:38912
    buffer_load_dwordx4 v20, s[16:19], s80 offen offset:1024 sc1 lds
    v_mfma_f32_16x16x32_bf16 v[216:219], v[248:251], a[40:43], v[216:219]
    s_waitcnt lgkmcnt(3)
    v_fma_f32 v122, v122, s66, v50
    v_fma_f32 v47, v123, s67, v52
    v_mfma_f32_16x16x32_bf16 v[216:219], v[244:247], a[48:51], v[216:219]
    ds_read_b128 v[236:239], v22 offset:41984
    v_fma_f32 v123, v123, s66, v50
    v_mfma_f32_16x16x32_bf16 v[216:219], v[240:243], a[56:59], v[216:219]
    v_fma_f32 v48, v124, s67, v52
    v_fma_f32 v124, v124, s66, v50
    v_mfma_f32_16x16x32_bf16 v[220:223], v[240:243], a[60:63], v[220:223]
    ds_read_b128 v[240:243], v22 offset:33792
    v_fma_f32 v49, v125, s67, v52
    v_mfma_f32_16x16x32_bf16 v[220:223], v[244:247], a[52:55], v[220:223]
    v_fma_f32 v125, v125, s66, v50
    v_mfma_f32_16x16x32_bf16 v[220:223], v[248:251], a[44:47], v[220:223]
    ds_read_b128 v[244:247], v22 offset:36864
    v_mfma_f32_16x16x32_bf16 v[220:223], v[252:255], a[36:39], v[220:223]
    s_waitcnt lgkmcnt(4)
    v_exp_f32 v112, v112
    v_mfma_f32_16x16x32_bf16 v[192:195], v[224:227], a[64:67], v[192:195]
    ds_read_b128 v[248:251], v22 offset:39936
    v_mfma_f32_16x16x32_bf16 v[192:195], v[228:231], a[72:75], v[192:195]
    s_waitcnt lgkmcnt(3)
    v_exp_f32 v36, v36
    v_mfma_f32_16x16x32_bf16 v[192:195], v[232:235], a[80:83], v[192:195]
    ds_read_b128 v[252:255], v22 offset:43008
    v_mfma_f32_16x16x32_bf16 v[192:195], v[236:239], a[88:91], v[192:195]
    v_exp_f32 v113, v113
    v_mfma_f32_16x16x32_bf16 v[196:199], v[236:239], a[92:95], v[196:199]
    ds_read_b128 v[236:239], v22 offset:34816
    v_mfma_f32_16x16x32_bf16 v[196:199], v[232:235], a[84:87], v[196:199]
    v_exp_f32 v37, v37
    v_mfma_f32_16x16x32_bf16 v[196:199], v[228:231], a[76:79], v[196:199]
    ds_read_b128 v[232:235], v22 offset:37888
    v_mfma_f32_16x16x32_bf16 v[196:199], v[224:227], a[68:71], v[196:199]
    s_waitcnt lgkmcnt(4)
    v_cvt_pk_bf16_f32 v216, v216, v217
    v_cvt_pk_bf16_f32 v217, v218, v219
    v_mfma_f32_16x16x32_bf16 v[200:203], v[240:243], a[64:67], v[200:203]
    ds_read_b128 v[228:231], v22 offset:40960
    v_cvt_pk_bf16_f32 v218, v220, v221
    v_mfma_f32_16x16x32_bf16 v[200:203], v[244:247], a[72:75], v[200:203]
    s_waitcnt lgkmcnt(3)
    v_cvt_pk_bf16_f32 v219, v222, v223
    v_mfma_f32_16x16x32_bf16 v[200:203], v[248:251], a[80:83], v[200:203]
    ds_read_b128 v[224:227], v22 offset:44032
    v_mfma_f32_16x16x32_bf16 v[200:203], v[252:255], a[88:91], v[200:203]
    buffer_store_dwordx4 v[216:219], v4, s[16:19], s59 offen offset:2048 sc1
    v_mfma_f32_16x16x32_bf16 v[204:207], v[252:255], a[92:95], v[204:207]
    s_waitcnt vmcnt(11)
    s_barrier
    buffer_load_dwordx4 v20, s[16:19], s80 offen offset:2048 sc1 lds
    ds_read_b128 v[252:255], v22 offset:45056
    v_mfma_f32_16x16x32_bf16 v[204:207], v[248:251], a[84:87], v[204:207]
    v_exp_f32 v114, v114
    v_mfma_f32_16x16x32_bf16 v[204:207], v[244:247], a[76:79], v[204:207]
    ds_read_b128 v[248:251], v22 offset:48128
    v_mfma_f32_16x16x32_bf16 v[204:207], v[240:243], a[68:71], v[204:207]
    s_waitcnt lgkmcnt(4)
    v_exp_f32 v38, v38
    v_mfma_f32_16x16x32_bf16 v[208:211], v[236:239], a[64:67], v[208:211]
    ds_read_b128 v[244:247], v22 offset:51200
    buffer_load_dwordx4 v20, s[16:19], s80 offen offset:3072 sc1 lds
    s_add_u32 s80, s80, 229376
    s_cmp_eq_u32 s80, 1835008
    s_cselect_b32 s80, 0, s80
    v_mfma_f32_16x16x32_bf16 v[208:211], v[232:235], a[72:75], v[208:211]
    s_waitcnt lgkmcnt(3)
    s_add_u32 m0, s81, 32768
    v_mfma_f32_16x16x32_bf16 v[208:211], v[228:231], a[80:83], v[208:211]
    ds_read_b128 v[240:243], v22 offset:54272
    v_mfma_f32_16x16x32_bf16 v[208:211], v[224:227], a[88:91], v[208:211]
    v_exp_f32 v115, v115
    v_mfma_f32_16x16x32_bf16 v[212:215], v[224:227], a[92:95], v[212:215]
    ds_read_b128 v[224:227], v22 offset:46080
    buffer_load_dwordx4 v20, s[16:19], s80 offen sc1 lds
    v_mfma_f32_16x16x32_bf16 v[212:215], v[228:231], a[84:87], v[212:215]
    s_waitcnt vmcnt(11)
    v_perm_b32 v136, v129, v128, s89
    v_perm_b32 v137, v131, v130, s89
    v_mfma_f32_16x16x32_bf16 v[212:215], v[232:235], a[76:79], v[212:215]
    ds_read_b128 v[228:231], v22 offset:49152
    v_lshl_or_b32 v136, v137, 16, v136
    v_mfma_f32_16x16x32_bf16 v[212:215], v[236:239], a[68:71], v[212:215]
    s_waitcnt lgkmcnt(4)
    s_waitcnt vmcnt(10)
    v_perm_b32 v138, v133, v132, s89
    v_mfma_f32_16x16x32_bf16 v[192:195], v[252:255], a[96:99], v[192:195]
    ds_read_b128 v[232:235], v22 offset:52224
    buffer_load_dwordx4 v20, s[16:19], s80 offen offset:1024 sc1 lds
    v_mfma_f32_16x16x32_bf16 v[192:195], v[248:251], a[104:107], v[192:195]
    s_waitcnt lgkmcnt(3)
    v_perm_b32 v139, v135, v134, s89
    v_lshl_or_b32 v138, v139, 16, v138
    v_mfma_f32_16x16x32_bf16 v[192:195], v[244:247], a[112:115], v[192:195]
    ds_read_b128 v[236:239], v22 offset:55296
    v_min3_u32 v140, v136, v138, v138
    v_mfma_f32_16x16x32_bf16 v[192:195], v[240:243], a[120:123], v[192:195]
    v_max3_u32 v141, v136, v138, v138
    v_xor_b32 v140, s52, v140
    v_mfma_f32_16x16x32_bf16 v[196:199], v[240:243], a[124:127], v[196:199]
    ds_read_b128 v[240:243], v22 offset:47104
    buffer_load_dwordx4 v20, s[16:19], s80 offen offset:2048 sc1 lds
    v_mfma_f32_16x16x32_bf16 v[196:199], v[244:247], a[116:119], v[196:199]
    v_xor_b32 v141, s52, v141
    v_or_b32 v140, v140, v141
    v_mfma_f32_16x16x32_bf16 v[196:199], v[248:251], a[108:111], v[196:199]
    ds_read_b128 v[244:247], v22 offset:50176
    v_mfma_f32_16x16x32_bf16 v[196:199], v[252:255], a[100:103], v[196:199]
    s_waitcnt lgkmcnt(4)
    v_cmp_ne_u32 s[54:55], 0, v140
    s_nop 0
    s_cmp_eq_u64 s[54:55], 0
    s_cbranch_scc0 Lslow_9
Lback_10:
    s_nop 0
    buffer_load_dwordx4 v20, s[16:19], s80 offen offset:3072 sc1 lds
    s_add_u32 s80, s80, 229376
    s_mov_b32 s89, 0xffffff00
    v_mfma_f32_16x16x32_bf16 v[200:203], v[224:227], a[96:99], v[200:203]
    ds_read_b128 v[248:251], v22 offset:53248
    s_cmp_eq_u32 s80, 1835008
    s_cselect_b32 s80, 0, s80
    s_add_u32 m0, s81, 49152
    v_mfma_f32_16x16x32_bf16 v[200:203], v[228:231], a[104:107], v[200:203]
    s_waitcnt lgkmcnt(3)
    v_and_b32 v128, s89, v128
    v_and_b32 v129, s89, v129
    v_mfma_f32_16x16x32_bf16 v[200:203], v[232:235], a[112:115], v[200:203]
    ds_read_b128 v[252:255], v22 offset:56320
    v_and_b32 v130, s89, v130
    v_mfma_f32_16x16x32_bf16 v[200:203], v[236:239], a[120:123], v[200:203]
    v_and_b32 v131, s89, v131
    v_and_b32 v132, s89, v132
    v_mfma_f32_16x16x32_bf16 v[204:207], v[236:239], a[124:127], v[204:207]
    ds_read_b128 v[236:239], v22 offset:57344
    buffer_load_dwordx4 v20, s[16:19], s80 offen sc1 lds
    v_mfma_f32_16x16x32_bf16 v[204:207], v[232:235], a[116:119], v[204:207]
    v_and_b32 v133, s89, v133
    v_and_b32 v134, s89, v134
    v_mfma_f32_16x16x32_bf16 v[204:207], v[228:231], a[108:111], v[204:207]
    ds_read_b128 v[232:235], v22 offset:60416
    v_and_b32 v135, s89, v135
    v_mfma_f32_16x16x32_bf16 v[204:207], v[224:227], a[100:103], v[204:207]
    s_waitcnt lgkmcnt(4)
    v_permlane32_swap_b32 v128, v132
    v_permlane32_swap_b32 v129, v133
    v_mfma_f32_16x16x32_bf16 v[208:211], v[240:243], a[96:99], v[208:211]
    ds_read_b128 v[228:231], v22 offset:63488
    buffer_load_dwordx4 v20, s[16:19], s80 offen offset:1024 sc1 lds
    v_mfma_f32_16x16x32_bf16 v[208:211], v[244:247], a[104:107], v[208:211]
    s_waitcnt lgkmcnt(3)
    v_permlane32_swap_b32 v130, v134
    v_permlane32_swap_b32 v131, v135
    v_mfma_f32_16x16x32_bf16 v[208:211], v[248:251], a[112:115], v[208:211]
    ds_read_b128 v[224:227], v21 offset:1024
    v_add_f32 v128, v128, v132
    v_mfma_f32_16x16x32_bf16 v[208:211], v[252:255], a[120:123], v[208:211]
    v_add_f32 v129, v129, v133
    v_add_f32 v130, v130, v134
    v_mfma_f32_16x16x32_bf16 v[212:215], v[252:255], a[124:127], v[212:215]
    ds_read_b128 v[252:255], v22 offset:58368
    buffer_load_dwordx4 v20, s[16:19], s80 offen offset:2048 sc1 lds
    v_mfma_f32_16x16x32_bf16 v[212:215], v[248:251], a[116:119], v[212:215]
    v_add_f32 v131, v131, v135
    v_permlane16_swap_b32 v128, v130
    v_mfma_f32_16x16x32_bf16 v[212:215], v[244:247], a[108:111], v[212:215]
    ds_read_b128 v[248:251], v22 offset:61440
    v_permlane16_swap_b32 v129, v131
    v_mfma_f32_16x16x32_bf16 v[212:215], v[240:243], a[100:103], v[212:215]
    s_waitcnt lgkmcnt(4)
    v_add_f32 v128, v128, v130
    v_add_f32 v129, v129, v131
    v_mfma_f32_16x16x32_bf16 v[192:195], v[236:239], a[128:131], v[192:195]
    ds_read_b128 v[244:247], v22 offset:64512
    buffer_load_dwordx4 v20, s[16:19], s80 offen offset:3072 sc1 lds
    s_add_u32 s80, s80, 229376
    s_cmp_eq_u32 s80, 1835008
    s_cselect_b32 s80, 0, s80
    v_mfma_f32_16x16x32_bf16 v[192:195], v[232:235], a[136:139], v[192:195]
    s_waitcnt lgkmcnt(3)
    s_add_u32 m0, s81, 65536
    v_add_f32_dpp v128, v128, v128 row_ror:8 row_mask:0xf bank_mask:0xf
    v_mfma_f32_16x16x32_bf16 v[192:195], v[228:231], a[144:147], v[192:195]
    ds_read_b128 v[240:243], v21 offset:2048
    v_add_f32_dpp v129, v129, v129 row_ror:8 row_mask:0xf bank_mask:0xf
    v_mfma_f32_16x16x32_bf16 v[192:195], v[224:227], a[152:155], v[192:195]
    v_add_f32_dpp v128, v128, v128 row_ror:4 row_mask:0xf bank_mask:0xf
    v_add_f32_dpp v129, v129, v129 row_ror:4 row_mask:0xf bank_mask:0xf
    v_mfma_f32_16x16x32_bf16 v[196:199], v[224:227], a[156:159], v[196:199]
    ds_read_b128 v[224:227], v22 offset:59392
    buffer_load_dwordx4 v20, s[16:19], s80 offen sc1 lds
    v_mfma_f32_16x16x32_bf16 v[196:199], v[228:231], a[148:151], v[196:199]
    v_cvt_pk_bf16_f32 v128, v128, v129
    v_mov_b32 v129, s52
    v_mfma_f32_16x16x32_bf16 v[196:199], v[232:235], a[140:143], v[196:199]
    ds_read_b128 v[228:231], v22 offset:62464
    v_mov_b32 v131, s52
    v_mfma_f32_16x16x32_bf16 v[196:199], v[236:239], a[132:135], v[196:199]
    s_waitcnt lgkmcnt(4)
    v_permlane16_swap_b32 v128, v130
    v_mfma_f32_16x16x32_bf16 v[200:203], v[252:255], a[128:131], v[200:203]
    ds_read_b128 v[232:235], v21 offset:0
    s_mov_b32 exec_lo, 15
    s_mov_b32 exec_hi, 15
    buffer_store_dwordx4 v[128:131], v58, s[16:19], s82 offen sc1
    s_mov_b64 exec, -1
    s_lshl_b32 s88, s36, 10
    s_add_u32 s88, s88, 131072
    v_mfma_f32_16x16x32_bf16 v[200:203], v[248:251], a[136:139], v[200:203]
    s_waitcnt lgkmcnt(3)
    v_add_u32 v29, s88, v4
    v_add_u32 v34, 131072, v4
    v_mfma_f32_16x16x32_bf16 v[200:203], v[244:247], a[144:147], v[200:203]
    ds_read_b128 v[236:239], v21 offset:3072
    v_mfma_f32_16x16x32_bf16 v[200:203], v[240:243], a[152:155], v[200:203]
    v_exp_f32 v39, v39
    v_mfma_f32_16x16x32_bf16 v[204:207], v[240:243], a[156:159], v[204:207]
    ds_read_b128 v[240:243], v21 offset:4096
    buffer_load_dwordx4 v20, s[16:19], s80 offen offset:1024 sc1 lds
    v_mfma_f32_16x16x32_bf16 v[204:207], v[244:247], a[148:151], v[204:207]
    v_exp_f32 v116, v116
    v_mfma_f32_16x16x32_bf16 v[204:207], v[248:251], a[140:143], v[204:207]
    ds_read_b128 v[244:247], v21 offset:7168
    v_mfma_f32_16x16x32_bf16 v[204:207], v[252:255], a[132:135], v[204:207]
    s_waitcnt lgkmcnt(4)
    v_exp_f32 v40, v40
    v_mfma_f32_16x16x32_bf16 v[208:211], v[224:227], a[128:131], v[208:211]
    ds_read_b128 v[248:251], v21 offset:10240
    buffer_load_dwordx4 v20, s[16:19], s80 offen offset:2048 sc1 lds
    v_mfma_f32_16x16x32_bf16 v[208:211], v[228:231], a[136:139], v[208:211]
    s_waitcnt lgkmcnt(3)
    v_exp_f32 v117, v117
    v_mfma_f32_16x16x32_bf16 v[208:211], v[232:235], a[144:147], v[208:211]
    ds_read_b128 v[252:255], v21 offset:13312
    v_mfma_f32_16x16x32_bf16 v[208:211], v[236:239], a[152:155], v[208:211]
    v_exp_f32 v41, v41
    v_mfma_f32_16x16x32_bf16 v[212:215], v[236:239], a[156:159], v[212:215]
    ds_read_b128 v[236:239], v21 offset:5120
    buffer_load_dwordx4 v20, s[16:19], s80 offen offset:3072 sc1 lds
    s_add_u32 s80, s80, 229376
    s_cmp_eq_u32 s80, 1835008
    s_cselect_b32 s80, 0, s80
    v_mfma_f32_16x16x32_bf16 v[212:215], v[232:235], a[148:151], v[212:215]
    s_add_u32 m0, s81, 81920
    v_exp_f32 v118, v118
    v_mfma_f32_16x16x32_bf16 v[212:215], v[228:231], a[140:143], v[212:215]
    ds_read_b128 v[232:235], v21 offset:8192
    v_mfma_f32_16x16x32_bf16 v[212:215], v[224:227], a[132:135], v[212:215]
    s_waitcnt lgkmcnt(4)
    v_exp_f32 v42, v42
    v_mfma_f32_16x16x32_bf16 v[192:195], v[240:243], a[160:163], v[192:195]
    ds_read_b128 v[228:231], v21 offset:11264
    buffer_load_dwordx4 v20, s[16:19], s80 offen sc1 lds
    v_mfma_f32_16x16x32_bf16 v[192:195], v[244:247], a[168:171], v[192:195]
    s_waitcnt lgkmcnt(3)
    v_exp_f32 v119, v119
    v_mfma_f32_16x16x32_bf16 v[192:195], v[248:251], a[176:179], v[192:195]
    ds_read_b128 v[224:227], v21 offset:14336
    v_mfma_f32_16x16x32_bf16 v[192:195], v[252:255], a[184:187], v[192:195]
    v_exp_f32 v43, v43
    v_mfma_f32_16x16x32_bf16 v[196:199], v[252:255], a[188:191], v[196:199]
    ds_read_b128 v[252:255], v21 offset:6144
    buffer_load_dwordx4 v20, s[16:19], s80 offen offset:1024 sc1 lds
    v_mfma_f32_16x16x32_bf16 v[196:199], v[248:251], a[180:183], v[196:199]
    v_exp_f32 v120, v120
    v_mfma_f32_16x16x32_bf16 v[196:199], v[244:247], a[172:175], v[196:199]
    ds_read_b128 v[248:251], v21 offset:9216
    v_mfma_f32_16x16x32_bf16 v[196:199], v[240:243], a[164:167], v[196:199]
    s_waitcnt lgkmcnt(4)
    v_exp_f32 v44, v44
    v_mfma_f32_16x16x32_bf16 v[200:203], v[236:239], a[160:163], v[200:203]
    ds_read_b128 v[244:247], v21 offset:12288
    buffer_load_dwordx4 v20, s[16:19], s80 offen offset:2048 sc1 lds
    v_mfma_f32_16x16x32_bf16 v[200:203], v[232:235], a[168:171], v[200:203]
    s_waitcnt lgkmcnt(3)
    v_exp_f32 v121, v121
    v_mfma_f32_16x16x32_bf16 v[200:203], v[228:231], a[176:179], v[200:203]
    ds_read_b128 v[240:243], v21 offset:15360
    v_mfma_f32_16x16x32_bf16 v[200:203], v[224:227], a[184:187], v[200:203]
    v_exp_f32 v45, v45
    v_mfma_f32_16x16x32_bf16 v[204:207], v[224:227], a[188:191], v[204:207]
    s_waitcnt vmcnt(21)
    s_barrier
    buffer_load_dwordx4 v20, s[16:19], s80 offen offset:3072 sc1 lds
    s_add_u32 s80, s80, 229376
    s_cmp_eq_u32 s80, 1835008
    s_cselect_b32 s80, 0, s80
    s_add_u32 m0, s81, 98304
    s_nop 0
    buffer_load_dwordx4 v20, s[16:19], s80 offen sc1 lds
    ds_read_b128 v[224:227], v21 offset:16384
    v_mfma_f32_16x16x32_bf16 v[204:207], v[228:231], a[180:183], v[204:207]
    v_exp_f32 v122, v122
    v_mfma_f32_16x16x32_bf16 v[204:207], v[232:235], a[172:175], v[204:207]
    ds_read_b128 v[228:231], v21 offset:19456
    v_mfma_f32_16x16x32_bf16 v[204:207], v[236:239], a[164:167], v[204:207]
    s_waitcnt lgkmcnt(4)
    v_exp_f32 v46, v46
    v_mfma_f32_16x16x32_bf16 v[208:211], v[252:255], a[160:163], v[208:211]
    ds_read_b128 v[232:235], v21 offset:22528
    buffer_load_dwordx4 v20, s[16:19], s80 offen offset:1024 sc1 lds
    v_mfma_f32_16x16x32_bf16 v[208:211], v[248:251], a[168:171], v[208:211]
    s_waitcnt lgkmcnt(3)
    v_exp_f32 v123, v123
    v_mfma_f32_16x16x32_bf16 v[208:211], v[244:247], a[176:179], v[208:211]
    ds_read_b128 v[236:239], v21 offset:25600
    v_mfma_f32_16x16x32_bf16 v[208:211], v[240:243], a[184:187], v[208:211]
    v_exp_f32 v47, v47
    v_mfma_f32_16x16x32_bf16 v[212:215], v[240:243], a[188:191], v[212:215]
    ds_read_b128 v[240:243], v21 offset:17408
    buffer_load_dwordx4 v20, s[16:19], s80 offen offset:2048 sc1 lds
    v_mfma_f32_16x16x32_bf16 v[212:215], v[244:247], a[180:183], v[212:215]
    v_exp_f32 v124, v124
    v_mfma_f32_16x16x32_bf16 v[212:215], v[248:251], a[172:175], v[212:215]
    ds_read_b128 v[244:247], v21 offset:20480
    v_mfma_f32_16x16x32_bf16 v[212:215], v[252:255], a[164:167], v[212:215]
    s_waitcnt lgkmcnt(4)
    v_exp_f32 v48, v48
    v_mfma_f32_16x16x32_bf16 v[192:195], v[224:227], a[192:195], v[192:195]
    ds_read_b128 v[248:251], v21 offset:23552
    buffer_load_dwordx4 v20, s[16:19], s80 offen offset:3072 sc1 lds
    s_add_u32 s80, s80, 229376
    s_cmp_eq_u32 s80, 1835008
    s_cselect_b32 s80, 0, s80
    v_mfma_f32_16x16x32_bf16 v[192:195], v[228:231], a[200:203], v[192:195]
    s_waitcnt lgkmcnt(3)
    s_add_u32 m0, s81, 114688
    v_mfma_f32_16x16x32_bf16 v[192:195], v[232:235], a[208:211], v[192:195]
    ds_read_b128 v[252:255], v21 offset:26624
    v_mfma_f32_16x16x32_bf16 v[192:195], v[236:239], a[216:219], v[192:195]
    v_exp_f32 v125, v125
    v_mfma_f32_16x16x32_bf16 v[196:199], v[236:239], a[220:223], v[196:199]
    ds_read_b128 v[236:239], v21 offset:18432
    buffer_load_dwordx4 v20, s[16:19], s80 offen sc1 lds
    v_mfma_f32_16x16x32_bf16 v[196:199], v[232:235], a[212:215], v[196:199]
    v_exp_f32 v49, v49
    v_mfma_f32_16x16x32_bf16 v[196:199], v[228:231], a[204:207], v[196:199]
    ds_read_b128 v[232:235], v21 offset:21504
    v_add_f32 v50, v112, v113
    v_mfma_f32_16x16x32_bf16 v[196:199], v[224:227], a[196:199], v[196:199]
    s_waitcnt lgkmcnt(4)
    v_add_f32 v52, v36, v37
    v_add_f32 v50, v50, v114
    v_mfma_f32_16x16x32_bf16 v[200:203], v[240:243], a[192:195], v[200:203]
    ds_read_b128 v[228:231], v21 offset:24576
    buffer_load_dwordx4 v20, s[16:19], s80 offen offset:1024 sc1 lds
    v_mfma_f32_16x16x32_bf16 v[200:203], v[244:247], a[200:203], v[200:203]
    s_waitcnt lgkmcnt(3)
    v_add_f32 v52, v52, v38
    v_add_f32 v50, v50, v115
    v_mfma_f32_16x16x32_bf16 v[200:203], v[248:251], a[208:211], v[200:203]
    ds_read_b128 v[224:227], v21 offset:27648
    v_add_f32 v52, v52, v39
    v_mfma_f32_16x16x32_bf16 v[200:203], v[252:255], a[216:219], v[200:203]
    v_add_f32 v50, v50, v116
    v_add_f32 v52, v52, v40
    v_mfma_f32_16x16x32_bf16 v[204:207], v[252:255], a[220:223], v[204:207]
    ds_read_b128 v[252:255], v4 offset:0
    buffer_load_dwordx4 v20, s[16:19], s80 offen offset:2048 sc1 lds
    v_mfma_f32_16x16x32_bf16 v[204:207], v[248:251], a[212:215], v[204:207]
    v_add_f32 v50, v50, v117
    v_add_f32 v52, v52, v41
    v_mfma_f32_16x16x32_bf16 v[204:207], v[244:247], a[204:207], v[204:207]
    ds_read_b128 v[248:251], v4 offset:3072
    v_add_f32 v50, v50, v118
    v_mfma_f32_16x16x32_bf16 v[204:207], v[240:243], a[196:199], v[204:207]
    s_waitcnt lgkmcnt(4)
    v_add_f32 v52, v52, v42
    v_add_f32 v50, v50, v119
    v_mfma_f32_16x16x32_bf16 v[208:211], v[236:239], a[192:195], v[208:211]
    ds_read_b128 v[244:247], v4 offset:6144
    buffer_load_dwordx4 v20, s[16:19], s80 offen offset:3072 sc1 lds
    v_mfma_f32_16x16x32_bf16 v[208:211], v[232:235], a[200:203], v[208:211]
    s_waitcnt lgkmcnt(3)
    v_add_f32 v52, v52, v43
    v_add_f32 v50, v50, v120
    v_mfma_f32_16x16x32_bf16 v[208:211], v[228:231], a[208:211], v[208:211]
    ds_read_b128 v[240:243], v4 offset:9216
    v_add_f32 v52, v52, v44
    v_mfma_f32_16x16x32_bf16 v[208:211], v[224:227], a[216:219], v[208:211]
    v_add_f32 v50, v50, v121
    v_add_f32 v52, v52, v45
    v_mfma_f32_16x16x32_bf16 v[212:215], v[224:227], a[220:223], v[212:215]
    ds_read_b128 v[224:227], v4 offset:1024
    v_add_f32 v50, v50, v122
    v_mfma_f32_16x16x32_bf16 v[212:215], v[228:231], a[212:215], v[212:215]
    v_add_f32 v52, v52, v46
    v_add_f32 v50, v50, v123
    v_mfma_f32_16x16x32_bf16 v[212:215], v[232:235], a[204:207], v[212:215]
    ds_read_b128 v[228:231], v4 offset:4096
    v_add_f32 v52, v52, v47
    v_mfma_f32_16x16x32_bf16 v[212:215], v[236:239], a[196:199], v[212:215]
    s_waitcnt lgkmcnt(4)
    v_add_f32 v50, v50, v124
    v_add_f32 v52, v52, v48
    v_mfma_f32_16x16x32_bf16 v[192:195], v[252:255], a[224:227], v[192:195]
    ds_read_b128 v[232:235], v4 offset:7168
    v_add_f32 v50, v50, v125
    v_mfma_f32_16x16x32_bf16 v[192:195], v[248:251], a[232:235], v[192:195]
    s_waitcnt lgkmcnt(3)
    v_add_f32 v52, v52, v49
    v_mfma_f32_16x16x32_bf16 v[192:195], v[244:247], a[240:243], v[192:195]
    ds_read_b128 v[236:239], v4 offset:10240
    v_permlane32_swap_b32 v50, v52
    v_mfma_f32_16x16x32_bf16 v[192:195], v[240:243], a[248:251], v[192:195]
    v_add_f32 v50, v50, v52
    v_mfma_f32_16x16x32_bf16 v[196:199], v[240:243], a[252:255], v[196:199]
    ds_read_b128 v[240:243], v4 offset:2048
    v_mfma_f32_16x16x32_bf16 v[196:199], v[244:247], a[244:247], v[196:199]
    v_rcp_f32 v50, v50
    v_mfma_f32_16x16x32_bf16 v[196:199], v[248:251], a[236:239], v[196:199]
    ds_read_b128 v[244:247], v4 offset:5120
    v_mov_b32 v52, v50
    v_mfma_f32_16x16x32_bf16 v[196:199], v[252:255], a[228:231], v[196:199]
    s_waitcnt lgkmcnt(4)
    v_permlane32_swap_b32 v50, v52
    v_mov_b32 v183, 0
    v_mfma_f32_16x16x32_bf16 v[200:203], v[224:227], a[224:227], v[200:203]
    ds_read_b128 v[248:251], v4 offset:8192
    buffer_load_dwordx4 v[132:135], v4, s[16:19], s83 offen offset:0 sc1
    v_mfma_f32_16x16x32_bf16 v[200:203], v[228:231], a[232:235], v[200:203]
    s_waitcnt lgkmcnt(3)
    v_mov_b32 v191, 0
    v_mul_f32 v112, v112, v50
    v_mfma_f32_16x16x32_bf16 v[200:203], v[232:235], a[240:243], v[200:203]
    ds_read_b128 v[252:255], v4 offset:11264
    v_mul_f32 v113, v113, v50
    v_mfma_f32_16x16x32_bf16 v[200:203], v[236:239], a[248:251], v[200:203]
    v_mul_f32 v114, v114, v50
    v_mul_f32 v115, v115, v50
    v_mfma_f32_16x16x32_bf16 v[204:207], v[236:239], a[252:255], v[204:207]
    s_waitcnt vmcnt(22)
    s_barrier
    buffer_load_dwordx4 v[136:139], v4, s[16:19], s83 offen offset:1024 sc1
    s_mul_i32 s49, s36, 28672
    s_add_u32 s49, s49, 0
    s_add_u32 m0, s81, 135168
    s_nop 0
    buffer_load_dwordx4 v55, s[24:27], s49 offen lds
    ds_read_b128 v[236:239], v4 offset:16384
    v_mfma_f32_16x16x32_bf16 v[204:207], v[232:235], a[244:247], v[204:207]
    v_mul_f32 v116, v116, v50
    v_mul_f32 v117, v117, v50
    v_mfma_f32_16x16x32_bf16 v[204:207], v[228:231], a[236:239], v[204:207]
    ds_read_b128 v[232:235], v4 offset:20480
    v_mul_f32 v118, v118, v50
    v_mfma_f32_16x16x32_bf16 v[204:207], v[224:227], a[228:231], v[204:207]
    s_waitcnt lgkmcnt(4)
    v_mul_f32 v119, v119, v50
    v_cvt_pk_bf16_f32 v176, v112, v113
    v_mfma_f32_16x16x32_bf16 v[208:211], v[240:243], a[224:227], v[208:211]
    ds_read_b128 v[228:231], v4 offset:24576
    buffer_load_dwordx4 v62, s[24:27], s49 offen offset:1024 lds
    v_mfma_f32_16x16x32_bf16 v[208:211], v[244:247], a[232:235], v[208:211]
    s_waitcnt lgkmcnt(3)
    v_cvt_pk_bf16_f32 v177, v114, v115
    v_cvt_pk_bf16_f32 v178, v116, v117
    v_mfma_f32_16x16x32_bf16 v[208:211], v[248:251], a[240:243], v[208:211]
    ds_read_b128 v[224:227], v4 offset:28672
    v_cvt_pk_bf16_f32 v179, v118, v119
    v_mfma_f32_16x16x32_bf16 v[208:211], v[252:255], a[248:251], v[208:211]
    v_mul_f32 v120, v120, v50
    v_mul_f32 v121, v121, v50
    v_mfma_f32_16x16x32_bf16 v[212:215], v[252:255], a[252:255], v[212:215]
    ds_read_b128 v[252:255], v4 offset:17408
    buffer_load_dwordx4 v63, s[24:27], s49 offen offset:2048 lds
    v_mfma_f32_16x16x32_bf16 v[212:215], v[248:251], a[244:247], v[212:215]
    v_mul_f32 v122, v122, v50
    v_mul_f32 v123, v123, v50
    v_mfma_f32_16x16x32_bf16 v[212:215], v[244:247], a[236:239], v[212:215]
    ds_read_b128 v[248:251], v4 offset:21504
    v_mul_f32 v124, v124, v50
    v_mfma_f32_16x16x32_bf16 v[212:215], v[240:243], a[228:231], v[212:215]
    s_waitcnt lgkmcnt(4)
    v_cvt_pk_bf16_f32 v64, v192, v193
    v_cvt_pk_bf16_f32 v65, v194, v195
    v_mfma_f32_16x16x32_bf16 v[144:147], v[236:239], a[0:3], v[168:171]
    ds_read_b128 v[244:247], v4 offset:25600
    buffer_load_dwordx4 v18, s[24:27], s49 offen offset:3072 lds
    s_mul_i32 s49, s36, 21504
    s_add_u32 s49, s49, 114688
    s_add_u32 m0, s76, 151552
    v_mfma_f32_16x16x32_bf16 v[144:147], v[232:235], a[8:11], v[144:147]
    s_waitcnt lgkmcnt(3)
    v_cvt_pk_bf16_f32 v66, v208, v209
    v_cvt_pk_bf16_f32 v68, v196, v197
    v_mfma_f32_16x16x32_bf16 v[144:147], v[228:231], a[16:19], v[144:147]
    ds_read_b128 v[240:243], v4 offset:29696
    v_cvt_pk_bf16_f32 v69, v198, v199
    v_mfma_f32_16x16x32_bf16 v[144:147], v[224:227], a[24:27], v[144:147]
    v_cvt_pk_bf16_f32 v70, v210, v211
    v_cvt_pk_bf16_f32 v72, v200, v201
    v_mfma_f32_16x16x32_bf16 v[148:151], v[236:239], a[4:7], v[172:175]
    ds_read_b128 v[236:239], v4 offset:18432
    buffer_load_dwordx4 v55, s[24:27], s49 offen lds
    v_mfma_f32_16x16x32_bf16 v[148:151], v[232:235], a[12:15], v[148:151]
    v_cvt_pk_bf16_f32 v73, v202, v203
    v_cvt_pk_bf16_f32 v74, v212, v213
    v_mfma_f32_16x16x32_bf16 v[148:151], v[228:231], a[20:23], v[148:151]
    ds_read_b128 v[232:235], v4 offset:22528
    v_cvt_pk_bf16_f32 v76, v204, v205
    v_mfma_f32_16x16x32_bf16 v[148:151], v[224:227], a[28:31], v[148:151]
    s_waitcnt lgkmcnt(4)
    v_cvt_pk_bf16_f32 v77, v206, v207
    v_cvt_pk_bf16_f32 v78, v214, v215
    v_mfma_f32_16x16x32_bf16 v[152:155], v[252:255], a[0:3], v[168:171]
    ds_read_b128 v[228:231], v4 offset:26624
    buffer_store_dwordx4 v[64:67], v4, s[16:19], s84 offen offset:0 sc1
    v_mfma_f32_16x16x32_bf16 v[152:155], v[248:251], a[8:11], v[152:155]
    s_waitcnt lgkmcnt(3)
    v_mul_f32 v125, v125, v50
    v_cvt_pk_bf16_f32 v180, v120, v121
    v_mfma_f32_16x16x32_bf16 v[152:155], v[244:247], a[16:19], v[152:155]
    ds_read_b128 v[224:227], v4 offset:30720
    buffer_store_dwordx4 v[68:71], v4, s[16:19], s84 offen offset:1024 sc1
    v_mfma_f32_16x16x32_bf16 v[152:155], v[240:243], a[24:27], v[152:155]
    v_cvt_pk_bf16_f32 v181, v122, v123
    v_cvt_pk_bf16_f32 v182, v124, v125
    v_mfma_f32_16x16x32_bf16 v[156:159], v[252:255], a[4:7], v[172:175]
    ds_read_b128 v[252:255], v4 offset:19456
    buffer_store_dwordx4 v[72:75], v4, s[16:19], s84 offen offset:2048 sc1
    v_mfma_f32_16x16x32_bf16 v[156:159], v[248:251], a[12:15], v[156:159]
    v_mul_f32 v36, v36, v52
    v_mul_f32 v37, v37, v52
    v_mfma_f32_16x16x32_bf16 v[156:159], v[244:247], a[20:23], v[156:159]
    ds_read_b128 v[248:251], v4 offset:23552
    buffer_store_dwordx4 v[76:79], v4, s[16:19], s84 offen offset:3072 sc1
    v_mfma_f32_16x16x32_bf16 v[156:159], v[240:243], a[28:31], v[156:159]
    s_waitcnt lgkmcnt(4)
    v_mul_f32 v38, v38, v52
    v_mul_f32 v39, v39, v52
    v_mfma_f32_16x16x32_bf16 v[160:163], v[236:239], a[0:3], v[168:171]
    ds_read_b128 v[244:247], v4 offset:27648
    buffer_load_dwordx4 v62, s[24:27], s49 offen offset:1024 lds
    v_mfma_f32_16x16x32_bf16 v[160:163], v[232:235], a[8:11], v[160:163]
    s_waitcnt lgkmcnt(3)
    v_mul_f32 v40, v40, v52
    v_mul_f32 v41, v41, v52
    v_mfma_f32_16x16x32_bf16 v[160:163], v[228:231], a[16:19], v[160:163]
    ds_read_b128 v[240:243], v4 offset:31744
    v_mul_f32 v42, v42, v52
    v_mfma_f32_16x16x32_bf16 v[160:163], v[224:227], a[24:27], v[160:163]
    v_mul_f32 v43, v43, v52
    v_cvt_pk_bf16_f32 v184, v36, v37
    v_mfma_f32_16x16x32_bf16 v[164:167], v[236:239], a[4:7], v[172:175]
    ds_read_b128 v[236:239], v4 offset:32768
    buffer_load_dwordx4 v63, s[24:27], s49 offen offset:2048 lds
    v_mfma_f32_16x16x32_bf16 v[164:167], v[232:235], a[12:15], v[164:167]
    v_cvt_pk_bf16_f32 v185, v38, v39
    v_cvt_pk_bf16_f32 v186, v40, v41
    v_mfma_f32_16x16x32_bf16 v[164:167], v[228:231], a[20:23], v[164:167]
    ds_read_b128 v[232:235], v4 offset:36864
    v_cvt_pk_bf16_f32 v187, v42, v43
    v_mfma_f32_16x16x32_bf16 v[164:167], v[224:227], a[28:31], v[164:167]
    s_waitcnt lgkmcnt(4)
    v_mul_f32 v44, v44, v52
    v_mul_f32 v45, v45, v52
    v_mfma_f32_16x16x32_bf16 v[168:171], v[252:255], a[0:3], v[168:171]
    ds_read_b128 v[228:231], v4 offset:40960
    v_mul_f32 v46, v46, v52
    v_mfma_f32_16x16x32_bf16 v[168:171], v[248:251], a[8:11], v[168:171]
    s_waitcnt lgkmcnt(3)
    v_mul_f32 v47, v47, v52
    v_mul_f32 v48, v48, v52
    v_mfma_f32_16x16x32_bf16 v[168:171], v[244:247], a[16:19], v[168:171]
    ds_read_b128 v[224:227], v4 offset:45056
    v_mul_f32 v49, v49, v52
    v_mfma_f32_16x16x32_bf16 v[168:171], v[240:243], a[24:27], v[168:171]
    v_cvt_pk_bf16_f32 v188, v44, v45
    s_waitcnt vmcnt(11)
    v_min3_u32 v140, v133, v135, v137
    v_mfma_f32_16x16x32_bf16 v[172:175], v[240:243], a[28:31], v[172:175]
    ds_read_b128 v[240:243], v4 offset:33792
    v_max3_u32 v141, v133, v135, v137
    v_mfma_f32_16x16x32_bf16 v[172:175], v[244:247], a[20:23], v[172:175]
    v_min3_u32 v140, v140, v139, v139
    v_max3_u32 v141, v141, v139, v139
    v_mfma_f32_16x16x32_bf16 v[172:175], v[248:251], a[12:15], v[172:175]
    ds_read_b128 v[244:247], v4 offset:37888
    v_xor_b32 v140, s52, v140
    v_mfma_f32_16x16x32_bf16 v[172:175], v[252:255], a[4:7], v[172:175]
    s_waitcnt lgkmcnt(4)
    v_xor_b32 v141, s52, v141
    v_or_b32 v140, v140, v141
    v_mfma_f32_16x16x32_bf16 v[144:147], v[236:239], a[32:35], v[144:147]
    ds_read_b128 v[248:251], v4 offset:41984
    v_cvt_pk_bf16_f32 v189, v46, v47
    v_mfma_f32_16x16x32_bf16 v[144:147], v[232:235], a[40:43], v[144:147]
    s_waitcnt lgkmcnt(3)
    v_cmp_ne_u32 s[54:55], 0, v140
    s_nop 0
    s_cmp_eq_u64 s[54:55], 0
    s_cbranch_scc0 Lslow_11
Lback_12:
    s_nop 0
    v_mfma_f32_16x16x32_bf16 v[144:147], v[228:231], a[48:51], v[144:147]
    ds_read_b128 v[252:255], v4 offset:46080
    v_cvt_pk_bf16_f32 v190, v48, v49
    v_mfma_f32_16x16x32_bf16 v[144:147], v[224:227], a[56:59], v[144:147]
    ds_write2_b32 v29, v132, v134 offset0:0 offset1:1
    v_mfma_f32_16x16x32_bf16 v[148:151], v[224:227], a[60:63], v[148:151]
    ds_read_b128 v[224:227], v4 offset:34816
    v_bfe_u32 v37, v0, 3, 2
    v_mfma_f32_16x16x32_bf16 v[148:151], v[228:231], a[52:55], v[148:151]
    ds_write2_b32 v29, v136, v138 offset0:2 offset1:3
    v_mfma_f32_16x16x32_bf16 v[148:151], v[232:235], a[44:47], v[148:151]
    ds_read_b128 v[228:231], v4 offset:38912
    v_and_b32 v39, 3, v0
    v_mfma_f32_16x16x32_bf16 v[148:151], v[236:239], a[36:39], v[148:151]
    s_waitcnt lgkmcnt(6)
    v_lshlrev_b32 v39, 3, v39
    v_lshl_add_u32 v39, v37, 5, v39
    v_mfma_f32_16x16x32_bf16 v[152:155], v[240:243], a[32:35], v[152:155]
    ds_read_b128 v[232:235], v4 offset:43008
    v_bfe_u32 v37, v0, 2, 3
    v_mfma_f32_16x16x32_bf16 v[152:155], v[244:247], a[40:43], v[152:155]
    s_waitcnt lgkmcnt(5)
    v_lshl_add_u32 v39, v37, 7, v39
    v_lshrrev_b32 v38, 5, v0
    v_mfma_f32_16x16x32_bf16 v[152:155], v[248:251], a[48:51], v[152:155]
    ds_read_b128 v[236:239], v4 offset:47104
    v_lshl_add_u32 v36, v38, 11, v39
    v_mfma_f32_16x16x32_bf16 v[152:155], v[252:255], a[56:59], v[152:155]
    v_lshl_add_u32 v40, v38, 10, v39
    s_waitcnt lgkmcnt(3)
    s_barrier
    v_mfma_f32_16x16x32_bf16 v[156:159], v[252:255], a[60:63], v[156:159]
    ds_read_b128 v[252:255], v4 offset:35840
    ds_read_b128 v[128:131], v34 offset:0
    v_mfma_f32_16x16x32_bf16 v[156:159], v[248:251], a[52:55], v[156:159]
    ds_read_b128 v[132:135], v34 offset:1024
    ds_read_b128 v[136:139], v34 offset:2048
    v_mfma_f32_16x16x32_bf16 v[156:159], v[244:247], a[44:47], v[156:159]
    ds_read_b128 v[248:251], v4 offset:39936
    ds_read_b128 v[140:143], v34 offset:3072
    v_mfma_f32_16x16x32_bf16 v[156:159], v[240:243], a[36:39], v[156:159]
    s_waitcnt lgkmcnt(8)
    v_bfe_u32 v29, v0, 4, 1
    v_lshlrev_b32 v29, 14, v29
    v_mfma_f32_16x16x32_bf16 v[160:163], v[224:227], a[32:35], v[160:163]
    ds_read_b128 v[244:247], v4 offset:44032
    v_lshrrev_b32 v34, 5, v0
    v_mfma_f32_16x16x32_bf16 v[160:163], v[228:231], a[40:43], v[160:163]
    s_waitcnt lgkmcnt(7)
    v_lshl_add_u32 v29, v34, 8, v29
    v_and_b32 v34, 15, v0
    v_mfma_f32_16x16x32_bf16 v[160:163], v[232:235], a[48:51], v[160:163]
    ds_read_b128 v[240:243], v4 offset:48128
    v_lshl_add_u32 v29, v34, 4, v29
    v_mfma_f32_16x16x32_bf16 v[160:163], v[236:239], a[56:59], v[160:163]
    s_lshl_b32 s88, s44, 15
    s_lshl_b32 s89, s40, 10
    s_add_u32 s88, s88, s89
    v_mfma_f32_16x16x32_bf16 v[164:167], v[236:239], a[60:63], v[164:167]
    s_barrier
    ds_read_b128 v[236:239], v4 offset:49152
    s_add_u32 s80, s80, 229376
    s_cmp_eq_u32 s80, 1835008
    s_cselect_b32 s80, 0, s80
    s_add_u32 m0, s81, 0
    s_nop 0
    buffer_load_dwordx4 v20, s[16:19], s80 offen sc1 lds
    s_add_u32 s88, s88, 15204352
    v_mfma_f32_16x16x32_bf16 v[164:167], v[232:235], a[52:55], v[164:167]
    s_waitcnt lgkmcnt(7)
    v_mfma_f32_32x32x16_bf16 v[112:127], v[128:131], v[176:179], 0
    s_waitcnt lgkmcnt(6)
    v_mfma_f32_32x32x16_bf16 v[112:127], v[132:135], v[180:183], v[112:127]
    s_waitcnt lgkmcnt(5)
    v_mfma_f32_32x32x16_bf16 v[112:127], v[136:139], v[184:187], v[112:127]
    buffer_load_dwordx4 v20, s[16:19], s80 offen offset:1024 sc1 lds
    s_waitcnt lgkmcnt(3)
    v_mfma_f32_32x32x16_bf16 v[112:127], v[140:143], v[188:191], v[112:127]
    v_add_u32 v40, 135168, v40
    v_xor_b32 v37, 32, v36
    v_xor_b32 v38, 64, v36
    v_xor_b32 v39, 96, v36
    v_xor_b32 v41, 32, v40
    v_xor_b32 v42, 64, v40
    v_mfma_f32_16x16x32_bf16 v[164:167], v[228:231], a[44:47], v[164:167]
    ds_read_b128 v[232:235], v4 offset:53248
    buffer_load_dwordx4 v20, s[16:19], s80 offen offset:2048 sc1 lds
    v_mfma_f32_16x16x32_bf16 v[164:167], v[224:227], a[36:39], v[164:167]
    v_xor_b32 v43, 96, v40
    s_lshl_b32 s63, s37, 3
    v_mfma_f32_16x16x32_bf16 v[168:171], v[252:255], a[32:35], v[168:171]
    s_lshl_b32 s93, s38, 2
    ds_read_b128 v[228:231], v4 offset:57344
    v_mov_b32 v59, v124
    v_mfma_f32_16x16x32_bf16 v[168:171], v[248:251], a[40:43], v[168:171]
    s_waitcnt lgkmcnt(3)
    v_mov_b32 v58, v124
    s_add_u32 s63, s63, s93
    v_mfma_f32_16x16x32_bf16 v[168:171], v[244:247], a[48:51], v[168:171]
    s_add_u32 s63, s63, s36
    ds_read_b128 v[224:227], v4 offset:61440
    buffer_load_dwordx4 v20, s[16:19], s80 offen offset:3072 sc1 lds
    s_add_u32 m0, s81, 16384
    s_add_u32 s49, s36, 0
    s_mul_i32 s49, s49, 25088
    v_mfma_f32_16x16x32_bf16 v[168:171], v[240:243], a[56:59], v[168:171]
    s_lshr_b32 s93, s63, 1
    v_permlane32_swap_b32 v59, v58
    v_add_f32 v58, 0x358637bd, v58
    v_mfma_f32_16x16x32_bf16 v[172:175], v[240:243], a[60:63], v[172:175]
    s_lshl_b32 s58, s93, 8
    ds_read_b128 v[240:243], v4 offset:50176
    s_add_u32 s58, s58, 32768
    v_mfma_f32_16x16x32_bf16 v[172:175], v[244:247], a[52:55], v[172:175]
    s_lshl_b32 s93, s63, 14
    v_rcp_f32 v58, v58
    v_mfma_f32_16x16x32_bf16 v[172:175], v[248:251], a[44:47], v[172:175]
    s_add_u32 s93, s93, 15204352
    ds_read_b128 v[244:247], v4 offset:54272
    buffer_load_dwordx4 v55, s[20:23], s49 offen lds
    s_mul_i32 s94, s63, 28672
    s_add_u32 s94, s94, 17301504
    v_mfma_f32_16x16x32_bf16 v[172:175], v[252:255], a[36:39], v[172:175]
    s_waitcnt lgkmcnt(4)
    v_mul_f32 v58, v58, v54
    v_mul_f32 v112, v112, v58
    v_mfma_f32_16x16x32_bf16 v[144:147], v[236:239], a[64:67], v[144:147]
    s_mul_i32 s61, s36, 2304
    ds_read_b128 v[248:251], v4 offset:58368
    v_mul_f32 v113, v113, v58
    v_mfma_f32_16x16x32_bf16 v[144:147], v[232:235], a[72:75], v[144:147]
    s_waitcnt lgkmcnt(3)
    v_mul_f32 v114, v114, v58
    v_mul_f32 v115, v115, v58
    v_mfma_f32_16x16x32_bf16 v[144:147], v[228:231], a[80:83], v[144:147]
    s_add_u32 s61, s61, 49152
    ds_read_b128 v[252:255], v4 offset:62464
    buffer_load_dwordx4 v62, s[20:23], s49 offen offset:1024 lds
    v_mfma_f32_16x16x32_bf16 v[144:147], v[224:227], a[88:91], v[144:147]
    v_mul_f32 v116, v116, v58
    v_mul_f32 v117, v117, v58
    v_mfma_f32_16x16x32_bf16 v[148:151], v[224:227], a[92:95], v[148:151]
    ds_read_b128 v[224:227], v4 offset:51200
    v_mul_f32 v118, v118, v58
    v_mfma_f32_16x16x32_bf16 v[148:151], v[228:231], a[84:87], v[148:151]
    v_mul_f32 v119, v119, v58
    v_mul_f32 v120, v120, v58
    v_mfma_f32_16x16x32_bf16 v[148:151], v[232:235], a[76:79], v[148:151]
    ds_read_b128 v[228:231], v4 offset:55296
    buffer_load_dwordx4 v63, s[20:23], s49 offen offset:2048 lds
    v_mfma_f32_16x16x32_bf16 v[148:151], v[236:239], a[68:71], v[148:151]
    s_waitcnt lgkmcnt(4)
    v_mul_f32 v121, v121, v58
    v_mul_f32 v122, v122, v58
    v_mfma_f32_16x16x32_bf16 v[152:155], v[240:243], a[64:67], v[152:155]
    ds_read_b128 v[232:235], v4 offset:59392
    v_mul_f32 v123, v123, v58
    v_mfma_f32_16x16x32_bf16 v[152:155], v[244:247], a[72:75], v[152:155]
    s_waitcnt lgkmcnt(3)
    v_mul_f32 v124, v124, v58
    v_mul_f32 v125, v125, v58
    v_mfma_f32_16x16x32_bf16 v[152:155], v[248:251], a[80:83], v[152:155]
    ds_read_b128 v[236:239], v4 offset:63488
    v_mul_f32 v126, v126, v58
    v_mfma_f32_16x16x32_bf16 v[152:155], v[252:255], a[88:91], v[152:155]
    v_mul_f32 v127, v127, v58
    v_cvt_pk_bf16_f32 v128, v112, v113
    v_mfma_f32_16x16x32_bf16 v[156:159], v[252:255], a[92:95], v[156:159]
    ds_read_b128 v[252:255], v4 offset:52224
    v_cvt_pk_bf16_f32 v129, v114, v115
    v_mfma_f32_16x16x32_bf16 v[156:159], v[248:251], a[84:87], v[156:159]
    v_cvt_pk_bf16_f32 v130, v116, v117
    v_cvt_pk_bf16_f32 v131, v118, v119
    v_mfma_f32_16x16x32_bf16 v[156:159], v[244:247], a[76:79], v[156:159]
    ds_read_b128 v[248:251], v4 offset:56320
    v_cvt_pk_bf16_f32 v132, v120, v121
    v_mfma_f32_16x16x32_bf16 v[156:159], v[240:243], a[68:71], v[156:159]
    s_waitcnt lgkmcnt(4)
    v_cvt_pk_bf16_f32 v133, v122, v123
    v_cvt_pk_bf16_f32 v134, v124, v125
    v_mfma_f32_16x16x32_bf16 v[160:163], v[224:227], a[64:67], v[160:163]
    ds_read_b128 v[244:247], v4 offset:60416
    v_cvt_pk_bf16_f32 v135, v126, v127
    v_mfma_f32_16x16x32_bf16 v[160:163], v[228:231], a[72:75], v[160:163]
    s_waitcnt lgkmcnt(3)
    v_cndmask_b32_e64 v134, v134, 0, s[68:69]
    v_cndmask_b32_e64 v135, v135, 0, s[68:69]
    v_mfma_f32_16x16x32_bf16 v[160:163], v[232:235], a[80:83], v[160:163]
    ds_read_b128 v[240:243], v4 offset:64512
    v_and_b32 v44, 15, v0
    v_mfma_f32_16x16x32_bf16 v[160:163], v[236:239], a[88:91], v[160:163]
    v_mul_u32_u24 v44, 144, v44
    v_lshl_add_u32 v44, v3, 3, v44
    v_mfma_f32_16x16x32_bf16 v[164:167], v[236:239], a[92:95], v[164:167]
    ds_read_b128 v[236:239], v22 offset:0
    v_add_u32 v44, s61, v44
    v_mfma_f32_16x16x32_bf16 v[164:167], v[232:235], a[84:87], v[164:167]
    v_mul_u32_u24 v45, 144, v1
    v_lshl_add_u32 v45, v2, 4, v45
    v_mfma_f32_16x16x32_bf16 v[164:167], v[228:231], a[76:79], v[164:167]
    ds_read_b128 v[232:235], v22 offset:4096
    v_add_u32 v45, s61, v45
    v_mfma_f32_16x16x32_bf16 v[164:167], v[224:227], a[68:71], v[164:167]
    s_waitcnt lgkmcnt(4)
    v_mul_u32_u24 v46, 896, v1
    v_lshl_add_u32 v46, v2, 4, v46
    v_mfma_f32_16x16x32_bf16 v[168:171], v[252:255], a[64:67], v[168:171]
    s_mul_i32 s61, s63, 14336
    ds_read_b128 v[228:231], v22 offset:8192
    s_lshl_b32 s62, s39, 7
    v_mfma_f32_16x16x32_bf16 v[168:171], v[248:251], a[72:75], v[168:171]
    s_waitcnt lgkmcnt(3)
    s_add_u32 s61, s61, s62
    s_add_u32 s62, s61, 7168
    v_mfma_f32_16x16x32_bf16 v[168:171], v[244:247], a[80:83], v[168:171]
    ds_read_b128 v[224:227], v22 offset:12288
    buffer_store_dwordx4 v[128:131], v29, s[16:19], s88 offen offset:0 sc1
    v_mfma_f32_16x16x32_bf16 v[168:171], v[240:243], a[88:91], v[168:171]
    v_mfma_f32_16x16x32_bf16 v[172:175], v[240:243], a[92:95], v[172:175]
    ds_read_b128 v[240:243], v22 offset:1024
    buffer_store_dwordx4 v[132:135], v29, s[16:19], s88 offen offset:512 sc1
    v_mfma_f32_16x16x32_bf16 v[172:175], v[244:247], a[84:87], v[172:175]
    v_mfma_f32_16x16x32_bf16 v[172:175], v[248:251], a[76:79], v[172:175]
    ds_read_b128 v[244:247], v22 offset:5120
    buffer_load_dwordx4 v18, s[20:23], s49 offen offset:3072 lds
    v_mfma_f32_16x16x32_bf16 v[172:175], v[252:255], a[68:71], v[172:175]
    s_waitcnt lgkmcnt(4)
    v_mfma_f32_16x16x32_bf16 v[144:147], v[236:239], a[96:99], v[144:147]
    ds_read_b128 v[248:251], v22 offset:9216
    v_mfma_f32_16x16x32_bf16 v[144:147], v[232:235], a[104:107], v[144:147]
    s_waitcnt lgkmcnt(3)
    v_mfma_f32_16x16x32_bf16 v[144:147], v[228:231], a[112:115], v[144:147]
    ds_read_b128 v[252:255], v22 offset:13312
    v_mfma_f32_16x16x32_bf16 v[144:147], v[224:227], a[120:123], v[144:147]
    v_mfma_f32_16x16x32_bf16 v[148:151], v[224:227], a[124:127], v[148:151]
    ds_read_b128 v[224:227], v22 offset:2048
    v_mfma_f32_16x16x32_bf16 v[148:151], v[228:231], a[116:119], v[148:151]
    v_mfma_f32_16x16x32_bf16 v[148:151], v[232:235], a[108:111], v[148:151]
    ds_read_b128 v[228:231], v22 offset:6144
    v_mfma_f32_16x16x32_bf16 v[148:151], v[236:239], a[100:103], v[148:151]
    s_waitcnt lgkmcnt(4)
    v_mfma_f32_16x16x32_bf16 v[152:155], v[240:243], a[96:99], v[152:155]
    ds_read_b128 v[232:235], v22 offset:10240
    v_mfma_f32_16x16x32_bf16 v[152:155], v[244:247], a[104:107], v[152:155]
    s_waitcnt lgkmcnt(3)
    v_mfma_f32_16x16x32_bf16 v[152:155], v[248:251], a[112:115], v[152:155]
    ds_read_b128 v[236:239], v22 offset:14336
    v_mfma_f32_16x16x32_bf16 v[152:155], v[252:255], a[120:123], v[152:155]
    v_mfma_f32_16x16x32_bf16 v[156:159], v[252:255], a[124:127], v[156:159]
    ds_read_b128 v[252:255], v22 offset:3072
    v_mfma_f32_16x16x32_bf16 v[156:159], v[248:251], a[116:119], v[156:159]
    v_mfma_f32_16x16x32_bf16 v[156:159], v[244:247], a[108:111], v[156:159]
    ds_read_b128 v[248:251], v22 offset:7168
    v_mfma_f32_16x16x32_bf16 v[156:159], v[240:243], a[100:103], v[156:159]
    s_waitcnt lgkmcnt(4)
    buffer_load_dwordx4 v[192:195], v4, s[16:19], s86 offen offset:0 sc1
    v_mfma_f32_16x16x32_bf16 v[160:163], v[224:227], a[96:99], v[160:163]
    ds_read_b128 v[244:247], v22 offset:11264
    v_mfma_f32_16x16x32_bf16 v[160:163], v[228:231], a[104:107], v[160:163]
    s_waitcnt lgkmcnt(3)
    v_mfma_f32_16x16x32_bf16 v[160:163], v[232:235], a[112:115], v[160:163]
    ds_read_b128 v[240:243], v22 offset:15360
    v_mfma_f32_16x16x32_bf16 v[160:163], v[236:239], a[120:123], v[160:163]
    v_mfma_f32_16x16x32_bf16 v[164:167], v[236:239], a[124:127], v[164:167]
    s_barrier
    ds_read_b128 v[236:239], v22 offset:16384
    buffer_load_dwordx4 v[196:199], v4, s[16:19], s86 offen offset:1024 sc1
    v_mfma_f32_16x16x32_bf16 v[164:167], v[232:235], a[116:119], v[164:167]
    v_mfma_f32_16x16x32_bf16 v[164:167], v[228:231], a[108:111], v[164:167]
    ds_read_b128 v[232:235], v22 offset:20480
    v_mfma_f32_16x16x32_bf16 v[164:167], v[224:227], a[100:103], v[164:167]
    s_waitcnt lgkmcnt(4)
    v_mfma_f32_16x16x32_bf16 v[168:171], v[252:255], a[96:99], v[168:171]
    ds_read_b128 v[228:231], v22 offset:24576
    v_mfma_f32_16x16x32_bf16 v[168:171], v[248:251], a[104:107], v[168:171]
    s_waitcnt lgkmcnt(3)
    buffer_load_dwordx4 v[200:203], v4, s[16:19], s86 offen offset:2048 sc1
    v_mfma_f32_16x16x32_bf16 v[168:171], v[244:247], a[112:115], v[168:171]
    ds_read_b128 v[224:227], v22 offset:28672
    v_mfma_f32_16x16x32_bf16 v[168:171], v[240:243], a[120:123], v[168:171]
    v_mfma_f32_16x16x32_bf16 v[172:175], v[240:243], a[124:127], v[172:175]
    ds_read_b128 v[240:243], v22 offset:17408
    v_mfma_f32_16x16x32_bf16 v[172:175], v[244:247], a[116:119], v[172:175]
    v_mfma_f32_16x16x32_bf16 v[172:175], v[248:251], a[108:111], v[172:175]
    ds_read_b128 v[244:247], v22 offset:21504
    buffer_load_dwordx4 v[204:207], v4, s[16:19], s86 offen offset:3072 sc1
    s_add_u32 m0, s81, 32768
    s_add_u32 s49, s36, 4
    s_mul_i32 s49, s49, 25088
    v_mfma_f32_16x16x32_bf16 v[172:175], v[252:255], a[100:103], v[172:175]
    s_waitcnt lgkmcnt(4)
    v_mfma_f32_16x16x32_bf16 v[144:147], v[236:239], a[128:131], v[144:147]
    ds_read_b128 v[248:251], v22 offset:25600
    v_mfma_f32_16x16x32_bf16 v[144:147], v[232:235], a[136:139], v[144:147]
    s_waitcnt lgkmcnt(3)
    v_mfma_f32_16x16x32_bf16 v[144:147], v[228:231], a[144:147], v[144:147]
    ds_read_b128 v[252:255], v22 offset:29696
    buffer_load_dwordx4 v55, s[20:23], s49 offen lds
    v_mfma_f32_16x16x32_bf16 v[144:147], v[224:227], a[152:155], v[144:147]
    v_mfma_f32_16x16x32_bf16 v[148:151], v[224:227], a[156:159], v[148:151]
    ds_read_b128 v[224:227], v22 offset:18432
    v_mfma_f32_16x16x32_bf16 v[148:151], v[228:231], a[148:151], v[148:151]
    v_mfma_f32_16x16x32_bf16 v[148:151], v[232:235], a[140:143], v[148:151]
    ds_read_b128 v[228:231], v22 offset:22528
    buffer_load_dwordx4 v62, s[20:23], s49 offen offset:1024 lds
    v_mfma_f32_16x16x32_bf16 v[148:151], v[236:239], a[132:135], v[148:151]
    s_waitcnt lgkmcnt(4)
    v_mfma_f32_16x16x32_bf16 v[152:155], v[240:243], a[128:131], v[152:155]
    ds_read_b128 v[232:235], v22 offset:26624
    v_mfma_f32_16x16x32_bf16 v[152:155], v[244:247], a[136:139], v[152:155]
    s_waitcnt lgkmcnt(3)
    v_mfma_f32_16x16x32_bf16 v[152:155], v[248:251], a[144:147], v[152:155]
    ds_read_b128 v[236:239], v22 offset:30720
    buffer_load_dwordx4 v63, s[20:23], s49 offen offset:2048 lds
    v_mfma_f32_16x16x32_bf16 v[152:155], v[252:255], a[152:155], v[152:155]
    v_mfma_f32_16x16x32_bf16 v[156:159], v[252:255], a[156:159], v[156:159]
    ds_read_b128 v[252:255], v22 offset:19456
    v_mfma_f32_16x16x32_bf16 v[156:159], v[248:251], a[148:151], v[156:159]
    v_mfma_f32_16x16x32_bf16 v[156:159], v[244:247], a[140:143], v[156:159]
    ds_read_b128 v[248:251], v22 offset:23552
    buffer_load_dwordx4 v18, s[20:23], s49 offen offset:3072 lds
    s_add_u32 m0, s81, 49152
    s_add_u32 s49, s36, 8
    s_mul_i32 s49, s49, 25088
    v_mfma_f32_16x16x32_bf16 v[156:159], v[240:243], a[132:135], v[156:159]
    s_waitcnt lgkmcnt(4)
    v_mfma_f32_16x16x32_bf16 v[160:163], v[224:227], a[128:131], v[160:163]
    ds_read_b128 v[244:247], v22 offset:27648
    v_mfma_f32_16x16x32_bf16 v[160:163], v[228:231], a[136:139], v[160:163]
    s_waitcnt lgkmcnt(3)
    v_mfma_f32_16x16x32_bf16 v[160:163], v[232:235], a[144:147], v[160:163]
    ds_read_b128 v[240:243], v22 offset:31744
    v_mfma_f32_16x16x32_bf16 v[160:163], v[236:239], a[152:155], v[160:163]
    v_mfma_f32_16x16x32_bf16 v[164:167], v[236:239], a[156:159], v[164:167]
    s_barrier
    ds_read_b128 v[236:239], v22 offset:32768
    v_mfma_f32_16x16x32_bf16 v[164:167], v[232:235], a[148:151], v[164:167]
    v_mfma_f32_16x16x32_bf16 v[164:167], v[228:231], a[140:143], v[164:167]
    ds_read_b128 v[232:235], v22 offset:36864
    v_mfma_f32_16x16x32_bf16 v[164:167], v[224:227], a[132:135], v[164:167]
    s_waitcnt lgkmcnt(4)
    v_mfma_f32_16x16x32_bf16 v[168:171], v[252:255], a[128:131], v[168:171]
    ds_read_b128 v[228:231], v22 offset:40960
    v_mfma_f32_16x16x32_bf16 v[168:171], v[248:251], a[136:139], v[168:171]
    s_waitcnt lgkmcnt(3)
    v_mfma_f32_16x16x32_bf16 v[168:171], v[244:247], a[144:147], v[168:171]
    ds_read_b128 v[224:227], v22 offset:45056
    v_mfma_f32_16x16x32_bf16 v[168:171], v[240:243], a[152:155], v[168:171]
    v_mfma_f32_16x16x32_bf16 v[172:175], v[240:243], a[156:159], v[172:175]
    ds_read_b128 v[240:243], v22 offset:33792
    v_mfma_f32_16x16x32_bf16 v[172:175], v[244:247], a[148:151], v[172:175]
    v_mfma_f32_16x16x32_bf16 v[172:175], v[248:251], a[140:143], v[172:175]
    ds_read_b128 v[244:247], v22 offset:37888
    v_mfma_f32_16x16x32_bf16 v[172:175], v[252:255], a[132:135], v[172:175]
    s_waitcnt lgkmcnt(4)
    v_mfma_f32_16x16x32_bf16 v[144:147], v[236:239], a[160:163], v[144:147]
    ds_read_b128 v[248:251], v22 offset:41984
    v_mfma_f32_16x16x32_bf16 v[144:147], v[232:235], a[168:171], v[144:147]
    s_waitcnt lgkmcnt(3)
    buffer_load_dwordx4 v55, s[20:23], s49 offen lds
    v_mfma_f32_16x16x32_bf16 v[144:147], v[228:231], a[176:179], v[144:147]
    ds_read_b128 v[252:255], v22 offset:46080
    v_mfma_f32_16x16x32_bf16 v[144:147], v[224:227], a[184:187], v[144:147]
    v_mfma_f32_16x16x32_bf16 v[148:151], v[224:227], a[188:191], v[148:151]
    ds_read_b128 v[224:227], v22 offset:34816
    v_mfma_f32_16x16x32_bf16 v[148:151], v[228:231], a[180:183], v[148:151]
    v_mfma_f32_16x16x32_bf16 v[148:151], v[232:235], a[172:175], v[148:151]
    ds_read_b128 v[228:231], v22 offset:38912
    buffer_load_dwordx4 v62, s[20:23], s49 offen offset:1024 lds
    s_waitcnt vmcnt(11)
    s_buffer_atomic_swap s52, s[16:19], s91
    v_mfma_f32_16x16x32_bf16 v[148:151], v[236:239], a[164:167], v[148:151]
    s_waitcnt lgkmcnt(4)
    v_mfma_f32_16x16x32_bf16 v[152:155], v[240:243], a[160:163], v[152:155]
    ds_read_b128 v[232:235], v22 offset:43008
    v_mfma_f32_16x16x32_bf16 v[152:155], v[244:247], a[168:171], v[152:155]
    s_waitcnt lgkmcnt(3)
    v_mfma_f32_16x16x32_bf16 v[152:155], v[248:251], a[176:179], v[152:155]
    ds_read_b128 v[236:239], v22 offset:47104
    buffer_load_dwordx4 v63, s[20:23], s49 offen offset:2048 lds
    v_mfma_f32_16x16x32_bf16 v[152:155], v[252:255], a[184:187], v[152:155]
    v_mfma_f32_16x16x32_bf16 v[156:159], v[252:255], a[188:191], v[156:159]
    ds_read_b128 v[252:255], v22 offset:35840
    v_mfma_f32_16x16x32_bf16 v[156:159], v[248:251], a[180:183], v[156:159]
    v_mfma_f32_16x16x32_bf16 v[156:159], v[244:247], a[172:175], v[156:159]
    ds_read_b128 v[248:251], v22 offset:39936
    buffer_load_dwordx4 v18, s[20:23], s49 offen offset:3072 lds
    s_mul_i32 s49, s36, 28672
    s_add_u32 s49, s49, 200704
    s_add_u32 m0, s81, 65536
    v_mfma_f32_16x16x32_bf16 v[156:159], v[240:243], a[164:167], v[156:159]
    s_waitcnt lgkmcnt(4)
    v_mfma_f32_16x16x32_bf16 v[160:163], v[224:227], a[160:163], v[160:163]
    ds_read_b128 v[244:247], v22 offset:44032
    v_mfma_f32_16x16x32_bf16 v[160:163], v[228:231], a[168:171], v[160:163]
    s_waitcnt lgkmcnt(3)
    s_waitcnt vmcnt(9)
    v_min3_u32 v220, v195, v199, v203
    v_mfma_f32_16x16x32_bf16 v[160:163], v[232:235], a[176:179], v[160:163]
    ds_read_b128 v[240:243], v22 offset:48128
    buffer_load_dwordx4 v55, s[24:27], s49 offen lds
    v_mfma_f32_16x16x32_bf16 v[160:163], v[236:239], a[184:187], v[160:163]
    v_max3_u32 v221, v195, v199, v203
    s_waitcnt vmcnt(9)
    v_min3_u32 v220, v220, v207, v207
    v_mfma_f32_16x16x32_bf16 v[164:167], v[236:239], a[188:191], v[164:167]
    ds_read_b128 v[236:239], v22 offset:49152
    v_max3_u32 v221, v221, v207, v207
    v_mfma_f32_16x16x32_bf16 v[164:167], v[232:235], a[180:183], v[164:167]
    v_xor_b32 v220, s52, v220
    v_xor_b32 v221, s52, v221
    v_mfma_f32_16x16x32_bf16 v[164:167], v[228:231], a[172:175], v[164:167]
    ds_read_b128 v[232:235], v22 offset:53248
    buffer_load_dwordx4 v62, s[24:27], s49 offen offset:1024 lds
    v_mfma_f32_16x16x32_bf16 v[164:167], v[224:227], a[164:167], v[164:167]
    s_waitcnt lgkmcnt(4)
    v_or_b32 v220, v220, v221
    v_mfma_f32_16x16x32_bf16 v[168:171], v[252:255], a[160:163], v[168:171]
    ds_read_b128 v[228:231], v22 offset:57344
    v_mfma_f32_16x16x32_bf16 v[168:171], v[248:251], a[168:171], v[168:171]
    s_waitcnt lgkmcnt(3)
    v_cmp_ne_u32 s[54:55], 0, v220
    s_nop 0
    s_cmp_eq_u64 s[54:55], 0
    s_cbranch_scc0 Lslow_13
Lback_14:
    s_nop 0
    buffer_load_dwordx4 v63, s[24:27], s49 offen offset:2048 lds
    v_mfma_f32_16x16x32_bf16 v[168:171], v[244:247], a[176:179], v[168:171]
    ds_read_b128 v[224:227], v22 offset:61440
    v_mov_b32 v220, v194
    v_mfma_f32_16x16x32_bf16 v[168:171], v[240:243], a[184:187], v[168:171]
    v_mov_b32 v221, v198
    v_mov_b32 v222, v202
    v_mfma_f32_16x16x32_bf16 v[172:175], v[240:243], a[188:191], v[172:175]
    ds_read_b128 v[240:243], v22 offset:50176
    v_mov_b32 v223, v206
    v_mfma_f32_16x16x32_bf16 v[172:175], v[244:247], a[180:183], v[172:175]
    v_mfma_f32_16x16x16_bf16 v[144:147], v[60:61], v[192:193], v[144:147]
    buffer_load_dwordx4 v18, s[24:27], s49 offen offset:3072 lds
    v_mfma_f32_16x16x32_bf16 v[172:175], v[248:251], a[172:175], v[172:175]
    ds_read_b128 v[244:247], v22 offset:54272
    v_mfma_f32_16x16x16_bf16 v[148:151], v[60:61], v[196:197], v[148:151]
    v_mfma_f32_16x16x16_bf16 v[152:155], v[60:61], v[200:201], v[152:155]
    v_mfma_f32_16x16x16_bf16 v[156:159], v[60:61], v[204:205], v[156:159]
    v_mfma_f32_16x16x16_bf16 v[160:163], v[60:61], v[220:221], v[160:163]
    v_mfma_f32_16x16x16_bf16 v[164:167], v[60:61], v[222:223], v[164:167]
    v_mfma_f32_16x16x32_bf16 v[172:175], v[252:255], a[164:167], v[172:175]
    s_waitcnt lgkmcnt(4)
    buffer_load_dwordx4 v[216:219], v4, s[16:19], s87 offen offset:2048 sc1
    v_mfma_f32_16x16x32_bf16 v[144:147], v[236:239], a[192:195], v[144:147]
    ds_read_b128 v[248:251], v22 offset:58368
    v_mfma_f32_16x16x32_bf16 v[144:147], v[232:235], a[200:203], v[144:147]
    s_waitcnt lgkmcnt(3)
    v_mfma_f32_16x16x32_bf16 v[144:147], v[228:231], a[208:211], v[144:147]
    ds_read_b128 v[252:255], v22 offset:62464
    v_mfma_f32_16x16x32_bf16 v[144:147], v[224:227], a[216:219], v[144:147]
    v_mfma_f32_16x16x32_bf16 v[148:151], v[224:227], a[220:223], v[148:151]
    ds_read_b128 v[224:227], v22 offset:51200
    buffer_load_dwordx4 v[208:211], v4, s[16:19], s87 offen offset:0 sc1
    v_mfma_f32_16x16x32_bf16 v[148:151], v[228:231], a[212:215], v[148:151]
    v_mfma_f32_16x16x32_bf16 v[148:151], v[232:235], a[204:207], v[148:151]
    ds_read_b128 v[228:231], v22 offset:55296
    v_mfma_f32_16x16x32_bf16 v[148:151], v[236:239], a[196:199], v[148:151]
    s_waitcnt lgkmcnt(4)
    v_mfma_f32_16x16x32_bf16 v[152:155], v[240:243], a[192:195], v[152:155]
    ds_read_b128 v[232:235], v22 offset:59392
    buffer_load_dwordx4 v[212:215], v4, s[16:19], s87 offen offset:1024 sc1
    v_mfma_f32_16x16x32_bf16 v[152:155], v[244:247], a[200:203], v[152:155]
    s_waitcnt lgkmcnt(3)
    v_mfma_f32_16x16x32_bf16 v[152:155], v[248:251], a[208:211], v[152:155]
    ds_read_b128 v[236:239], v22 offset:63488
    v_mfma_f32_16x16x32_bf16 v[152:155], v[252:255], a[216:219], v[152:155]
    v_mfma_f32_16x16x32_bf16 v[156:159], v[252:255], a[220:223], v[156:159]
    ds_read_b128 v[252:255], v22 offset:52224
    v_mfma_f32_16x16x32_bf16 v[156:159], v[248:251], a[212:215], v[156:159]
    v_mfma_f32_16x16x32_bf16 v[156:159], v[244:247], a[204:207], v[156:159]
    ds_read_b128 v[248:251], v22 offset:56320
    v_mfma_f32_16x16x32_bf16 v[156:159], v[240:243], a[196:199], v[156:159]
    s_waitcnt lgkmcnt(4)
    v_mfma_f32_16x16x32_bf16 v[160:163], v[224:227], a[192:195], v[160:163]
    ds_read_b128 v[244:247], v22 offset:60416
    v_mfma_f32_16x16x32_bf16 v[160:163], v[228:231], a[200:203], v[160:163]
    s_waitcnt lgkmcnt(3)
    v_mfma_f32_16x16x32_bf16 v[160:163], v[232:235], a[208:211], v[160:163]
    ds_read_b128 v[240:243], v22 offset:64512
    v_mfma_f32_16x16x32_bf16 v[160:163], v[236:239], a[216:219], v[160:163]
    v_mfma_f32_16x16x32_bf16 v[164:167], v[236:239], a[220:223], v[164:167]
    s_barrier
    ds_read_b128 v[236:239], v4 offset:0
    s_mul_i32 s49, s36, 21504
    s_add_u32 s49, s49, 315392
    s_add_u32 m0, s76, 81920
    s_nop 0
    buffer_load_dwordx4 v55, s[24:27], s49 offen lds
    v_mfma_f32_16x16x32_bf16 v[164:167], v[232:235], a[212:215], v[164:167]
    v_mfma_f32_16x16x32_bf16 v[164:167], v[228:231], a[204:207], v[164:167]
    ds_read_b128 v[232:235], v4 offset:4096
    v_mfma_f32_16x16x32_bf16 v[164:167], v[224:227], a[196:199], v[164:167]
    s_waitcnt lgkmcnt(4)
    v_mfma_f32_16x16x32_bf16 v[168:171], v[252:255], a[192:195], v[168:171]
    ds_read_b128 v[228:231], v4 offset:8192
    v_mfma_f32_16x16x32_bf16 v[168:171], v[248:251], a[200:203], v[168:171]
    s_waitcnt lgkmcnt(3)
    buffer_load_dwordx4 v62, s[24:27], s49 offen offset:1024 lds
    v_mfma_f32_16x16x32_bf16 v[168:171], v[244:247], a[208:211], v[168:171]
    ds_read_b128 v[224:227], v4 offset:12288
    v_mfma_f32_16x16x32_bf16 v[168:171], v[240:243], a[216:219], v[168:171]
    v_mfma_f32_16x16x32_bf16 v[172:175], v[240:243], a[220:223], v[172:175]
    ds_read_b128 v[240:243], v4 offset:1024
    v_mfma_f32_16x16x32_bf16 v[172:175], v[244:247], a[212:215], v[172:175]
    v_mfma_f32_16x16x32_bf16 v[172:175], v[248:251], a[204:207], v[172:175]
    ds_read_b128 v[244:247], v4 offset:5120
    buffer_load_dwordx4 v63, s[24:27], s49 offen offset:2048 lds
    s_mul_i32 s49, s36, 28672
    s_add_u32 s49, s49, 401408
    s_add_u32 m0, s81, 98304
    v_mfma_f32_16x16x32_bf16 v[172:175], v[252:255], a[196:199], v[172:175]
    s_waitcnt lgkmcnt(4)
    v_mfma_f32_16x16x32_bf16 v[144:147], v[236:239], a[224:227], v[144:147]
    ds_read_b128 v[248:251], v4 offset:9216
    v_mfma_f32_16x16x32_bf16 v[144:147], v[232:235], a[232:235], v[144:147]
    s_waitcnt lgkmcnt(3)
    v_mfma_f32_16x16x32_bf16 v[144:147], v[228:231], a[240:243], v[144:147]
    ds_read_b128 v[252:255], v4 offset:13312
    buffer_load_dwordx4 v55, s[24:27], s49 offen lds
    v_mfma_f32_16x16x32_bf16 v[144:147], v[224:227], a[248:251], v[144:147]
    v_mfma_f32_16x16x32_bf16 v[148:151], v[224:227], a[252:255], v[148:151]
    ds_read_b128 v[224:227], v4 offset:2048
    v_mfma_f32_16x16x32_bf16 v[148:151], v[228:231], a[244:247], v[148:151]
    v_mfma_f32_16x16x32_bf16 v[148:151], v[232:235], a[236:239], v[148:151]
    ds_read_b128 v[228:231], v4 offset:6144
    buffer_load_dwordx4 v62, s[24:27], s49 offen offset:1024 lds
    v_mfma_f32_16x16x32_bf16 v[148:151], v[236:239], a[228:231], v[148:151]
    s_waitcnt lgkmcnt(4)
    v_mfma_f32_16x16x32_bf16 v[152:155], v[240:243], a[224:227], v[152:155]
    ds_read_b128 v[232:235], v4 offset:10240
    v_mfma_f32_16x16x32_bf16 v[152:155], v[244:247], a[232:235], v[152:155]
    s_waitcnt lgkmcnt(3)
    v_mfma_f32_16x16x32_bf16 v[152:155], v[248:251], a[240:243], v[152:155]
    ds_read_b128 v[236:239], v4 offset:14336
    buffer_load_dwordx4 v63, s[24:27], s49 offen offset:2048 lds
    v_mfma_f32_16x16x32_bf16 v[152:155], v[252:255], a[248:251], v[152:155]
    v_mfma_f32_16x16x32_bf16 v[156:159], v[252:255], a[252:255], v[156:159]
    ds_read_b128 v[252:255], v4 offset:3072
    v_mfma_f32_16x16x32_bf16 v[156:159], v[248:251], a[244:247], v[156:159]
    v_mfma_f32_16x16x32_bf16 v[156:159], v[244:247], a[236:239], v[156:159]
    ds_read_b128 v[248:251], v4 offset:7168
    buffer_load_dwordx4 v18, s[24:27], s49 offen offset:3072 lds
    v_mfma_f32_16x16x32_bf16 v[156:159], v[240:243], a[228:231], v[156:159]
    s_waitcnt lgkmcnt(4)
    v_mfma_f32_16x16x32_bf16 v[160:163], v[224:227], a[224:227], v[160:163]
    ds_read_b128 v[244:247], v4 offset:11264
    v_mfma_f32_16x16x32_bf16 v[160:163], v[228:231], a[232:235], v[160:163]
    s_waitcnt lgkmcnt(3)
    v_mfma_f32_16x16x32_bf16 v[160:163], v[232:235], a[240:243], v[160:163]
    ds_read_b128 v[240:243], v4 offset:15360
    v_mfma_f32_16x16x32_bf16 v[160:163], v[236:239], a[248:251], v[160:163]
    v_mfma_f32_16x16x32_bf16 v[164:167], v[236:239], a[252:255], v[164:167]
    v_mfma_f32_16x16x32_bf16 v[164:167], v[232:235], a[244:247], v[164:167]
    v_mfma_f32_16x16x32_bf16 v[164:167], v[228:231], a[236:239], v[164:167]
    v_mfma_f32_16x16x32_bf16 v[164:167], v[224:227], a[228:231], v[164:167]
    s_waitcnt lgkmcnt(2)
    v_mfma_f32_16x16x32_bf16 v[168:171], v[252:255], a[224:227], v[168:171]
    v_mfma_f32_16x16x32_bf16 v[168:171], v[248:251], a[232:235], v[168:171]
    s_waitcnt lgkmcnt(0)
    v_mfma_f32_16x16x32_bf16 v[168:171], v[244:247], a[240:243], v[168:171]
    v_mfma_f32_16x16x32_bf16 v[168:171], v[240:243], a[248:251], v[168:171]
    v_mfma_f32_16x16x32_bf16 v[172:175], v[240:243], a[252:255], v[172:175]
    v_mfma_f32_16x16x32_bf16 v[172:175], v[244:247], a[244:247], v[172:175]
    v_mfma_f32_16x16x32_bf16 v[172:175], v[248:251], a[236:239], v[172:175]
    v_mfma_f32_16x16x32_bf16 v[172:175], v[252:255], a[228:231], v[172:175]
    s_waitcnt vmcnt(9)
    s_nop 0
    v_mfma_f32_16x16x16_bf16 v[168:171], v[60:61], v[216:217], v[168:171]
    s_nop 2
    v_mfma_f32_16x16x16_bf16 v[172:175], v[60:61], v[218:219], v[172:175]
    s_waitcnt vmcnt(7)
    v_min3_u32 v192, v211, v215, v215
    v_max3_u32 v193, v211, v215, v215
    v_xor_b32 v192, s52, v192
    v_xor_b32 v193, s52, v193
    v_or_b32 v192, v192, v193
    v_cmp_ne_u32 s[54:55], 0, v192
    s_nop 0
    s_cmp_eq_u64 s[54:55], 0
    s_cbranch_scc0 Lslow_15
Lback_16:
    s_nop 0
    v_mfma_f32_16x16x16_bf16 v[168:171], v[60:61], v[208:209], v[168:171]
    v_mfma_f32_16x16x16_bf16 v[172:175], v[60:61], v[212:213], v[172:175]
    v_pk_mul_f32 v[144:145], v[144:145], v[80:81]
    v_pk_mul_f32 v[146:147], v[146:147], v[82:83]
    v_cvt_pk_bf16_f32 v64, v144, v145
    v_cvt_pk_bf16_f32 v65, v146, v147
    v_pk_mul_f32 v[152:153], v[152:153], v[84:85]
    v_pk_mul_f32 v[154:155], v[154:155], v[86:87]
    v_cvt_pk_bf16_f32 v66, v152, v153
    v_cvt_pk_bf16_f32 v67, v154, v155
    buffer_store_dwordx4 v[64:67], v4, s[16:19], s72 offen offset:0 sc1
    v_pk_mul_f32 v[148:149], v[148:149], v[88:89]
    v_pk_mul_f32 v[150:151], v[150:151], v[90:91]
    v_cvt_pk_bf16_f32 v68, v148, v149
    v_cvt_pk_bf16_f32 v69, v150, v151
    v_pk_mul_f32 v[156:157], v[156:157], v[92:93]
    v_pk_mul_f32 v[158:159], v[158:159], v[94:95]
    v_cvt_pk_bf16_f32 v70, v156, v157
    v_cvt_pk_bf16_f32 v71, v158, v159
    buffer_store_dwordx4 v[68:71], v4, s[16:19], s73 offen offset:0 sc1
    v_pk_mul_f32 v[160:161], v[160:161], v[96:97]
    v_pk_mul_f32 v[162:163], v[162:163], v[98:99]
    v_cvt_pk_bf16_f32 v72, v160, v161
    v_cvt_pk_bf16_f32 v73, v162, v163
    v_pk_mul_f32 v[168:169], v[168:169], v[100:101]
    v_pk_mul_f32 v[170:171], v[170:171], v[102:103]
    v_cvt_pk_bf16_f32 v74, v168, v169
    v_cvt_pk_bf16_f32 v75, v170, v171
    buffer_store_dwordx4 v[72:75], v4, s[16:19], s72 offen offset:1024 sc1
    v_pk_mul_f32 v[164:165], v[164:165], v[104:105]
    v_pk_mul_f32 v[166:167], v[166:167], v[106:107]
    v_cvt_pk_bf16_f32 v76, v164, v165
    v_cvt_pk_bf16_f32 v77, v166, v167
    v_pk_mul_f32 v[172:173], v[172:173], v[108:109]
    v_pk_mul_f32 v[174:175], v[174:175], v[110:111]
    v_cvt_pk_bf16_f32 v78, v172, v173
    v_cvt_pk_bf16_f32 v79, v174, v175
    buffer_store_dwordx4 v[76:79], v4, s[16:19], s73 offen offset:1024 sc1
    s_barrier
    s_add_u32 m0, s81, 0
    s_add_u32 s49, s36, 12
    s_mul_i32 s49, s49, 25088
    buffer_load_dwordx4 v55, s[20:23], s49 offen lds
    ds_read_b64_tr_b16 a[64:65], v36 offset:16384
    ds_read_b64_tr_b16 a[66:67], v36 offset:17408
    ds_read_b64_tr_b16 a[68:69], v37 offset:16384
    ds_read_b64_tr_b16 a[70:71], v37 offset:17408
    ds_read_b64_tr_b16 a[72:73], v38 offset:16384
    ds_read_b64_tr_b16 a[74:75], v38 offset:17408
    ds_read_b64_tr_b16 a[76:77], v39 offset:16384
    buffer_load_dwordx4 v62, s[20:23], s49 offen offset:1024 lds
    ds_read_b64_tr_b16 a[78:79], v39 offset:17408
    ds_read_b64_tr_b16 a[80:81], v36 offset:20480
    ds_read_b64_tr_b16 a[82:83], v36 offset:21504
    ds_read_b64_tr_b16 a[84:85], v37 offset:20480
    ds_read_b64_tr_b16 a[86:87], v37 offset:21504
    ds_read_b64_tr_b16 a[88:89], v38 offset:20480
    ds_read_b64_tr_b16 a[90:91], v38 offset:21504
    buffer_load_dwordx4 v63, s[20:23], s49 offen offset:2048 lds
    ds_read_b64_tr_b16 a[92:93], v39 offset:20480
    ds_read_b64_tr_b16 a[94:95], v39 offset:21504
    ds_read_b64_tr_b16 a[96:97], v36 offset:24576
    ds_read_b64_tr_b16 a[98:99], v36 offset:25600
    ds_read_b64_tr_b16 a[100:101], v37 offset:24576
    ds_read_b64_tr_b16 a[102:103], v37 offset:25600
    ds_read_b64_tr_b16 a[104:105], v38 offset:24576
    buffer_load_dwordx4 v18, s[20:23], s49 offen offset:3072 lds
    s_mul_i32 s49, s36, 21504
    s_add_u32 s49, s49, 516096
    s_add_u32 m0, s76, 114688
    s_nop 0
    buffer_load_dwordx4 v55, s[24:27], s49 offen lds
    ds_read_b64_tr_b16 a[106:107], v38 offset:25600
    ds_read_b64_tr_b16 a[108:109], v39 offset:24576
    ds_read_b64_tr_b16 a[110:111], v39 offset:25600
    ds_read_b64_tr_b16 a[112:113], v36 offset:28672
    ds_read_b64_tr_b16 a[114:115], v36 offset:29696
    ds_read_b64_tr_b16 a[116:117], v37 offset:28672
    ds_read_b64_tr_b16 a[118:119], v37 offset:29696
    buffer_load_dwordx4 v62, s[24:27], s49 offen offset:1024 lds
    ds_read_b64_tr_b16 a[120:121], v38 offset:28672
    ds_read_b64_tr_b16 a[122:123], v38 offset:29696
    ds_read_b64_tr_b16 a[124:125], v39 offset:28672
    ds_read_b64_tr_b16 a[126:127], v39 offset:29696
    ds_read_b64_tr_b16 a[128:129], v36 offset:32768
    ds_read_b64_tr_b16 a[130:131], v36 offset:33792
    ds_read_b64_tr_b16 a[132:133], v37 offset:32768
    buffer_load_dwordx4 v63, s[24:27], s49 offen offset:2048 lds
    ds_read_b64_tr_b16 a[134:135], v37 offset:33792
    ds_read_b64_tr_b16 a[136:137], v38 offset:32768
    ds_read_b64_tr_b16 a[138:139], v38 offset:33792
    ds_read_b64_tr_b16 a[140:141], v39 offset:32768
    ds_read_b64_tr_b16 a[142:143], v39 offset:33792
    ds_read_b64_tr_b16 a[144:145], v36 offset:36864
    ds_read_b64_tr_b16 a[146:147], v36 offset:37888
    ds_read_b64_tr_b16 a[148:149], v37 offset:36864
    ds_read_b64_tr_b16 a[150:151], v37 offset:37888
    ds_read_b64_tr_b16 a[152:153], v38 offset:36864
    ds_read_b64_tr_b16 a[154:155], v38 offset:37888
    ds_read_b64_tr_b16 a[156:157], v39 offset:36864
    ds_read_b64_tr_b16 a[158:159], v39 offset:37888
    ds_read_b64_tr_b16 a[160:161], v36 offset:40960
    ds_read_b64_tr_b16 a[162:163], v36 offset:41984
    ds_read_b64_tr_b16 a[164:165], v37 offset:40960
    ds_read_b64_tr_b16 a[166:167], v37 offset:41984
    ds_read_b64_tr_b16 a[168:169], v38 offset:40960
    ds_read_b64_tr_b16 a[170:171], v38 offset:41984
    ds_read_b64_tr_b16 a[172:173], v39 offset:40960
    ds_read_b64_tr_b16 a[174:175], v39 offset:41984
    ds_read_b64_tr_b16 a[176:177], v36 offset:45056
    ds_read_b64_tr_b16 a[178:179], v36 offset:46080
    s_not_b64 s[0:1], s[52:53]
    s_not_b64 s[2:3], s[52:53]
    s_not_b64 s[4:5], s[52:53]
    s_not_b64 s[6:7], s[52:53]
    s_not_b64 s[8:9], s[52:53]
    s_not_b64 s[10:11], s[52:53]
    s_not_b64 s[12:13], s[52:53]
    s_not_b64 s[14:15], s[52:53]
    s_buffer_load_dwordx16 s[0:15], s[16:19], s58 offset:0
    ds_read_b64_tr_b16 a[180:181], v37 offset:45056
    ds_read_b64_tr_b16 a[182:183], v37 offset:46080
    ds_read_b64_tr_b16 a[184:185], v38 offset:45056
    ds_read_b64_tr_b16 a[186:187], v38 offset:46080
    ds_read_b64_tr_b16 a[188:189], v39 offset:45056
    ds_read_b64_tr_b16 a[190:191], v39 offset:46080
    s_waitcnt lgkmcnt(8)
    s_barrier
    s_mul_i32 s49, s36, 28672
    s_add_u32 s49, s49, 602112
    s_add_u32 m0, s81, 16384
    s_nop 0
    buffer_load_dwordx4 v55, s[24:27], s49 offen lds
    ds_read_b64_tr_b16 a[192:193], v36 offset:49152
    ds_read_b64_tr_b16 a[194:195], v36 offset:50176
    ds_read_b64_tr_b16 a[196:197], v37 offset:49152
    ds_read_b64_tr_b16 a[198:199], v37 offset:50176
    ds_read_b64_tr_b16 a[200:201], v38 offset:49152
    ds_read_b64_tr_b16 a[202:203], v38 offset:50176
    ds_read_b64_tr_b16 a[204:205], v39 offset:49152
    buffer_load_dwordx4 v62, s[24:27], s49 offen offset:1024 lds
    ds_read_b64_tr_b16 a[206:207], v39 offset:50176
    ds_read_b64_tr_b16 a[208:209], v36 offset:53248
    ds_read_b64_tr_b16 a[210:211], v36 offset:54272
    ds_read_b64_tr_b16 a[212:213], v37 offset:53248
    ds_read_b64_tr_b16 a[214:215], v37 offset:54272
    ds_read_b64_tr_b16 a[216:217], v38 offset:53248
    ds_read_b64_tr_b16 a[218:219], v38 offset:54272
    ds_read_b64_tr_b16 a[220:221], v39 offset:53248
    ds_read_b64_tr_b16 a[222:223], v39 offset:54272
    ds_read_b64_tr_b16 a[224:225], v36 offset:57344
    ds_read_b64_tr_b16 a[226:227], v36 offset:58368
    ds_read_b64_tr_b16 a[228:229], v37 offset:57344
    ds_read_b64_tr_b16 a[230:231], v37 offset:58368
    ds_read_b64_tr_b16 a[232:233], v38 offset:57344
    ds_read_b64_tr_b16 a[234:235], v38 offset:58368
    ds_read_b64_tr_b16 a[236:237], v39 offset:57344
    ds_read_b64_tr_b16 a[238:239], v39 offset:58368
    ds_read_b64_tr_b16 a[240:241], v36 offset:61440
    ds_read_b64_tr_b16 a[242:243], v36 offset:62464
    ds_read_b64_tr_b16 a[244:245], v37 offset:61440
    ds_read_b64_tr_b16 a[246:247], v37 offset:62464
    ds_read_b64_tr_b16 a[248:249], v38 offset:61440
    ds_read_b64_tr_b16 a[250:251], v38 offset:62464
    ds_read_b64_tr_b16 a[252:253], v39 offset:61440
    ds_read_b64_tr_b16 a[254:255], v39 offset:62464
    buffer_load_dwordx4 v63, s[24:27], s49 offen offset:2048 lds
    buffer_load_dwordx4 v18, s[24:27], s49 offen offset:3072 lds
    s_waitcnt vmcnt(7)
    s_buffer_atomic_swap s52, s[16:19], s92
    s_barrier
    s_cmp_eq_u64 s[0:1], s[52:53]
    s_cbranch_scc0 Lslow_17
    s_cmp_eq_u64 s[2:3], s[52:53]
    s_cbranch_scc0 Lslow_17
    s_cmp_eq_u64 s[4:5], s[52:53]
    s_cbranch_scc0 Lslow_17
    s_cmp_eq_u64 s[6:7], s[52:53]
    s_cbranch_scc0 Lslow_17
    s_cmp_eq_u64 s[8:9], s[52:53]
    s_cbranch_scc0 Lslow_17
    s_cmp_eq_u64 s[10:11], s[52:53]
    s_cbranch_scc0 Lslow_17
    s_cmp_eq_u64 s[12:13], s[52:53]
    s_cbranch_scc0 Lslow_17
    s_cmp_eq_u64 s[14:15], s[52:53]
    s_cbranch_scc0 Lslow_17
Lback_18:
    s_nop 0
    ds_read_b64_tr_b16 v[208:209], v36 offset:0
    buffer_load_dwordx4 a[0:3], v4, s[16:19], s93 offen offset:0 sc1
    s_mul_i32 s49, s36, 21504
    s_add_u32 s49, s49, 716800
    s_add_u32 m0, s76, 32768
    s_nop 0
    buffer_load_dwordx4 v55, s[24:27], s49 offen lds
    ds_read_b64_tr_b16 v[210:211], v36 offset:1024
    ds_read_b64_tr_b16 v[212:213], v37 offset:0
    ds_read_b64_tr_b16 v[214:215], v37 offset:1024
    ds_read_b64_tr_b16 v[216:217], v38 offset:0
    ds_read_b64_tr_b16 v[218:219], v38 offset:1024
    ds_read_b64_tr_b16 v[220:221], v39 offset:0
    ds_read_b64_tr_b16 v[222:223], v39 offset:1024
    buffer_load_dwordx4 a[4:7], v4, s[16:19], s93 offen offset:1024 sc1
    ds_read_b64_tr_b16 v[224:225], v36 offset:4096
    ds_read_b64_tr_b16 v[226:227], v36 offset:5120
    ds_read_b64_tr_b16 v[228:229], v37 offset:4096
    ds_read_b64_tr_b16 v[230:231], v37 offset:5120
    ds_read_b64_tr_b16 v[232:233], v38 offset:4096
    ds_read_b64_tr_b16 v[234:235], v38 offset:5120
    ds_read_b64_tr_b16 v[236:237], v39 offset:4096
    buffer_load_dwordx4 a[8:11], v4, s[16:19], s93 offen offset:2048 sc1
    ds_read_b64_tr_b16 v[238:239], v39 offset:5120
    ds_read_b64_tr_b16 v[240:241], v36 offset:8192
    ds_read_b64_tr_b16 v[242:243], v36 offset:9216
    ds_read_b64_tr_b16 v[244:245], v37 offset:8192
    ds_read_b64_tr_b16 v[246:247], v37 offset:9216
    ds_read_b64_tr_b16 v[248:249], v38 offset:8192
    ds_read_b64_tr_b16 v[250:251], v38 offset:9216
    buffer_load_dwordx4 a[12:15], v4, s[16:19], s93 offen offset:3072 sc1
    ds_read_b64_tr_b16 v[252:253], v39 offset:8192
    ds_read_b64_tr_b16 v[254:255], v39 offset:9216
    ds_read_b64_tr_b16 v[144:145], v36 offset:12288
    ds_read_b64_tr_b16 v[146:147], v36 offset:13312
    ds_read_b64_tr_b16 v[148:149], v37 offset:12288
    ds_read_b64_tr_b16 v[150:151], v37 offset:13312
    s_add_u32 s93, s93, 4096
    buffer_load_dwordx4 a[16:19], v4, s[16:19], s93 offen offset:0 sc1
    ds_read_b64_tr_b16 v[152:153], v38 offset:12288
    ds_read_b64_tr_b16 v[154:155], v38 offset:13312
    ds_read_b64_tr_b16 v[156:157], v39 offset:12288
    ds_read_b64_tr_b16 v[158:159], v39 offset:13312
    ds_read_b64_tr_b16 v[160:161], v40 offset:0
    ds_read_b64_tr_b16 v[162:163], v40 offset:2048
    buffer_load_dwordx4 a[20:23], v4, s[16:19], s93 offen offset:1024 sc1
    ds_read_b64_tr_b16 v[164:165], v41 offset:0
    ds_read_b64_tr_b16 v[166:167], v41 offset:2048
    ds_read_b64_tr_b16 v[168:169], v42 offset:0
    ds_read_b64_tr_b16 v[170:171], v42 offset:2048
    ds_read_b64_tr_b16 v[172:173], v43 offset:0
    ds_read_b64_tr_b16 v[174:175], v43 offset:2048
    buffer_load_dwordx4 a[24:27], v4, s[16:19], s93 offen offset:2048 sc1
    ds_read_b64_tr_b16 v[176:177], v40 offset:4096
    ds_read_b64_tr_b16 v[178:179], v40 offset:6144
    ds_read_b64_tr_b16 v[180:181], v41 offset:4096
    ds_read_b64_tr_b16 v[182:183], v41 offset:6144
    ds_read_b64_tr_b16 v[184:185], v42 offset:4096
    ds_read_b64_tr_b16 v[186:187], v42 offset:6144
    buffer_load_dwordx4 a[28:31], v4, s[16:19], s93 offen offset:3072 sc1
    ds_read_b64_tr_b16 v[188:189], v43 offset:4096
    ds_read_b64_tr_b16 v[190:191], v43 offset:6144
    ds_read_b64_tr_b16 v[80:81], v40 offset:8192
    ds_read_b64_tr_b16 v[82:83], v40 offset:10240
    ds_read_b64_tr_b16 v[84:85], v41 offset:8192
    ds_read_b64_tr_b16 v[86:87], v41 offset:10240
    s_add_u32 s93, s93, 4096
    buffer_load_dwordx4 a[32:35], v4, s[16:19], s93 offen offset:0 sc1
    ds_read_b64_tr_b16 v[88:89], v42 offset:8192
    ds_read_b64_tr_b16 v[90:91], v42 offset:10240
    ds_read_b64_tr_b16 v[92:93], v43 offset:8192
    ds_read_b64_tr_b16 v[94:95], v43 offset:10240
    ds_read_b64_tr_b16 v[96:97], v40 offset:12288
    ds_read_b64_tr_b16 v[98:99], v40 offset:14336
    buffer_load_dwordx4 a[36:39], v4, s[16:19], s93 offen offset:1024 sc1
    ds_read_b64_tr_b16 v[100:101], v41 offset:12288
    ds_read_b64_tr_b16 v[102:103], v41 offset:14336
    ds_read_b64_tr_b16 v[104:105], v42 offset:12288
    ds_read_b64_tr_b16 v[106:107], v42 offset:14336
    ds_read_b64_tr_b16 v[108:109], v43 offset:12288
    ds_read_b64_tr_b16 v[110:111], v43 offset:14336
    ds_read_b64_tr_b16 v[112:113], v40 offset:16384
    buffer_load_dwordx4 a[40:43], v4, s[16:19], s93 offen offset:2048 sc1
    ds_read_b64_tr_b16 v[114:115], v40 offset:18432
    ds_read_b64_tr_b16 v[116:117], v41 offset:16384
    ds_read_b64_tr_b16 v[118:119], v41 offset:18432
    ds_read_b64_tr_b16 v[120:121], v42 offset:16384
    ds_read_b64_tr_b16 v[122:123], v42 offset:18432
    ds_read_b64_tr_b16 v[124:125], v43 offset:16384
    ds_read_b64_tr_b16 v[126:127], v43 offset:18432
    buffer_load_dwordx4 a[44:47], v4, s[16:19], s93 offen offset:3072 sc1
    ds_read_b64_tr_b16 v[128:129], v40 offset:20480
    ds_read_b64_tr_b16 v[130:131], v40 offset:22528
    ds_read_b64_tr_b16 v[132:133], v41 offset:20480
    ds_read_b64_tr_b16 v[134:135], v41 offset:22528
    ds_read_b64_tr_b16 v[136:137], v42 offset:20480
    ds_read_b64_tr_b16 v[138:139], v42 offset:22528
    ds_read_b64_tr_b16 v[140:141], v43 offset:20480
    s_add_u32 s93, s93, 4096
    buffer_load_dwordx4 a[48:51], v4, s[16:19], s93 offen offset:0 sc1
    ds_read_b64_tr_b16 v[142:143], v43 offset:22528
    s_waitcnt vmcnt(13)
    v_mfma_f32_16x16x32_bf16 v[192:195], a[64:67], a[0:3], 0
    v_mfma_f32_16x16x32_bf16 v[196:199], a[68:71], a[0:3], 0
    v_mfma_f32_16x16x32_bf16 v[200:203], a[72:75], a[0:3], 0
    v_mfma_f32_16x16x32_bf16 v[204:207], a[76:79], a[0:3], 0
    s_waitcnt vmcnt(11)
    buffer_load_dwordx4 a[52:55], v4, s[16:19], s93 offen offset:1024 sc1
    v_mfma_f32_16x16x32_bf16 v[192:195], a[80:83], a[4:7], v[192:195]
    ds_read_b64_tr_b16 a[0:1], v40 offset:24576
    ds_read_b64_tr_b16 a[2:3], v40 offset:26624
    v_mfma_f32_16x16x32_bf16 v[196:199], a[84:87], a[4:7], v[196:199]
    v_mfma_f32_16x16x32_bf16 v[200:203], a[88:91], a[4:7], v[200:203]
    v_mfma_f32_16x16x32_bf16 v[204:207], a[92:95], a[4:7], v[204:207]
    s_waitcnt vmcnt(11)
    buffer_load_dwordx4 a[56:59], v4, s[16:19], s93 offen offset:2048 sc1
    v_mfma_f32_16x16x32_bf16 v[192:195], a[96:99], a[8:11], v[192:195]
    ds_read_b64_tr_b16 a[4:5], v41 offset:24576
    ds_read_b64_tr_b16 a[6:7], v41 offset:26624
    v_mfma_f32_16x16x32_bf16 v[196:199], a[100:103], a[8:11], v[196:199]
    v_mfma_f32_16x16x32_bf16 v[200:203], a[104:107], a[8:11], v[200:203]
    v_mfma_f32_16x16x32_bf16 v[204:207], a[108:111], a[8:11], v[204:207]
    s_waitcnt vmcnt(11)
    buffer_load_dwordx4 a[60:63], v4, s[16:19], s93 offen offset:3072 sc1
    v_mfma_f32_16x16x32_bf16 v[192:195], a[112:115], a[12:15], v[192:195]
    ds_read_b64_tr_b16 a[8:9], v42 offset:24576
    ds_read_b64_tr_b16 a[10:11], v42 offset:26624
    v_mfma_f32_16x16x32_bf16 v[196:199], a[116:119], a[12:15], v[196:199]
    v_mfma_f32_16x16x32_bf16 v[200:203], a[120:123], a[12:15], v[200:203]
    v_mfma_f32_16x16x32_bf16 v[204:207], a[124:127], a[12:15], v[204:207]
    s_waitcnt vmcnt(11)
    s_not_b64 s[0:1], s[52:53]
    s_not_b64 s[2:3], s[52:53]
    s_not_b64 s[4:5], s[52:53]
    v_mfma_f32_16x16x32_bf16 v[192:195], a[128:131], a[16:19], v[192:195]
    s_not_b64 s[6:7], s[52:53]
    ds_read_b64_tr_b16 a[12:13], v43 offset:24576
    ds_read_b64_tr_b16 a[14:15], v43 offset:26624
    s_not_b64 s[8:9], s[52:53]
    v_mfma_f32_16x16x32_bf16 v[196:199], a[132:135], a[16:19], v[196:199]
    s_not_b64 s[10:11], s[52:53]
    s_not_b64 s[12:13], s[52:53]
    s_not_b64 s[14:15], s[52:53]
    s_buffer_load_dwordx16 s[0:15], s[16:19], s58 offset:128
    v_mfma_f32_16x16x32_bf16 v[200:203], a[136:139], a[16:19], v[200:203]
    buffer_load_dwordx4 v62, s[24:27], s49 offen offset:1024 lds
    v_mfma_f32_16x16x32_bf16 v[204:207], a[140:143], a[16:19], v[204:207]
    s_waitcnt vmcnt(11)
    v_mfma_f32_16x16x32_bf16 v[192:195], a[144:147], a[20:23], v[192:195]
    v_subrev_u32 v40, 69632, v40
    v_subrev_u32 v41, 69632, v41
    v_subrev_u32 v42, 69632, v42
    v_subrev_u32 v43, 69632, v43
    ds_read_b64_tr_b16 a[16:17], v40 offset:0
    ds_read_b64_tr_b16 a[18:19], v40 offset:2048
    buffer_load_dwordx4 v63, s[24:27], s49 offen offset:2048 lds
    v_mfma_f32_16x16x32_bf16 v[196:199], a[148:151], a[20:23], v[196:199]
    v_mfma_f32_16x16x32_bf16 v[200:203], a[152:155], a[20:23], v[200:203]
    v_mfma_f32_16x16x32_bf16 v[204:207], a[156:159], a[20:23], v[204:207]
    s_waitcnt vmcnt(11)
    v_mfma_f32_16x16x32_bf16 v[192:195], a[160:163], a[24:27], v[192:195]
    ds_read_b64_tr_b16 a[20:21], v41 offset:0
    ds_read_b64_tr_b16 a[22:23], v41 offset:2048
    v_mfma_f32_16x16x32_bf16 v[196:199], a[164:167], a[24:27], v[196:199]
    v_mfma_f32_16x16x32_bf16 v[200:203], a[168:171], a[24:27], v[200:203]
    v_mfma_f32_16x16x32_bf16 v[204:207], a[172:175], a[24:27], v[204:207]
    s_waitcnt vmcnt(10)
    s_waitcnt lgkmcnt(15)
    v_mfma_f32_16x16x32_bf16 v[192:195], a[176:179], a[28:31], v[192:195]
    ds_read_b64_tr_b16 a[24:25], v42 offset:0
    ds_read_b64_tr_b16 a[26:27], v42 offset:2048
    v_mfma_f32_16x16x32_bf16 v[196:199], a[180:183], a[28:31], v[196:199]
    ds_read_b64_tr_b16 a[176:177], v43 offset:0
    ds_read_b64_tr_b16 a[178:179], v43 offset:2048
    v_mfma_f32_16x16x32_bf16 v[200:203], a[184:187], a[28:31], v[200:203]
    ds_read_b64_tr_b16 a[180:181], v40 offset:4096
    ds_read_b64_tr_b16 a[182:183], v40 offset:6144
    v_mfma_f32_16x16x32_bf16 v[204:207], a[188:191], a[28:31], v[204:207]
    s_waitcnt vmcnt(9)
    v_mfma_f32_16x16x32_bf16 v[192:195], a[192:195], a[32:35], v[192:195]
    ds_read_b64_tr_b16 a[184:185], v41 offset:4096
    ds_read_b64_tr_b16 a[186:187], v41 offset:6144
    v_mfma_f32_16x16x32_bf16 v[196:199], a[196:199], a[32:35], v[196:199]
    ds_read_b64_tr_b16 a[188:189], v42 offset:4096
    ds_read_b64_tr_b16 a[190:191], v42 offset:6144
    v_mfma_f32_16x16x32_bf16 v[200:203], a[200:203], a[32:35], v[200:203]
    ds_read_b64_tr_b16 a[28:29], v43 offset:4096
    ds_read_b64_tr_b16 a[30:31], v43 offset:6144
    v_mfma_f32_16x16x32_bf16 v[204:207], a[204:207], a[32:35], v[204:207]
    s_waitcnt vmcnt(8)
    v_mfma_f32_16x16x32_bf16 v[192:195], a[208:211], a[36:39], v[192:195]
    ds_read_b64_tr_b16 a[192:193], v40 offset:8192
    ds_read_b64_tr_b16 a[194:195], v40 offset:10240
    v_mfma_f32_16x16x32_bf16 v[196:199], a[212:215], a[36:39], v[196:199]
    ds_read_b64_tr_b16 a[196:197], v41 offset:8192
    ds_read_b64_tr_b16 a[198:199], v41 offset:10240
    v_mfma_f32_16x16x32_bf16 v[200:203], a[216:219], a[36:39], v[200:203]
    ds_read_b64_tr_b16 a[200:201], v42 offset:8192
    ds_read_b64_tr_b16 a[202:203], v42 offset:10240
    v_mfma_f32_16x16x32_bf16 v[204:207], a[220:223], a[36:39], v[204:207]
    s_waitcnt vmcnt(7)
    v_mfma_f32_16x16x32_bf16 v[192:195], a[224:227], a[40:43], v[192:195]
    ds_read_b64_tr_b16 a[204:205], v43 offset:8192
    ds_read_b64_tr_b16 a[206:207], v43 offset:10240
    v_mfma_f32_16x16x32_bf16 v[196:199], a[228:231], a[40:43], v[196:199]
    ds_read_b64_tr_b16 a[32:33], v40 offset:12288
    ds_read_b64_tr_b16 a[34:35], v40 offset:14336
    v_mfma_f32_16x16x32_bf16 v[200:203], a[232:235], a[40:43], v[200:203]
    ds_read_b64_tr_b16 a[208:209], v41 offset:12288
    ds_read_b64_tr_b16 a[210:211], v41 offset:14336
    v_mfma_f32_16x16x32_bf16 v[204:207], a[236:239], a[40:43], v[204:207]
    s_waitcnt vmcnt(6)
    v_mfma_f32_16x16x32_bf16 v[192:195], a[240:243], a[44:47], v[192:195]
    ds_read_b64_tr_b16 a[212:213], v42 offset:12288
    ds_read_b64_tr_b16 a[214:215], v42 offset:14336
    v_mfma_f32_16x16x32_bf16 v[196:199], a[244:247], a[44:47], v[196:199]
    ds_read_b64_tr_b16 a[216:217], v43 offset:12288
    ds_read_b64_tr_b16 a[218:219], v43 offset:14336
    v_mfma_f32_16x16x32_bf16 v[200:203], a[248:251], a[44:47], v[200:203]
    ds_read_b64_tr_b16 a[220:221], v40 offset:16384
    ds_read_b64_tr_b16 a[222:223], v40 offset:18432
    v_mfma_f32_16x16x32_bf16 v[204:207], a[252:255], a[44:47], v[204:207]
    s_waitcnt vmcnt(5)
    v_mfma_f32_16x16x32_bf16 v[192:195], v[208:211], a[48:51], v[192:195]
    ds_read_b64_tr_b16 a[36:37], v41 offset:16384
    ds_read_b64_tr_b16 a[38:39], v41 offset:18432
    v_mfma_f32_16x16x32_bf16 v[196:199], v[212:215], a[48:51], v[196:199]
    ds_read_b64_tr_b16 a[224:225], v42 offset:16384
    ds_read_b64_tr_b16 a[226:227], v42 offset:18432
    v_mfma_f32_16x16x32_bf16 v[200:203], v[216:219], a[48:51], v[200:203]
    ds_read_b64_tr_b16 a[228:229], v43 offset:16384
    ds_read_b64_tr_b16 a[230:231], v43 offset:18432
    v_mfma_f32_16x16x32_bf16 v[204:207], v[220:223], a[48:51], v[204:207]
    s_waitcnt vmcnt(4)
    v_mfma_f32_16x16x32_bf16 v[192:195], v[224:227], a[52:55], v[192:195]
    ds_read_b64_tr_b16 a[232:233], v40 offset:20480
    ds_read_b64_tr_b16 a[234:235], v40 offset:22528
    v_mfma_f32_16x16x32_bf16 v[196:199], v[228:231], a[52:55], v[196:199]
    ds_read_b64_tr_b16 a[236:237], v41 offset:20480
    ds_read_b64_tr_b16 a[238:239], v41 offset:22528
    v_mfma_f32_16x16x32_bf16 v[200:203], v[232:235], a[52:55], v[200:203]
    ds_read_b64_tr_b16 a[40:41], v42 offset:20480
    ds_read_b64_tr_b16 a[42:43], v42 offset:22528
    v_mfma_f32_16x16x32_bf16 v[204:207], v[236:239], a[52:55], v[204:207]
    s_waitcnt vmcnt(3)
    v_mfma_f32_16x16x32_bf16 v[192:195], v[240:243], a[56:59], v[192:195]
    ds_read_b64_tr_b16 a[240:241], v43 offset:20480
    ds_read_b64_tr_b16 a[242:243], v43 offset:22528
    v_mfma_f32_16x16x32_bf16 v[196:199], v[244:247], a[56:59], v[196:199]
    ds_read_b64_tr_b16 a[244:245], v40 offset:24576
    ds_read_b64_tr_b16 a[246:247], v40 offset:26624
    v_mfma_f32_16x16x32_bf16 v[200:203], v[248:251], a[56:59], v[200:203]
    ds_read_b64_tr_b16 a[248:249], v41 offset:24576
    ds_read_b64_tr_b16 a[250:251], v41 offset:26624
    v_mfma_f32_16x16x32_bf16 v[204:207], v[252:255], a[56:59], v[204:207]
    s_waitcnt vmcnt(2)
    s_cmp_eq_u64 s[0:1], s[52:53]
    s_cbranch_scc0 Lslow_21
    s_cmp_eq_u64 s[2:3], s[52:53]
    s_cbranch_scc0 Lslow_21
    s_cmp_eq_u64 s[4:5], s[52:53]
    s_cbranch_scc0 Lslow_21
    s_cmp_eq_u64 s[6:7], s[52:53]
    s_cbranch_scc0 Lslow_21
    s_cmp_eq_u64 s[8:9], s[52:53]
    s_cbranch_scc0 Lslow_21
    s_cmp_eq_u64 s[10:11], s[52:53]
    s_cbranch_scc0 Lslow_21
    s_cmp_eq_u64 s[12:13], s[52:53]
    s_cbranch_scc0 Lslow_21
Lback_22:
    s_nop 0
    buffer_load_dwordx4 a[64:67], v4, s[16:19], s94 offen offset:0 sc1
    v_mfma_f32_16x16x32_bf16 v[192:195], v[144:147], a[60:63], v[192:195]
    ds_read_b64_tr_b16 a[252:253], v42 offset:24576
    ds_read_b64_tr_b16 a[254:255], v42 offset:26624
    v_mfma_f32_16x16x32_bf16 v[196:199], v[148:151], a[60:63], v[196:199]
    ds_read_b64_tr_b16 a[44:45], v43 offset:24576
    ds_read_b64_tr_b16 a[46:47], v43 offset:26624
    v_mfma_f32_16x16x32_bf16 v[200:203], v[152:155], a[60:63], v[200:203]
    s_waitcnt vmcnt(1)
    s_barrier
    buffer_load_dwordx4 a[68:71], v4, s[16:19], s94 offen offset:1024 sc1
    ds_read_b64_tr_b16 v[208:209], v40 offset:32768
    ds_read_b64_tr_b16 v[210:211], v40 offset:34816
    v_mfma_f32_16x16x32_bf16 v[204:207], v[156:159], a[60:63], v[204:207]
    ds_read_b64_tr_b16 v[212:213], v41 offset:32768
    ds_read_b64_tr_b16 v[214:215], v41 offset:34816
    ds_read_b64_tr_b16 v[216:217], v42 offset:32768
    ds_read_b64_tr_b16 v[218:219], v42 offset:34816
    buffer_load_dwordx4 a[72:75], v4, s[16:19], s94 offen offset:2048 sc1
    ds_read_b64_tr_b16 v[220:221], v43 offset:32768
    ds_read_b64_tr_b16 v[222:223], v43 offset:34816
    ds_read_b64_tr_b16 a[48:49], v40 offset:36864
    ds_read_b64_tr_b16 a[50:51], v40 offset:38912
    ds_read_b64_tr_b16 v[224:225], v41 offset:36864
    ds_read_b64_tr_b16 v[226:227], v41 offset:38912
    ds_read_b64_tr_b16 v[228:229], v42 offset:36864
    buffer_load_dwordx4 a[76:79], v4, s[16:19], s94 offen offset:3072 sc1
    ds_read_b64_tr_b16 v[230:231], v42 offset:38912
    ds_read_b64_tr_b16 v[232:233], v43 offset:36864
    ds_read_b64_tr_b16 v[234:235], v43 offset:38912
    ds_read_b64_tr_b16 v[236:237], v40 offset:40960
    ds_read_b64_tr_b16 v[238:239], v40 offset:43008
    ds_read_b64_tr_b16 a[52:53], v41 offset:40960
    ds_read_b64_tr_b16 a[54:55], v41 offset:43008
    s_add_u32 s94, s94, 4096
    buffer_load_dwordx4 a[80:83], v4, s[16:19], s94 offen offset:0 sc1
    ds_read_b64_tr_b16 v[240:241], v42 offset:40960
    ds_read_b64_tr_b16 v[242:243], v42 offset:43008
    ds_read_b64_tr_b16 v[244:245], v43 offset:40960
    ds_read_b64_tr_b16 v[246:247], v43 offset:43008
    ds_read_b64_tr_b16 v[248:249], v40 offset:45056
    ds_read_b64_tr_b16 v[250:251], v40 offset:47104
    ds_read_b64_tr_b16 v[252:253], v41 offset:45056
    buffer_load_dwordx4 a[84:87], v4, s[16:19], s94 offen offset:1024 sc1
    ds_read_b64_tr_b16 v[254:255], v41 offset:47104
    ds_read_b64_tr_b16 a[56:57], v42 offset:45056
    ds_read_b64_tr_b16 a[58:59], v42 offset:47104
    ds_read_b64_tr_b16 v[144:145], v43 offset:45056
    ds_read_b64_tr_b16 v[146:147], v43 offset:47104
    ds_read_b64_tr_b16 v[148:149], v40 offset:49152
    ds_read_b64_tr_b16 v[150:151], v40 offset:51200
    buffer_load_dwordx4 a[88:91], v4, s[16:19], s94 offen offset:2048 sc1
    ds_read_b64_tr_b16 v[152:153], v41 offset:49152
    ds_read_b64_tr_b16 v[154:155], v41 offset:51200
    ds_read_b64_tr_b16 v[156:157], v42 offset:49152
    ds_read_b64_tr_b16 v[158:159], v42 offset:51200
    ds_read_b64_tr_b16 a[60:61], v43 offset:49152
    ds_read_b64_tr_b16 a[62:63], v43 offset:51200
    buffer_load_dwordx4 a[92:95], v4, s[16:19], s94 offen offset:3072 sc1
    s_waitcnt vmcnt(7)
    s_add_u32 s94, s94, 4096
    buffer_load_dwordx4 a[96:99], v4, s[16:19], s94 offen offset:0 sc1
    v_mfma_f32_16x16x32_bf16 v[192:195], v[160:163], a[64:67], v[192:195]
    ds_read_b64_tr_b16 v[160:161], v40 offset:53248
    v_mfma_f32_16x16x32_bf16 v[196:199], v[164:167], a[64:67], v[196:199]
    ds_read_b64_tr_b16 v[162:163], v40 offset:55296
    v_mfma_f32_16x16x32_bf16 v[200:203], v[168:171], a[64:67], v[200:203]
    ds_read_b64_tr_b16 v[164:165], v41 offset:53248
    v_mfma_f32_16x16x32_bf16 v[204:207], v[172:175], a[64:67], v[204:207]
    s_waitcnt vmcnt(7)
    buffer_load_dwordx4 a[100:103], v4, s[16:19], s94 offen offset:1024 sc1
    v_mfma_f32_16x16x32_bf16 v[192:195], v[176:179], a[68:71], v[192:195]
    ds_read_b64_tr_b16 v[166:167], v41 offset:55296
    v_mfma_f32_16x16x32_bf16 v[196:199], v[180:183], a[68:71], v[196:199]
    ds_read_b64_tr_b16 v[168:169], v42 offset:53248
    v_mfma_f32_16x16x32_bf16 v[200:203], v[184:187], a[68:71], v[200:203]
    ds_read_b64_tr_b16 v[170:171], v42 offset:55296
    v_mfma_f32_16x16x32_bf16 v[204:207], v[188:191], a[68:71], v[204:207]
    s_waitcnt vmcnt(7)
    buffer_load_dwordx4 a[104:107], v4, s[16:19], s94 offen offset:2048 sc1
    v_mfma_f32_16x16x32_bf16 v[192:195], v[80:83], a[72:75], v[192:195]
    ds_read_b64_tr_b16 v[172:173], v43 offset:53248
    v_mfma_f32_16x16x32_bf16 v[196:199], v[84:87], a[72:75], v[196:199]
    ds_read_b64_tr_b16 v[174:175], v43 offset:55296
    v_mfma_f32_16x16x32_bf16 v[200:203], v[88:91], a[72:75], v[200:203]
    ds_read_b64_tr_b16 v[176:177], v40 offset:57344
    v_mfma_f32_16x16x32_bf16 v[204:207], v[92:95], a[72:75], v[204:207]
    s_waitcnt vmcnt(7)
    buffer_load_dwordx4 a[108:111], v4, s[16:19], s94 offen offset:3072 sc1
    v_mfma_f32_16x16x32_bf16 v[192:195], v[96:99], a[76:79], v[192:195]
    ds_read_b64_tr_b16 v[178:179], v40 offset:59392
    v_mfma_f32_16x16x32_bf16 v[196:199], v[100:103], a[76:79], v[196:199]
    ds_read_b64_tr_b16 v[180:181], v41 offset:57344
    v_mfma_f32_16x16x32_bf16 v[200:203], v[104:107], a[76:79], v[200:203]
    ds_read_b64_tr_b16 v[182:183], v41 offset:59392
    v_mfma_f32_16x16x32_bf16 v[204:207], v[108:111], a[76:79], v[204:207]
    s_waitcnt vmcnt(7)
    s_add_u32 s94, s94, 4096
    buffer_load_dwordx4 a[112:115], v4, s[16:19], s94 offen offset:0 sc1
    v_mfma_f32_16x16x32_bf16 v[192:195], v[112:115], a[80:83], v[192:195]
    ds_read_b64_tr_b16 v[184:185], v42 offset:57344
    v_mfma_f32_16x16x32_bf16 v[196:199], v[116:119], a[80:83], v[196:199]
    ds_read_b64_tr_b16 v[186:187], v42 offset:59392
    v_mfma_f32_16x16x32_bf16 v[200:203], v[120:123], a[80:83], v[200:203]
    ds_read_b64_tr_b16 v[188:189], v43 offset:57344
    v_mfma_f32_16x16x32_bf16 v[204:207], v[124:127], a[80:83], v[204:207]
    s_waitcnt vmcnt(7)
    s_waitcnt lgkmcnt(15)
    buffer_load_dwordx4 a[116:119], v4, s[16:19], s94 offen offset:1024 sc1
    v_mfma_f32_16x16x32_bf16 v[192:195], v[128:131], a[84:87], v[192:195]
    ds_read_b64_tr_b16 v[190:191], v43 offset:59392
    v_mfma_f32_16x16x32_bf16 v[196:199], v[132:135], a[84:87], v[196:199]
    v_subrev_u32 v40, 49152, v40
    v_subrev_u32 v41, 49152, v41
    v_subrev_u32 v42, 49152, v42
    v_subrev_u32 v43, 49152, v43
    ds_read_b64_tr_b16 v[80:81], v40 offset:0
    buffer_load_dwordx4 a[120:123], v4, s[16:19], s94 offen offset:2048 sc1
    v_mfma_f32_16x16x32_bf16 v[200:203], v[136:139], a[84:87], v[200:203]
    ds_read_b64_tr_b16 v[82:83], v40 offset:2048
    v_mfma_f32_16x16x32_bf16 v[204:207], v[140:143], a[84:87], v[204:207]
    s_waitcnt vmcnt(8)
    v_mfma_f32_16x16x32_bf16 v[192:195], a[0:3], a[88:91], v[192:195]
    ds_read_b64_tr_b16 v[84:85], v41 offset:0
    v_mfma_f32_16x16x32_bf16 v[196:199], a[4:7], a[88:91], v[196:199]
    ds_read_b64_tr_b16 v[86:87], v41 offset:2048
    buffer_load_dwordx4 a[124:127], v4, s[16:19], s94 offen offset:3072 sc1
    v_mfma_f32_16x16x32_bf16 v[200:203], a[8:11], a[88:91], v[200:203]
    ds_read_b64_tr_b16 v[88:89], v42 offset:0
    v_mfma_f32_16x16x32_bf16 v[204:207], a[12:15], a[88:91], v[204:207]
    s_waitcnt vmcnt(8)
    v_mfma_f32_16x16x32_bf16 v[192:195], a[16:19], a[92:95], v[192:195]
    ds_read_b64_tr_b16 v[90:91], v42 offset:2048
    v_mfma_f32_16x16x32_bf16 v[196:199], a[20:23], a[92:95], v[196:199]
    ds_read_b64_tr_b16 v[92:93], v43 offset:0
    s_add_u32 s94, s94, 4096
    buffer_load_dwordx4 a[128:131], v4, s[16:19], s94 offen offset:0 sc1
    v_mfma_f32_16x16x32_bf16 v[200:203], a[24:27], a[92:95], v[200:203]
    ds_read_b64_tr_b16 v[94:95], v43 offset:2048
    v_mfma_f32_16x16x32_bf16 v[204:207], a[176:179], a[92:95], v[204:207]
    s_waitcnt vmcnt(8)
    v_mfma_f32_16x16x32_bf16 v[192:195], a[180:183], a[96:99], v[192:195]
    ds_read_b64_tr_b16 v[96:97], v40 offset:4096
    v_mfma_f32_16x16x32_bf16 v[196:199], a[184:187], a[96:99], v[196:199]
    ds_read_b64_tr_b16 v[98:99], v40 offset:6144
    buffer_load_dwordx4 a[132:135], v4, s[16:19], s94 offen offset:1024 sc1
    v_mfma_f32_16x16x32_bf16 v[200:203], a[188:191], a[96:99], v[200:203]
    ds_read_b64_tr_b16 v[100:101], v41 offset:4096
    v_mfma_f32_16x16x32_bf16 v[204:207], a[28:31], a[96:99], v[204:207]
    s_waitcnt vmcnt(8)
    v_mfma_f32_16x16x32_bf16 v[192:195], a[192:195], a[100:103], v[192:195]
    ds_read_b64_tr_b16 v[102:103], v41 offset:6144
    v_mfma_f32_16x16x32_bf16 v[196:199], a[196:199], a[100:103], v[196:199]
    ds_read_b64_tr_b16 v[104:105], v42 offset:4096
    buffer_load_dwordx4 a[136:139], v4, s[16:19], s94 offen offset:2048 sc1
    v_mfma_f32_16x16x32_bf16 v[200:203], a[200:203], a[100:103], v[200:203]
    ds_read_b64_tr_b16 v[106:107], v42 offset:6144
    v_mfma_f32_16x16x32_bf16 v[204:207], a[204:207], a[100:103], v[204:207]
    s_waitcnt vmcnt(8)
    v_mfma_f32_16x16x32_bf16 v[192:195], a[32:35], a[104:107], v[192:195]
    ds_read_b64_tr_b16 v[108:109], v43 offset:4096
    v_mfma_f32_16x16x32_bf16 v[196:199], a[208:211], a[104:107], v[196:199]
    ds_read_b64_tr_b16 v[110:111], v43 offset:6144
    buffer_load_dwordx4 a[140:143], v4, s[16:19], s94 offen offset:3072 sc1
    v_mfma_f32_16x16x32_bf16 v[200:203], a[212:215], a[104:107], v[200:203]
    ds_read_b64_tr_b16 v[112:113], v40 offset:8192
    v_mfma_f32_16x16x32_bf16 v[204:207], a[216:219], a[104:107], v[204:207]
    s_waitcnt vmcnt(8)
    v_mfma_f32_16x16x32_bf16 v[192:195], a[220:223], a[108:111], v[192:195]
    ds_read_b64_tr_b16 v[114:115], v40 offset:10240
    v_mfma_f32_16x16x32_bf16 v[196:199], a[36:39], a[108:111], v[196:199]
    ds_read_b64_tr_b16 v[116:117], v41 offset:8192
    s_add_u32 s94, s94, 4096
    buffer_load_dwordx4 a[144:147], v4, s[16:19], s94 offen offset:0 sc1
    v_mfma_f32_16x16x32_bf16 v[200:203], a[224:227], a[108:111], v[200:203]
    ds_read_b64_tr_b16 v[118:119], v41 offset:10240
    v_mfma_f32_16x16x32_bf16 v[204:207], a[228:231], a[108:111], v[204:207]
    s_waitcnt vmcnt(8)
    v_mfma_f32_16x16x32_bf16 v[192:195], a[232:235], a[112:115], v[192:195]
    ds_read_b64_tr_b16 v[120:121], v42 offset:8192
    v_mfma_f32_16x16x32_bf16 v[196:199], a[236:239], a[112:115], v[196:199]
    ds_read_b64_tr_b16 v[122:123], v42 offset:10240
    buffer_load_dwordx4 a[148:151], v4, s[16:19], s94 offen offset:1024 sc1
    v_mfma_f32_16x16x32_bf16 v[200:203], a[40:43], a[112:115], v[200:203]
    ds_read_b64_tr_b16 v[124:125], v43 offset:8192
    v_mfma_f32_16x16x32_bf16 v[204:207], a[240:243], a[112:115], v[204:207]
    s_waitcnt vmcnt(8)
    v_mfma_f32_16x16x32_bf16 v[192:195], a[244:247], a[116:119], v[192:195]
    ds_read_b64_tr_b16 v[126:127], v43 offset:10240
    v_mfma_f32_16x16x32_bf16 v[196:199], a[248:251], a[116:119], v[196:199]
    ds_read_b64_tr_b16 v[128:129], v40 offset:12288
    buffer_load_dwordx4 a[152:155], v4, s[16:19], s94 offen offset:2048 sc1
    v_mfma_f32_16x16x32_bf16 v[200:203], a[252:255], a[116:119], v[200:203]
    ds_read_b64_tr_b16 v[130:131], v40 offset:14336
    v_mfma_f32_16x16x32_bf16 v[204:207], a[44:47], a[116:119], v[204:207]
    s_waitcnt vmcnt(8)
    v_mfma_f32_16x16x32_bf16 v[192:195], v[208:211], a[120:123], v[192:195]
    ds_read_b64_tr_b16 v[132:133], v41 offset:12288
    v_mfma_f32_16x16x32_bf16 v[196:199], v[212:215], a[120:123], v[196:199]
    ds_read_b64_tr_b16 v[134:135], v41 offset:14336
    buffer_load_dwordx4 a[156:159], v4, s[16:19], s94 offen offset:3072 sc1
    v_mfma_f32_16x16x32_bf16 v[200:203], v[216:219], a[120:123], v[200:203]
    ds_read_b64_tr_b16 v[136:137], v42 offset:12288
    v_mfma_f32_16x16x32_bf16 v[204:207], v[220:223], a[120:123], v[204:207]
    s_waitcnt vmcnt(8)
    v_mfma_f32_16x16x32_bf16 v[192:195], a[48:51], a[124:127], v[192:195]
    ds_read_b64_tr_b16 v[138:139], v42 offset:14336
    v_mfma_f32_16x16x32_bf16 v[196:199], v[224:227], a[124:127], v[196:199]
    ds_read_b64_tr_b16 v[140:141], v43 offset:12288
    s_add_u32 s94, s94, 4096
    buffer_load_dwordx4 a[160:163], v4, s[16:19], s94 offen offset:0 sc1
    v_mfma_f32_16x16x32_bf16 v[200:203], v[228:231], a[124:127], v[200:203]
    ds_read_b64_tr_b16 v[142:143], v43 offset:14336
    v_mfma_f32_16x16x32_bf16 v[204:207], v[232:235], a[124:127], v[204:207]
    s_waitcnt vmcnt(8)
    v_mfma_f32_16x16x32_bf16 v[192:195], v[236:239], a[128:131], v[192:195]
    ds_read_b64_tr_b16 a[0:1], v40 offset:16384
    v_mfma_f32_16x16x32_bf16 v[196:199], a[52:55], a[128:131], v[196:199]
    ds_read_b64_tr_b16 a[2:3], v40 offset:18432
    buffer_load_dwordx4 a[164:167], v4, s[16:19], s94 offen offset:1024 sc1
    v_mfma_f32_16x16x32_bf16 v[200:203], v[240:243], a[128:131], v[200:203]
    ds_read_b64_tr_b16 a[4:5], v41 offset:16384
    v_mfma_f32_16x16x32_bf16 v[204:207], v[244:247], a[128:131], v[204:207]
    s_waitcnt vmcnt(8)
    v_mfma_f32_16x16x32_bf16 v[192:195], v[248:251], a[132:135], v[192:195]
    ds_read_b64_tr_b16 a[6:7], v41 offset:18432
    v_mfma_f32_16x16x32_bf16 v[196:199], v[252:255], a[132:135], v[196:199]
    ds_read_b64_tr_b16 a[8:9], v42 offset:16384
    buffer_load_dwordx4 a[168:171], v4, s[16:19], s94 offen offset:2048 sc1
    v_mfma_f32_16x16x32_bf16 v[200:203], a[56:59], a[132:135], v[200:203]
    ds_read_b64_tr_b16 a[10:11], v42 offset:18432
    v_mfma_f32_16x16x32_bf16 v[204:207], v[144:147], a[132:135], v[204:207]
    s_waitcnt vmcnt(8)
    v_mfma_f32_16x16x32_bf16 v[192:195], v[148:151], a[136:139], v[192:195]
    ds_read_b64_tr_b16 a[12:13], v43 offset:16384
    v_mfma_f32_16x16x32_bf16 v[196:199], v[152:155], a[136:139], v[196:199]
    ds_read_b64_tr_b16 a[14:15], v43 offset:18432
    buffer_load_dwordx4 a[172:175], v4, s[16:19], s94 offen offset:3072 sc1
    v_mfma_f32_16x16x32_bf16 v[200:203], v[156:159], a[136:139], v[200:203]
    ds_read_b64_tr_b16 a[16:17], v40 offset:20480
    v_mfma_f32_16x16x32_bf16 v[204:207], a[60:63], a[136:139], v[204:207]
    s_waitcnt vmcnt(8)
    s_waitcnt lgkmcnt(15)
    v_mfma_f32_16x16x32_bf16 v[192:195], v[160:163], a[140:143], v[192:195]
    ds_read_b64_tr_b16 a[18:19], v40 offset:22528
    v_mfma_f32_16x16x32_bf16 v[196:199], v[164:167], a[140:143], v[196:199]
    ds_read_b64_tr_b16 a[20:21], v41 offset:20480
    v_mfma_f32_16x16x32_bf16 v[200:203], v[168:171], a[140:143], v[200:203]
    ds_read_b64_tr_b16 a[22:23], v41 offset:22528
    v_mfma_f32_16x16x32_bf16 v[204:207], v[172:175], a[140:143], v[204:207]
    s_waitcnt vmcnt(7)
    v_mfma_f32_16x16x32_bf16 v[192:195], v[176:179], a[144:147], v[192:195]
    ds_read_b64_tr_b16 a[24:25], v42 offset:20480
    v_mfma_f32_16x16x32_bf16 v[196:199], v[180:183], a[144:147], v[196:199]
    ds_read_b64_tr_b16 a[26:27], v42 offset:22528
    v_mfma_f32_16x16x32_bf16 v[200:203], v[184:187], a[144:147], v[200:203]
    ds_read_b64_tr_b16 a[176:177], v43 offset:20480
    v_mfma_f32_16x16x32_bf16 v[204:207], v[188:191], a[144:147], v[204:207]
    s_waitcnt vmcnt(6)
    v_mfma_f32_16x16x32_bf16 v[192:195], v[80:83], a[148:151], v[192:195]
    ds_read_b64_tr_b16 a[178:179], v43 offset:22528
    v_mfma_f32_16x16x32_bf16 v[196:199], v[84:87], a[148:151], v[196:199]
    ds_read_b64_tr_b16 a[180:181], v40 offset:24576
    v_mfma_f32_16x16x32_bf16 v[200:203], v[88:91], a[148:151], v[200:203]
    ds_read_b64_tr_b16 a[182:183], v40 offset:26624
    v_mfma_f32_16x16x32_bf16 v[204:207], v[92:95], a[148:151], v[204:207]
    s_waitcnt vmcnt(5)
    v_mfma_f32_16x16x32_bf16 v[192:195], v[96:99], a[152:155], v[192:195]
    ds_read_b64_tr_b16 a[184:185], v41 offset:24576
    v_mfma_f32_16x16x32_bf16 v[196:199], v[100:103], a[152:155], v[196:199]
    ds_read_b64_tr_b16 a[186:187], v41 offset:26624
    v_mfma_f32_16x16x32_bf16 v[200:203], v[104:107], a[152:155], v[200:203]
    ds_read_b64_tr_b16 a[188:189], v42 offset:24576
    v_mfma_f32_16x16x32_bf16 v[204:207], v[108:111], a[152:155], v[204:207]
    s_waitcnt vmcnt(4)
    v_mfma_f32_16x16x32_bf16 v[192:195], v[112:115], a[156:159], v[192:195]
    ds_read_b64_tr_b16 a[190:191], v42 offset:26624
    v_mfma_f32_16x16x32_bf16 v[196:199], v[116:119], a[156:159], v[196:199]
    ds_read_b64_tr_b16 a[28:29], v43 offset:24576
    v_mfma_f32_16x16x32_bf16 v[200:203], v[120:123], a[156:159], v[200:203]
    ds_read_b64_tr_b16 a[30:31], v43 offset:26624
    v_mfma_f32_16x16x32_bf16 v[204:207], v[124:127], a[156:159], v[204:207]
    s_waitcnt vmcnt(3)
    s_waitcnt lgkmcnt(15)
    v_mfma_f32_16x16x32_bf16 v[192:195], v[128:131], a[160:163], v[192:195]
    v_mfma_f32_16x16x32_bf16 v[196:199], v[132:135], a[160:163], v[196:199]
    v_mfma_f32_16x16x32_bf16 v[200:203], v[136:139], a[160:163], v[200:203]
    v_mfma_f32_16x16x32_bf16 v[204:207], v[140:143], a[160:163], v[204:207]
    s_waitcnt vmcnt(2)
    v_mfma_f32_16x16x32_bf16 v[192:195], a[0:3], a[164:167], v[192:195]
    v_mfma_f32_16x16x32_bf16 v[196:199], a[4:7], a[164:167], v[196:199]
    v_mfma_f32_16x16x32_bf16 v[200:203], a[8:11], a[164:167], v[200:203]
    v_mfma_f32_16x16x32_bf16 v[204:207], a[12:15], a[164:167], v[204:207]
    s_waitcnt vmcnt(1)
    s_waitcnt lgkmcnt(8)
    v_mfma_f32_16x16x32_bf16 v[192:195], a[16:19], a[168:171], v[192:195]
    v_mfma_f32_16x16x32_bf16 v[196:199], a[20:23], a[168:171], v[196:199]
    v_mfma_f32_16x16x32_bf16 v[200:203], a[24:27], a[168:171], v[200:203]
    v_mfma_f32_16x16x32_bf16 v[204:207], a[176:179], a[168:171], v[204:207]
    s_waitcnt vmcnt(0)
    s_waitcnt lgkmcnt(0)
    v_mfma_f32_16x16x32_bf16 v[192:195], a[180:183], a[172:175], v[192:195]
    v_mfma_f32_16x16x32_bf16 v[196:199], a[184:187], a[172:175], v[196:199]
    v_mfma_f32_16x16x32_bf16 v[200:203], a[188:191], a[172:175], v[200:203]
    v_mfma_f32_16x16x32_bf16 v[204:207], a[28:31], a[172:175], v[204:207]
    s_nop 4
    v_cvt_pk_bf16_f32 v64, v192, v193
    v_cvt_pk_bf16_f32 v65, v194, v195
    ds_write_b64 v44, v[64:65] offset:0
    v_cvt_pk_bf16_f32 v66, v196, v197
    v_cvt_pk_bf16_f32 v67, v198, v199
    ds_write_b64 v44, v[66:67] offset:32
    v_cvt_pk_bf16_f32 v68, v200, v201
    v_cvt_pk_bf16_f32 v69, v202, v203
    ds_write_b64 v44, v[68:69] offset:64
    v_cvt_pk_bf16_f32 v70, v204, v205
    v_cvt_pk_bf16_f32 v71, v206, v207
    ds_write_b64 v44, v[70:71] offset:96
    ds_read_b128 v[72:75], v45 offset:0
    ds_read_b128 v[76:79], v45 offset:1152
    s_waitcnt lgkmcnt(1)
    buffer_store_dwordx4 v[72:75], v46, s[28:31], s61 offen sc1
    s_waitcnt lgkmcnt(0)
    buffer_store_dwordx4 v[76:79], v46, s[28:31], s62 offen sc1
    s_or_b32 s47, s42, s36
    s_cbranch_scc1 Lnoep_25
    buffer_store_dword v5, off, s[16:19], 0 sc1
Lnoep_25:
    s_endpgm
LpathB:
    s_nop 1
    s_mov_b32 s23, 0x20000
    s_mov_b32 s27, 0x20000
    s_mov_b32 s31, 0x20000
    s_mov_b32 s22, 1204224
    s_mov_b32 s26, 25088
    s_mov_b32 s30, 896
    s_lshl_b32 s63, s37, 1
    s_add_u32 s63, s63, s38
    s_mul_i32 s45, s63, 43008
    s_mul_i32 s46, s36, 11264
    s_add_u32 s45, s45, s46
    s_mul_i32 s46, s36, 11264
    s_add_u32 s46, s46, 118784
    s_waitcnt lgkmcnt(0)
    s_mov_b64 s[20:21], s[82:83]
    s_add_u32 m0, s46, 0
    s_nop 0
    buffer_load_dwordx4 v4, s[20:23], s45 offen offset:0 lds
    buffer_load_dwordx4 v4, s[20:23], s45 offen offset:1024 lds
    buffer_load_dwordx4 v4, s[20:23], s45 offen offset:2048 lds
    buffer_load_dwordx4 v4, s[20:23], s45 offen offset:3072 lds
    s_add_u32 s45, s45, 4096
    s_add_u32 m0, s46, 4096
    s_nop 0
    buffer_load_dwordx4 v4, s[20:23], s45 offen offset:0 lds
    buffer_load_dwordx4 v4, s[20:23], s45 offen offset:1024 lds
    buffer_load_dwordx4 v4, s[20:23], s45 offen offset:2048 lds
    buffer_load_dwordx4 v4, s[20:23], s45 offen offset:3072 lds
    s_add_u32 s45, s45, 4096
    s_add_u32 m0, s46, 8192
    s_nop 0
    buffer_load_dwordx4 v4, s[20:23], s45 offen offset:0 lds
    buffer_load_dwordx4 v4, s[20:23], s45 offen offset:1024 lds
    buffer_load_dwordx4 v4, s[20:23], s45 offen offset:2048 lds
    s_add_u32 s45, s45, 4096
    s_mov_b64 s[24:25], s[84:85]
    s_mov_b64 s[28:29], s[74:75]
    v_and_b32 v132, 31, v0
    v_lshrrev_b32 v133, 5, v0
    v_lshlrev_b32 v133, 4, v133
    v_cmp_eq_u32 vcc, 28, v132
    v_mov_b32 v134, 0x100000
    s_lshl_b32 s45, s63, 5
    v_cndmask_b32 v133, v134, v133, vcc
    buffer_load_dwordx4 v[128:131], v133, s[28:31], s45 offen
    v_bfe_u32 v132, v0, 3, 2
    v_and_b32 v133, 3, v0
    v_lshl_add_u32 v132, v132, 2, v133
    v_cmp_gt_u32 vcc, 14, v132
    v_bfe_u32 v133, v0, 2, 1
    v_mul_u32_u24 v133, 14, v133
    v_add_lshl_u32 v132, v132, v133, 1
    v_cndmask_b32 v132, v134, v132, vcc
    s_lshr_b32 s45, s36, 1
    s_and_b32 s47, s36, 1
    s_lshl_b32 s45, s45, 3
    s_lshl_b32 s46, s47, 1
    s_add_u32 s45, s45, s46
    s_lshl_b32 s46, s38, 4
    s_add_u32 s45, s45, s46
    v_lshrrev_b32 v133, 5, v0
    v_lshl_add_u32 v133, v133, 2, s45
    v_cmp_gt_u32 vcc, 28, v133
    v_mul_u32_u24 v133, 56, v133
    v_add_u32 v132, v132, v133
    s_mul_i32 s45, s37, 1568
    v_cndmask_b32 v132, v134, v132, vcc
    buffer_load_ushort v135, v132, s[24:27], s45 offen offset:0
    buffer_load_ushort v136, v132, s[24:27], s45 offen offset:56
    s_mov_b64 s[4:5], s[80:81]
    s_nop 0
    s_buffer_load_dword s52, s[16:19], 0
    s_mov_b32 s34, 8388608
    s_mov_b32 s35, 0x20000
    s_mov_b32 s14, 4096
    s_mov_b32 s15, 0x20000
    s_mov_b64 s[32:33], s[92:93]
    s_mov_b64 s[12:13], s[94:95]
    s_mov_b32 s23, 0x20000
    s_mov_b32 s27, 0x20000
    s_mov_b32 s31, 0x20000
    s_mov_b64 s[20:21], s[86:87]
    s_mov_b32 s22, 401408
    s_mov_b64 s[24:25], s[72:73]
    s_mov_b32 s26, 802816
    s_mov_b64 s[28:29], s[76:77]
    s_mov_b32 s30, 1835008
    s_mov_b32 s42, s39
    s_mov_b32 s43, 400000
    s_lshl_b32 s79, s36, 13
    s_add_u32 s79, s79, 131072
    s_mov_b32 s64, 0xc0135761
    s_mov_b32 s65, 0xbdd2d3e8
    s_mov_b32 s66, 0x3fb8aa3b
    s_mov_b32 s67, 0xbfb8aa3b
    s_add_u32 m0, s51, 0
    s_nop 0
    buffer_load_dwordx4 v8, s[4:7], s56 offen lds
    s_mov_b32 s68, 0
    s_mov_b32 s69, -1
    s_mul_i32 s46, s40, 98304
    s_mul_i32 s45, s36, 3072
    s_add_u32 s46, s46, s45
    s_add_u32 s46, s46, 1048576
    v_add_u32 v7, s46, v4
    s_mul_i32 s76, s36, 3072
    s_lshl_b32 s75, s36, 11
    s_lshl_b32 s81, s36, 12
    s_lshl_b32 s85, s42, 8
    s_sub_u32 s85, s85, 128
    s_mul_i32 s80, s42, 229376
    buffer_load_dwordx4 v9, s[4:7], s56 offen offset:1024 lds
    s_sub_u32 s80, s80, 229376
    s_xor_b32 s74, s38, 1
    s_mul_i32 s74, s74, 7
    s_mul_i32 s84, s37, 401408
    s_mul_i32 s45, s74, 28672
    s_add_u32 s84, s84, s45
    s_mul_i32 s45, s36, 7168
    s_add_u32 s84, s84, s45
    s_add_u32 s84, s84, 4853760
    s_lshl_b32 s91, s44, 8
    s_lshl_b32 s45, s40, 2
    s_add_u32 s91, s91, s45
    s_add_u32 s91, s91, 32768
    buffer_load_dwordx4 v10, s[4:7], s56 offen offset:2048 lds
    s_lshl_b32 s77, s40, 11
    s_add_u32 s77, s77, 589824
    s_mov_b32 s42, s2
    v_and_b32 v60, 31, v0
    v_bfe_u32 v61, v0, 1, 3
    v_lshrrev_b32 v12, 5, v0
    v_xor_b32 v61, v61, v12
    v_lshl_add_u32 v60, v60, 7, s51
    v_lshl_add_u32 v12, v61, 4, v60
    v_xor_b32 v13, 32, v12
    v_xor_b32 v14, 64, v12
    v_xor_b32 v15, 96, v12
    v_add_u32 v16, 65536, v4
    buffer_load_dwordx4 v11, s[4:7], s56 offen offset:3072 lds
    s_lshl_b32 s45, s44, 17
    s_lshl_b32 s46, s38, 11
    s_add_u32 s45, s45, s46
    v_lshl_add_u32 v60, v1, 12, s45
    v_xor_b32 v61, v2, v3
    v_lshl_add_u32 v60, v61, 4, v60
    v_xor_b32 v61, 64, v60
    v_mov_b32 v17, v60
    v_add_u32 v18, 31744, v61
    v_add_u32 v19, 63488, v60
    v_add_u32 v20, 95232, v61
    v_and_b32 v60, 15, v0
    s_add_u32 m0, s51, 4096
    s_nop 0
    buffer_load_dwordx4 v8, s[4:7], s57 offen lds
    v_bfe_u32 v61, v0, 1, 3
    v_xor_b32 v61, v61, v3
    v_lshl_add_u32 v60, v60, 7, s51
    v_lshl_add_u32 v21, v61, 4, v60
    v_xor_b32 v22, 64, v21
    v_and_b32 v60, 31, v0
    v_mul_u32_u24 v60, 144, v60
    v_lshrrev_b32 v23, 5, v0
    v_lshl_add_u32 v23, v23, 5, v60
    v_add_u32 v23, s79, v23
    buffer_load_dwordx4 v9, s[4:7], s57 offen offset:1024 lds
    buffer_load_dwordx4 v10, s[4:7], s57 offen offset:2048 lds
    buffer_load_dwordx4 v11, s[4:7], s57 offen offset:3072 lds
    s_waitcnt lgkmcnt(0)
    s_mul_i32 s52, s52, 1664525
    s_add_u32 s52, s52, 1013904223
    s_mov_b32 s53, s52
    v_mov_b32 v5, s52
    v_and_b32 v132, 31, v0
    v_cmp_le_u32 s[70:71], 28, v132
    v_bfe_u32 v132, v0, 2, 2
    v_lshrrev_b32 v133, 5, v0
    v_lshl_add_u32 v132, v133, 3, v132
    v_mul_u32_u24 v132, 2688, v132
    v_bfe_u32 v133, v0, 4, 1
    v_lshl_add_u32 v132, v133, 5, v132
    v_and_b32 v133, 3, v0
    v_lshl_add_u32 v132, v133, 3, v132
    s_mul_i32 s45, s36, 224
    s_add_u32 s45, s45, 118784
    v_add_u32 v132, s45, v132
    s_mul_i32 s45, s36, 393216
    s_mul_i32 s46, s63, 3072
    s_add_u32 s45, s45, s46
    s_add_u32 s45, s45, 1048576
    s_lshl_b32 s47, s63, 10
    s_lshl_b32 s46, s36, 2
    s_add_u32 s47, s47, s46
    s_add_u32 s47, s47, 589824
    s_waitcnt vmcnt(11)
    s_barrier
    ds_read_b64_tr_b16 v[80:81], v132 offset:0
    ds_read_b64_tr_b16 v[82:83], v132 offset:10752
    ds_read_b64_tr_b16 v[84:85], v132 offset:896
    ds_read_b64_tr_b16 v[86:87], v132 offset:11648
    ds_read_b64_tr_b16 v[88:89], v132 offset:1792
    ds_read_b64_tr_b16 v[90:91], v132 offset:12544
    ds_read_b64_tr_b16 v[92:93], v132 offset:56
    ds_read_b64_tr_b16 v[94:95], v132 offset:10808
    ds_read_b64_tr_b16 v[96:97], v132 offset:952
    ds_read_b64_tr_b16 v[98:99], v132 offset:11704
    ds_read_b64_tr_b16 v[100:101], v132 offset:1848
    ds_read_b64_tr_b16 v[102:103], v132 offset:12600
    ds_read_b64_tr_b16 v[104:105], v132 offset:112
    ds_read_b64_tr_b16 v[106:107], v132 offset:10864
    ds_read_b64_tr_b16 v[108:109], v132 offset:1008
    ds_read_b64_tr_b16 v[110:111], v132 offset:11760
    ds_read_b64_tr_b16 v[112:113], v132 offset:1904
    ds_read_b64_tr_b16 v[114:115], v132 offset:12656
    ds_read_b64_tr_b16 v[116:117], v132 offset:168
    ds_read_b64_tr_b16 v[118:119], v132 offset:10920
    ds_read_b64_tr_b16 v[120:121], v132 offset:1064
    ds_read_b64_tr_b16 v[122:123], v132 offset:11816
    ds_read_b64_tr_b16 v[124:125], v132 offset:1960
    ds_read_b64_tr_b16 v[126:127], v132 offset:12712
    s_waitcnt vmcnt(8)
    v_lshl_or_b32 v135, v136, 16, v135
    buffer_store_dword v135, v4, s[16:19], s47 offen sc1
    s_waitcnt lgkmcnt(15)
    v_cndmask_b32_e64 v80, v80, v128, s[70:71]
    v_cndmask_b32_e64 v81, v81, v129, s[70:71]
    v_cndmask_b32_e64 v82, v82, v130, s[70:71]
    v_cndmask_b32_e64 v83, v83, v131, s[70:71]
    buffer_store_dwordx4 v[80:83], v4, s[16:19], s45 offen offset:1024 sc1
    v_cndmask_b32_e64 v84, v84, v128, s[70:71]
    v_cndmask_b32_e64 v85, v85, v129, s[70:71]
    v_cndmask_b32_e64 v86, v86, v130, s[70:71]
    v_cndmask_b32_e64 v87, v87, v131, s[70:71]
    buffer_store_dwordx4 v[84:87], v4, s[16:19], s45 offen offset:2048 sc1
    v_cndmask_b32_e64 v88, v88, v128, s[70:71]
    v_cndmask_b32_e64 v89, v89, v129, s[70:71]
    v_cndmask_b32_e64 v90, v90, v130, s[70:71]
    v_cndmask_b32_e64 v91, v91, v131, s[70:71]
    buffer_store_dwordx4 v[88:91], v4, s[16:19], s45 offen offset:0 sc1
    s_add_u32 s45, s45, 98304
    v_cndmask_b32_e64 v92, v92, v128, s[70:71]
    v_cndmask_b32_e64 v93, v93, v129, s[70:71]
    v_cndmask_b32_e64 v94, v94, v130, s[70:71]
    v_cndmask_b32_e64 v95, v95, v131, s[70:71]
    buffer_store_dwordx4 v[92:95], v4, s[16:19], s45 offen offset:1024 sc1
    v_cndmask_b32_e64 v96, v96, v128, s[70:71]
    s_waitcnt vmcnt(9)
    ds_read_b128 v[144:147], v12 offset:0
    ds_read_b128 v[148:151], v13 offset:0
    ds_read_b128 v[152:155], v14 offset:0
    ds_read_b128 v[156:159], v15 offset:0
    v_cndmask_b32_e64 v97, v97, v129, s[70:71]
    s_waitcnt lgkmcnt(15)
    v_cndmask_b32_e64 v98, v98, v130, s[70:71]
    v_cndmask_b32_e64 v99, v99, v131, s[70:71]
    buffer_store_dwordx4 v[96:99], v4, s[16:19], s45 offen offset:2048 sc1
    v_cndmask_b32_e64 v100, v100, v128, s[70:71]
    v_cndmask_b32_e64 v101, v101, v129, s[70:71]
    v_cndmask_b32_e64 v102, v102, v130, s[70:71]
    v_cndmask_b32_e64 v103, v103, v131, s[70:71]
    buffer_store_dwordx4 v[100:103], v4, s[16:19], s45 offen offset:0 sc1
    s_add_u32 s45, s45, 98304
    v_cndmask_b32_e64 v104, v104, v128, s[70:71]
    v_cndmask_b32_e64 v105, v105, v129, s[70:71]
    s_waitcnt lgkmcnt(14)
    v_cndmask_b32_e64 v106, v106, v130, s[70:71]
    v_cndmask_b32_e64 v107, v107, v131, s[70:71]
    buffer_store_dwordx4 v[104:107], v4, s[16:19], s45 offen offset:1024 sc1
    s_waitcnt vmcnt(8)
    ds_read_b128 v[160:163], v12 offset:4096
    ds_read_b128 v[164:167], v13 offset:4096
    ds_read_b128 v[168:171], v14 offset:4096
    ds_read_b128 v[172:175], v15 offset:4096
    s_waitcnt lgkmcnt(15)
    v_cndmask_b32_e64 v108, v108, v128, s[70:71]
    v_cndmask_b32_e64 v109, v109, v129, s[70:71]
    v_cndmask_b32_e64 v110, v110, v130, s[70:71]
    v_cndmask_b32_e64 v111, v111, v131, s[70:71]
    buffer_store_dwordx4 v[108:111], v4, s[16:19], s45 offen offset:2048 sc1
    v_cndmask_b32_e64 v112, v112, v128, s[70:71]
    v_cndmask_b32_e64 v113, v113, v129, s[70:71]
    s_waitcnt lgkmcnt(14)
    v_cndmask_b32_e64 v114, v114, v130, s[70:71]
    v_cndmask_b32_e64 v115, v115, v131, s[70:71]
    buffer_store_dwordx4 v[112:115], v4, s[16:19], s45 offen offset:0 sc1
    s_add_u32 s45, s45, 98304
    s_waitcnt lgkmcnt(13)
    v_cndmask_b32_e64 v116, v116, v128, s[70:71]
    v_cndmask_b32_e64 v117, v117, v129, s[70:71]
    s_waitcnt lgkmcnt(12)
    v_cndmask_b32_e64 v118, v118, v130, s[70:71]
    v_cndmask_b32_e64 v119, v119, v131, s[70:71]
    buffer_store_dwordx4 v[116:119], v4, s[16:19], s45 offen offset:1024 sc1
    s_waitcnt lgkmcnt(11)
    v_cndmask_b32_e64 v120, v120, v128, s[70:71]
    v_cndmask_b32_e64 v121, v121, v129, s[70:71]
    s_waitcnt lgkmcnt(10)
    v_cndmask_b32_e64 v122, v122, v130, s[70:71]
    v_cndmask_b32_e64 v123, v123, v131, s[70:71]
    buffer_store_dwordx4 v[120:123], v4, s[16:19], s45 offen offset:2048 sc1
    s_waitcnt lgkmcnt(9)
    v_cndmask_b32_e64 v124, v124, v128, s[70:71]
    v_cndmask_b32_e64 v125, v125, v129, s[70:71]
    s_waitcnt lgkmcnt(8)
    v_cndmask_b32_e64 v126, v126, v130, s[70:71]
    v_cndmask_b32_e64 v127, v127, v131, s[70:71]
    buffer_store_dwordx4 v[124:127], v4, s[16:19], s45 offen offset:0 sc1
    s_add_u32 s45, s45, 98304
    s_add_u32 m0, s51, 8192
    s_nop 0
    buffer_load_dwordx4 v8, s[4:7], s58 offen lds
    s_and_b32 s45, s63, 3
    s_and_b32 s47, s63, 28
    s_lshl_b32 s45, s45, 7
    s_add_u32 s45, s45, s47
    s_add_u32 s45, s45, 4096
    buffer_load_dwordx4 v9, s[4:7], s58 offen offset:1024 lds
    buffer_load_dwordx4 v10, s[4:7], s58 offen offset:2048 lds
    buffer_load_dwordx4 v11, s[4:7], s58 offen offset:3072 lds
    s_add_u32 m0, s51, 12288
    s_nop 0
    buffer_load_dwordx4 v8, s[4:7], s59 offen lds
    buffer_load_dwordx4 v9, s[4:7], s59 offen offset:1024 lds
    buffer_load_dwordx4 v10, s[4:7], s59 offen offset:2048 lds
    buffer_load_dwordx4 v11, s[4:7], s59 offen offset:3072 lds
    s_add_u32 m0, s51, 0
    s_waitcnt lgkmcnt(4)
    buffer_load_dwordx4 v8, s[4:7], s60 offen lds
    buffer_load_dwordx4 v9, s[4:7], s60 offen offset:1024 lds
    buffer_load_dwordx4 v10, s[4:7], s60 offen offset:2048 lds
    buffer_load_dwordx4 v11, s[4:7], s60 offen offset:3072 lds
    s_add_u32 m0, s51, 4096
    s_waitcnt lgkmcnt(0)
    buffer_load_dwordx4 v8, s[4:7], s61 offen lds
    buffer_load_dwordx4 v9, s[4:7], s61 offen offset:1024 lds
    buffer_load_dwordx4 v10, s[4:7], s61 offen offset:2048 lds
    buffer_load_dwordx4 v11, s[4:7], s61 offen offset:3072 lds
    s_waitcnt vmcnt(16)
    s_barrier
    s_cmp_lg_u32 s36, 0
    s_cbranch_scc1 Lnofl_30
    s_buffer_atomic_swap s52, s[16:19], s45
Lnofl_30:
    s_nop 0
    s_waitcnt vmcnt(12)
    ds_read_b128 v[176:179], v12 offset:8192
    ds_read_b128 v[180:183], v13 offset:8192
    ds_read_b128 v[184:187], v14 offset:8192
    ds_read_b128 v[188:191], v15 offset:8192
    s_waitcnt vmcnt(8)
    ds_read_b128 v[192:195], v12 offset:12288
    ds_read_b128 v[196:199], v13 offset:12288
    ds_read_b128 v[200:203], v14 offset:12288
    ds_read_b128 v[204:207], v15 offset:12288
    s_waitcnt vmcnt(4)
    ds_read_b128 v[208:211], v12 offset:0
    ds_read_b128 v[212:215], v13 offset:0
    ds_read_b128 v[216:219], v14 offset:0
    ds_read_b128 v[220:223], v15 offset:0
    s_waitcnt vmcnt(0)
    ds_read_b128 v[224:227], v12 offset:4096
    ds_read_b128 v[228:231], v13 offset:4096
    ds_read_b128 v[232:235], v14 offset:4096
    ds_read_b128 v[236:239], v15 offset:4096
    s_add_u32 m0, s51, 8192
    s_waitcnt lgkmcnt(12)
    buffer_load_dwordx4 v8, s[4:7], s62 offen lds
    buffer_load_dwordx4 v9, s[4:7], s62 offen offset:1024 lds
    buffer_load_dwordx4 v10, s[4:7], s62 offen offset:2048 lds
    buffer_load_dwordx4 v11, s[4:7], s62 offen offset:3072 lds
    s_add_u32 s85, s85, 128
    s_and_b32 s85, s85, 2047
    s_add_u32 m0, s51, 12288
    s_waitcnt lgkmcnt(8)
    buffer_load_dwordx4 v17, s[32:35], s85 offen lds
    buffer_load_dwordx4 v18, s[32:35], s85 offen offset:1024 lds
    buffer_load_dwordx4 v19, s[32:35], s85 offen offset:2048 lds
    buffer_load_dwordx4 v20, s[32:35], s85 offen offset:3072 lds
    s_add_u32 s85, s85, 128
    s_and_b32 s85, s85, 2047
    s_add_u32 m0, s51, 0
    s_waitcnt lgkmcnt(4)
    buffer_load_dwordx4 v17, s[32:35], s85 offen lds
    buffer_load_dwordx4 v18, s[32:35], s85 offen offset:1024 lds
    buffer_load_dwordx4 v19, s[32:35], s85 offen offset:2048 lds
    buffer_load_dwordx4 v20, s[32:35], s85 offen offset:3072 lds
    s_waitcnt vmcnt(0)
    s_lshl_b32 s70, s36, 7
    s_add_u32 s70, s70, 4096
    s_lshl_b32 s71, s36, 10
    s_not_b64 s[4:5], s[52:53]
    s_not_b64 s[6:7], s[52:53]
    s_not_b64 s[8:9], s[52:53]
    s_not_b64 s[10:11], s[52:53]
    s_buffer_load_dwordx8 s[4:11], s[16:19], s70 offset:0
    ds_read_b128 v[240:243], v12 offset:8192
    ds_read_b128 v[244:247], v13 offset:8192
    ds_read_b128 v[248:251], v14 offset:8192
    ds_read_b128 v[252:255], v15 offset:8192
    ds_read_b128 a[0:3], v21 offset:12288
    ds_read_b128 a[4:7], v21 offset:14336
    ds_read_b128 a[8:11], v22 offset:12288
    ds_read_b128 a[12:15], v22 offset:14336
    s_add_u32 s85, s85, 128
    s_and_b32 s85, s85, 2047
    s_add_u32 m0, s51, 4096
    s_waitcnt lgkmcnt(8)
    buffer_load_dwordx4 v17, s[32:35], s85 offen lds
    buffer_load_dwordx4 v18, s[32:35], s85 offen offset:1024 lds
    ds_read_b128 a[16:19], v21 offset:0
    ds_read_b128 a[20:23], v21 offset:2048
    ds_read_b128 a[24:27], v22 offset:0
    ds_read_b128 a[28:31], v22 offset:2048
    buffer_load_dwordx4 v19, s[32:35], s85 offen offset:2048 lds
    buffer_load_dwordx4 v20, s[32:35], s85 offen offset:3072 lds
    s_cmp_eq_u64 s[4:5], s[52:53]
    s_cbranch_scc0 Lslow_26
    s_cmp_eq_u64 s[6:7], s[52:53]
    s_cbranch_scc0 Lslow_26
    s_cmp_eq_u64 s[8:9], s[52:53]
    s_cbranch_scc0 Lslow_26
    s_cmp_eq_u64 s[10:11], s[52:53]
    s_cbranch_scc0 Lslow_26
Lback_27:
    s_nop 0
    s_mul_i32 s49, s56, 96
    s_add_u32 m0, s71, 63488
    s_nop 0
    buffer_load_dwordx4 v7, s[16:19], s49 offen offset:2048 sc1 lds
    s_mul_i32 s49, s57, 96
    s_add_u32 m0, s71, 67584
    s_nop 0
    buffer_load_dwordx4 v7, s[16:19], s49 offen offset:2048 sc1 lds
    s_mul_i32 s49, s58, 96
    s_add_u32 m0, s71, 71680
    s_nop 0
    buffer_load_dwordx4 v7, s[16:19], s49 offen offset:2048 sc1 lds
    s_mul_i32 s49, s59, 96
    s_add_u32 m0, s71, 75776
    s_nop 0
    buffer_load_dwordx4 v7, s[16:19], s49 offen offset:2048 sc1 lds
    s_waitcnt vmcnt(4)
    ds_read_b128 a[32:35], v21 offset:4096
    ds_read_b128 a[36:39], v21 offset:6144
    ds_read_b128 a[40:43], v22 offset:4096
    ds_read_b128 a[44:47], v22 offset:6144
    s_mul_i32 s49, s60, 96
    s_add_u32 m0, s71, 79872
    s_nop 0
    buffer_load_dwordx4 v7, s[16:19], s49 offen offset:2048 sc1 lds
    s_mul_i32 s49, s61, 96
    s_add_u32 m0, s71, 83968
    s_nop 0
    buffer_load_dwordx4 v7, s[16:19], s49 offen offset:2048 sc1 lds
    s_mul_i32 s49, s62, 96
    s_add_u32 m0, s71, 88064
    s_nop 0
    buffer_load_dwordx4 v7, s[16:19], s49 offen offset:2048 sc1 lds
    s_mul_i32 s49, s56, 96
    s_add_u32 m0, s75, 94208
    s_nop 0
    buffer_load_dwordx4 v7, s[16:19], s49 offen sc1 lds
    buffer_load_dwordx4 v7, s[16:19], s49 offen offset:1024 sc1 lds
    s_mul_i32 s49, s57, 96
    s_add_u32 m0, s75, 102400
    s_nop 0
    buffer_load_dwordx4 v7, s[16:19], s49 offen sc1 lds
    buffer_load_dwordx4 v7, s[16:19], s49 offen offset:1024 sc1 lds
    s_mul_i32 s49, s58, 96
    s_add_u32 m0, s75, 110592
    s_nop 0
    buffer_load_dwordx4 v7, s[16:19], s49 offen sc1 lds
    buffer_load_dwordx4 v7, s[16:19], s49 offen offset:1024 sc1 lds
    s_waitcnt vmcnt(9)
    s_mul_i32 s49, s59, 96
    s_add_u32 m0, s75, 118784
    s_nop 0
    buffer_load_dwordx4 v7, s[16:19], s49 offen sc1 lds
    s_barrier
    ds_read_b128 v[36:39], v16 offset:0
    ds_read_b128 v[40:43], v16 offset:1024
    ds_read_b128 v[44:47], v16 offset:2048
    ds_read_b128 v[48:51], v16 offset:3072
    buffer_load_dwordx4 v7, s[16:19], s49 offen offset:1024 sc1 lds
    v_min_u32 v24, 6, v1
    v_lshlrev_b32 v24, 7, v24
    v_lshl_add_u32 v24, v2, 3, v24
    s_mul_i32 s88, s38, 4092
    s_lshl_b32 s89, s36, 10
    s_add_u32 s88, s88, s89
    s_add_u32 s88, s88, 8196
    v_add_u32 v24, s88, v24
    s_mul_i32 s88, s38, 1835008
    s_waitcnt lgkmcnt(3)
    v_mfma_f32_32x32x16_bf16 v[128:143], v[36:39], v[144:147], 0
    s_waitcnt lgkmcnt(2)
    ds_read_b128 v[36:39], v16 offset:4096
    buffer_load_dwordx4 v[96:99], v4, s[16:19], s77 offen offset:0 sc1
    s_add_u32 s85, s85, 128
    s_and_b32 s85, s85, 2047
    s_add_u32 m0, s51, 8192
    v_mfma_f32_32x32x16_bf16 v[128:143], v[40:43], v[148:151], v[128:143]
    s_waitcnt lgkmcnt(2)
    ds_read_b128 v[40:43], v16 offset:5120
    s_mul_i32 s89, s36, 57344
    s_add_u32 s88, s88, s89
    s_lshl_b32 s89, s74, 12
    s_add_u32 s88, s88, s89
    s_add_u32 s88, s88, 11406336
    v_mfma_f32_32x32x16_bf16 v[128:143], v[44:47], v[152:155], v[128:143]
    s_waitcnt lgkmcnt(2)
    ds_read_b128 v[44:47], v16 offset:6144
    buffer_load_dwordx4 v[100:103], v4, s[16:19], s77 offen offset:1024 sc1
    v_add_u32 v26, s88, v4
    v_add_u32 v28, 7168, v26
    v_mfma_f32_32x32x16_bf16 v[128:143], v[48:51], v[156:159], v[128:143]
    s_waitcnt lgkmcnt(2)
    ds_read_b128 v[48:51], v16 offset:7168
    v_add_u32 v30, 14336, v26
    v_add_u32 v27, 4096, v26
    v_add_u32 v31, 19456, v26
    v_add_u32 v29, 12288, v26
    v_add_u32 v32, 23552, v26
    v_mfma_f32_32x32x16_bf16 v[128:143], v[36:39], v[160:163], v[128:143]
    s_waitcnt lgkmcnt(2)
    ds_read_b128 v[36:39], v16 offset:8192
    v_add_u32 v33, 131072, v4
    v_mfma_f32_32x32x16_bf16 v[128:143], v[40:43], v[164:167], v[128:143]
    s_waitcnt lgkmcnt(2)
    ds_read_b128 v[40:43], v16 offset:9216
    buffer_load_dwordx4 v17, s[32:35], s85 offen lds
    v_mfma_f32_32x32x16_bf16 v[128:143], v[44:47], v[168:171], v[128:143]
    s_waitcnt lgkmcnt(2)
    ds_read_b128 v[44:47], v16 offset:10240
    v_mfma_f32_32x32x16_bf16 v[128:143], v[48:51], v[172:175], v[128:143]
    s_waitcnt lgkmcnt(2)
    ds_read_b128 v[48:51], v16 offset:11264
    buffer_load_dwordx4 v18, s[32:35], s85 offen offset:1024 lds
    v_mfma_f32_32x32x16_bf16 v[128:143], v[36:39], v[176:179], v[128:143]
    s_waitcnt lgkmcnt(2)
    ds_read_b128 v[36:39], v16 offset:12288
    v_mfma_f32_32x32x16_bf16 v[128:143], v[40:43], v[180:183], v[128:143]
    s_waitcnt lgkmcnt(2)
    ds_read_b128 v[40:43], v16 offset:13312
    buffer_load_dwordx4 v19, s[32:35], s85 offen offset:2048 lds
    v_mfma_f32_32x32x16_bf16 v[128:143], v[44:47], v[184:187], v[128:143]
    s_waitcnt lgkmcnt(2)
    ds_read_b128 v[44:47], v16 offset:14336
    v_mfma_f32_32x32x16_bf16 v[128:143], v[48:51], v[188:191], v[128:143]
    s_waitcnt lgkmcnt(2)
    ds_read_b128 v[48:51], v16 offset:15360
    buffer_load_dwordx4 v20, s[32:35], s85 offen offset:3072 lds
    s_add_u32 s85, s85, 128
    s_and_b32 s85, s85, 2047
    s_add_u32 m0, s51, 12288
    v_mfma_f32_32x32x16_bf16 v[128:143], v[36:39], v[192:195], v[128:143]
    s_waitcnt lgkmcnt(2)
    s_waitcnt vmcnt(14)
    s_barrier
    ds_read_b128 v[36:39], v16 offset:16384
    buffer_load_dwordx4 v17, s[32:35], s85 offen lds
    v_mfma_f32_32x32x16_bf16 v[128:143], v[40:43], v[196:199], v[128:143]
    s_waitcnt lgkmcnt(2)
    ds_read_b128 v[40:43], v16 offset:17408
    v_mfma_f32_32x32x16_bf16 v[128:143], v[44:47], v[200:203], v[128:143]
    s_waitcnt lgkmcnt(2)
    ds_read_b128 v[44:47], v16 offset:18432
    v_mfma_f32_32x32x16_bf16 v[128:143], v[48:51], v[204:207], v[128:143]
    s_waitcnt lgkmcnt(2)
    ds_read_b128 v[48:51], v16 offset:19456
    buffer_load_dwordx4 v18, s[32:35], s85 offen offset:1024 lds
    v_mfma_f32_32x32x16_bf16 v[128:143], v[36:39], v[208:211], v[128:143]
    s_waitcnt lgkmcnt(2)
    ds_read_b128 v[36:39], v16 offset:20480
    v_mfma_f32_32x32x16_bf16 v[128:143], v[40:43], v[212:215], v[128:143]
    s_waitcnt lgkmcnt(2)
    ds_read_b128 v[40:43], v16 offset:21504
    buffer_load_dwordx4 v19, s[32:35], s85 offen offset:2048 lds
    v_mfma_f32_32x32x16_bf16 v[128:143], v[44:47], v[216:219], v[128:143]
    s_waitcnt lgkmcnt(2)
    ds_read_b128 v[44:47], v16 offset:22528
    v_mfma_f32_32x32x16_bf16 v[128:143], v[48:51], v[220:223], v[128:143]
    s_waitcnt lgkmcnt(2)
    ds_read_b128 v[48:51], v16 offset:23552
    buffer_load_dwordx4 v20, s[32:35], s85 offen offset:3072 lds
    s_add_u32 s85, s85, 128
    s_and_b32 s85, s85, 2047
    s_add_u32 m0, s51, 0
    v_mfma_f32_32x32x16_bf16 v[128:143], v[36:39], v[224:227], v[128:143]
    s_waitcnt lgkmcnt(2)
    ds_read_b128 v[36:39], v16 offset:24576
    v_mfma_f32_32x32x16_bf16 v[128:143], v[40:43], v[228:231], v[128:143]
    s_waitcnt lgkmcnt(2)
    ds_read_b128 v[40:43], v16 offset:25600
    buffer_load_dwordx4 v17, s[32:35], s85 offen lds
    v_mfma_f32_32x32x16_bf16 v[128:143], v[44:47], v[232:235], v[128:143]
    s_waitcnt lgkmcnt(2)
    ds_read_b128 v[44:47], v16 offset:26624
    v_mfma_f32_32x32x16_bf16 v[128:143], v[48:51], v[236:239], v[128:143]
    s_waitcnt lgkmcnt(2)
    ds_read_b128 v[48:51], v16 offset:27648
    v_mfma_f32_32x32x16_bf16 v[128:143], v[36:39], v[240:243], v[128:143]
    s_waitcnt lgkmcnt(2)
    s_waitcnt vmcnt(15)
    s_barrier
    ds_read_b128 v[36:39], v16 offset:28672
    buffer_load_dwordx4 v18, s[32:35], s85 offen offset:1024 lds
    v_mfma_f32_32x32x16_bf16 v[128:143], v[40:43], v[244:247], v[128:143]
    s_waitcnt lgkmcnt(2)
    ds_read_b128 v[40:43], v16 offset:29696
    v_mfma_f32_32x32x16_bf16 v[128:143], v[44:47], v[248:251], v[128:143]
    s_waitcnt lgkmcnt(2)
    ds_read_b128 v[44:47], v16 offset:30720
    v_mfma_f32_32x32x16_bf16 v[128:143], v[48:51], v[252:255], v[128:143]
    s_waitcnt lgkmcnt(2)
    ds_read_b128 v[48:51], v16 offset:31744
    buffer_load_dwordx4 v19, s[32:35], s85 offen offset:2048 lds
    v_mfma_f32_32x32x16_bf16 v[64:79], v[144:147], v[36:39], 0
    s_waitcnt lgkmcnt(2)
    ds_read_b128 v[36:39], v16 offset:32768
    v_mfma_f32_32x32x16_bf16 v[112:127], v[40:43], v[144:147], 0
    s_waitcnt lgkmcnt(2)
    ds_read_b128 v[40:43], v16 offset:33792
    buffer_load_dwordx4 v20, s[32:35], s85 offen offset:3072 lds
    s_mul_i32 s49, s60, 96
    s_add_u32 m0, s75, 65536
    v_cvt_pk_bf16_f32 v52, v128, v129
    v_cvt_pk_bf16_f32 v53, v130, v131
    v_mfma_f32_32x32x16_bf16 v[64:79], v[148:151], v[44:47], v[64:79]
    s_waitcnt lgkmcnt(2)
    ds_read_b128 v[44:47], v16 offset:34816
    v_cvt_pk_bf16_f32 v54, v132, v133
    v_cvt_pk_bf16_f32 v55, v134, v135
    v_cvt_pk_bf16_f32 v56, v136, v137
    v_cvt_pk_bf16_f32 v57, v138, v139
    v_cvt_pk_bf16_f32 v58, v140, v141
    v_mfma_f32_32x32x16_bf16 v[112:127], v[48:51], v[148:151], v[112:127]
    s_waitcnt lgkmcnt(2)
    ds_read_b128 v[48:51], v16 offset:35840
    buffer_load_dwordx4 v7, s[16:19], s49 offen sc1 lds
    v_cvt_pk_bf16_f32 v59, v142, v143
    s_waitcnt vmcnt(14)
    v_mfma_f32_32x32x16_bf16 v[128:143], v[96:99], v[52:55], 0
    s_waitcnt vmcnt(13)
    v_mfma_f32_32x32x16_bf16 v[128:143], v[100:103], v[56:59], v[128:143]
    buffer_load_dwordx4 v7, s[16:19], s49 offen offset:1024 sc1 lds
    s_mul_i32 s49, s61, 96
    s_add_u32 m0, s75, 73728
    v_mfma_f32_32x32x16_bf16 v[64:79], v[152:155], v[36:39], v[64:79]
    s_waitcnt lgkmcnt(2)
    ds_read_b128 v[36:39], v16 offset:36864
    v_mfma_f32_32x32x16_bf16 v[112:127], v[40:43], v[152:155], v[112:127]
    s_waitcnt lgkmcnt(2)
    ds_read_b128 v[40:43], v16 offset:37888
    buffer_load_dwordx4 v7, s[16:19], s49 offen sc1 lds
    v_mfma_f32_32x32x16_bf16 v[64:79], v[156:159], v[44:47], v[64:79]
    s_waitcnt lgkmcnt(2)
    ds_read_b128 v[44:47], v16 offset:38912
    s_waitcnt vmcnt(11)
    ds_read_b128 a[48:51], v21 offset:8192
    ds_read_b128 a[52:55], v21 offset:10240
    ds_read_b128 a[56:59], v22 offset:8192
    ds_read_b128 a[60:63], v22 offset:10240
    v_mfma_f32_32x32x16_bf16 v[112:127], v[48:51], v[156:159], v[112:127]
    s_waitcnt lgkmcnt(6)
    ds_read_b128 v[48:51], v16 offset:39936
    buffer_load_dwordx4 v7, s[16:19], s49 offen offset:1024 sc1 lds
    s_add_u32 s85, s85, 128
    s_and_b32 s85, s85, 2047
    s_add_u32 m0, s51, 4096
    v_mfma_f32_32x32x16_bf16 v[64:79], v[160:163], v[36:39], v[64:79]
    s_waitcnt lgkmcnt(6)
    ds_read_b128 v[36:39], v16 offset:40960
    v_max3_f32 v60, v128, v129, v130
    v_max3_f32 v62, -v128, -v129, -v130
    v_max3_f32 v60, v60, v131, v132
    v_max3_f32 v62, v62, -v131, -v132
    v_max3_f32 v60, v60, v133, v134
    v_mfma_f32_32x32x16_bf16 v[112:127], v[40:43], v[160:163], v[112:127]
    s_waitcnt lgkmcnt(6)
    ds_read_b128 v[40:43], v16 offset:41984
    buffer_load_dwordx4 v17, s[32:35], s85 offen lds
    v_max3_f32 v62, v62, -v133, -v134
    v_max3_f32 v60, v60, v135, v136
    v_mfma_f32_32x32x16_bf16 v[64:79], v[164:167], v[44:47], v[64:79]
    s_waitcnt lgkmcnt(2)
    ds_read_b128 v[44:47], v16 offset:43008
    v_mfma_f32_32x32x16_bf16 v[112:127], v[48:51], v[164:167], v[112:127]
    s_waitcnt lgkmcnt(2)
    ds_read_b128 v[48:51], v16 offset:44032
    buffer_load_dwordx4 v18, s[32:35], s85 offen offset:1024 lds
    v_max3_f32 v62, v62, -v135, -v136
    v_mfma_f32_32x32x16_bf16 v[64:79], v[168:171], v[36:39], v[64:79]
    s_waitcnt lgkmcnt(2)
    s_barrier
    ds_read_b128 v[36:39], v16 offset:45056
    buffer_load_dwordx4 v19, s[32:35], s85 offen offset:2048 lds
    v_mfma_f32_32x32x16_bf16 v[112:127], v[40:43], v[168:171], v[112:127]
    s_waitcnt lgkmcnt(2)
    ds_read_b128 v[40:43], v16 offset:46080
    v_max3_f32 v60, v60, v137, v138
    v_max3_f32 v62, v62, -v137, -v138
    v_max3_f32 v60, v60, v139, v140
    v_max3_f32 v62, v62, -v139, -v140
    v_max3_f32 v60, v60, v141, v141
    v_mfma_f32_32x32x16_bf16 v[64:79], v[172:175], v[44:47], v[64:79]
    s_waitcnt lgkmcnt(2)
    ds_read_b128 v[44:47], v16 offset:47104
    s_waitcnt vmcnt(11)
    ds_read_b128 a[64:67], v21 offset:12288
    ds_read_b128 a[68:71], v21 offset:14336
    ds_read_b128 a[72:75], v22 offset:12288
    ds_read_b128 a[76:79], v22 offset:14336
    v_mfma_f32_32x32x16_bf16 v[112:127], v[48:51], v[172:175], v[112:127]
    s_waitcnt lgkmcnt(6)
    ds_read_b128 v[48:51], v16 offset:48128
    buffer_load_dwordx4 v20, s[32:35], s85 offen offset:3072 lds
    s_mul_i32 s49, s62, 96
    s_add_u32 m0, s75, 81920
    v_max3_f32 v62, v62, -v141, -v141
    v_mfma_f32_32x32x16_bf16 v[64:79], v[176:179], v[36:39], v[64:79]
    s_waitcnt lgkmcnt(6)
    ds_read_b128 v[36:39], v16 offset:49152
    v_permlane32_swap_b32 v60, v62
    v_max_f32 v60, v60, v62
    v_mul_f32 v60, s67, v60
    v_mov_b32 v62, v60
    v_mfma_f32_32x32x16_bf16 v[112:127], v[40:43], v[176:179], v[112:127]
    s_waitcnt lgkmcnt(6)
    ds_read_b128 v[40:43], v16 offset:50176
    buffer_load_dwordx4 v7, s[16:19], s49 offen sc1 lds
    v_permlane32_swap_b32 v60, v62
    v_fma_f32 v144, v128, s67, v62
    v_mfma_f32_32x32x16_bf16 v[64:79], v[180:183], v[44:47], v[64:79]
    s_waitcnt lgkmcnt(2)
    ds_read_b128 v[44:47], v16 offset:51200
    v_mfma_f32_32x32x16_bf16 v[112:127], v[48:51], v[180:183], v[112:127]
    s_waitcnt lgkmcnt(2)
    ds_read_b128 v[48:51], v16 offset:52224
    buffer_load_dwordx4 v7, s[16:19], s49 offen offset:1024 sc1 lds
    s_add_u32 s85, s85, 128
    s_and_b32 s85, s85, 2047
    s_add_u32 m0, s51, 8192
    v_mfma_f32_32x32x16_bf16 v[64:79], v[184:187], v[36:39], v[64:79]
    s_waitcnt lgkmcnt(2)
    ds_read_b128 v[36:39], v16 offset:53248
    v_fma_f32 v128, v128, s66, v60
    v_fma_f32 v145, v129, s67, v62
    v_fma_f32 v129, v129, s66, v60
    v_fma_f32 v146, v130, s67, v62
    v_fma_f32 v130, v130, s66, v60
    v_mfma_f32_32x32x16_bf16 v[112:127], v[40:43], v[184:187], v[112:127]
    s_waitcnt lgkmcnt(2)
    ds_read_b128 v[40:43], v16 offset:54272
    buffer_load_dwordx4 v17, s[32:35], s85 offen lds
    v_fma_f32 v147, v131, s67, v62
    v_mfma_f32_32x32x16_bf16 v[64:79], v[188:191], v[44:47], v[64:79]
    s_waitcnt lgkmcnt(2)
    ds_read_b128 v[44:47], v16 offset:55296
    s_waitcnt vmcnt(11)
    ds_read_b128 a[80:83], v21 offset:0
    ds_read_b128 a[84:87], v21 offset:2048
    ds_read_b128 a[88:91], v22 offset:0
    ds_read_b128 a[92:95], v22 offset:2048
    v_mfma_f32_32x32x16_bf16 v[112:127], v[48:51], v[188:191], v[112:127]
    s_waitcnt lgkmcnt(6)
    ds_read_b128 v[48:51], v16 offset:56320
    buffer_load_dwordx4 v18, s[32:35], s85 offen offset:1024 lds
    v_fma_f32 v131, v131, s66, v60
    v_mfma_f32_32x32x16_bf16 v[64:79], v[192:195], v[36:39], v[64:79]
    s_waitcnt lgkmcnt(6)
    ds_read_b128 v[36:39], v16 offset:57344
    v_fma_f32 v148, v132, s67, v62
    v_fma_f32 v132, v132, s66, v60
    v_fma_f32 v149, v133, s67, v62
    v_fma_f32 v133, v133, s66, v60
    v_fma_f32 v150, v134, s67, v62
    v_mfma_f32_32x32x16_bf16 v[112:127], v[40:43], v[192:195], v[112:127]
    s_waitcnt lgkmcnt(6)
    ds_read_b128 v[40:43], v16 offset:58368
    buffer_load_dwordx4 v19, s[32:35], s85 offen offset:2048 lds
    v_fma_f32 v134, v134, s66, v60
    v_fma_f32 v151, v135, s67, v62
    v_mfma_f32_32x32x16_bf16 v[64:79], v[196:199], v[44:47], v[64:79]
    s_waitcnt lgkmcnt(2)
    ds_read_b128 v[44:47], v16 offset:59392
    v_mfma_f32_32x32x16_bf16 v[112:127], v[48:51], v[196:199], v[112:127]
    s_waitcnt lgkmcnt(2)
    ds_read_b128 v[48:51], v16 offset:60416
    buffer_load_dwordx4 v20, s[32:35], s85 offen offset:3072 lds
    s_add_u32 s85, s85, 128
    s_and_b32 s85, s85, 2047
    s_add_u32 m0, s51, 12288
    v_mfma_f32_32x32x16_bf16 v[64:79], v[200:203], v[36:39], v[64:79]
    s_waitcnt lgkmcnt(2)
    s_waitcnt vmcnt(12)
    s_barrier
    ds_read_b128 v[36:39], v16 offset:0
    buffer_load_dwordx4 v17, s[32:35], s85 offen lds
    v_mfma_f32_32x32x16_bf16 v[112:127], v[40:43], v[200:203], v[112:127]
    s_waitcnt lgkmcnt(2)
    ds_read_b128 v[40:43], v16 offset:1024
    v_fma_f32 v135, v135, s66, v60
    v_fma_f32 v152, v136, s67, v62
    v_fma_f32 v136, v136, s66, v60
    v_fma_f32 v153, v137, s67, v62
    v_fma_f32 v137, v137, s66, v60
    v_mfma_f32_32x32x16_bf16 v[64:79], v[204:207], v[44:47], v[64:79]
    s_waitcnt lgkmcnt(2)
    ds_read_b128 v[44:47], v16 offset:2048
    v_fma_f32 v154, v138, s67, v62
    v_fma_f32 v138, v138, s66, v60
    v_fma_f32 v155, v139, s67, v62
    v_fma_f32 v139, v139, s66, v60
    v_fma_f32 v156, v140, s67, v62
    v_mfma_f32_32x32x16_bf16 v[112:127], v[48:51], v[204:207], v[112:127]
    s_waitcnt lgkmcnt(2)
    ds_read_b128 v[48:51], v16 offset:3072
    buffer_load_dwordx4 v18, s[32:35], s85 offen offset:1024 lds
    v_fma_f32 v140, v140, s66, v60
    v_fma_f32 v157, v141, s67, v62
    v_mfma_f32_32x32x16_bf16 v[64:79], v[208:211], v[36:39], v[64:79]
    s_waitcnt lgkmcnt(2)
    ds_read_b128 v[36:39], v16 offset:4096
    v_fma_f32 v141, v141, s66, v60
    v_exp_f32 v128, v128
    v_exp_f32 v144, v144
    v_mfma_f32_32x32x16_bf16 v[112:127], v[40:43], v[208:211], v[112:127]
    s_waitcnt lgkmcnt(2)
    ds_read_b128 v[40:43], v16 offset:5120
    buffer_load_dwordx4 v19, s[32:35], s85 offen offset:2048 lds
    v_exp_f32 v129, v129
    v_mfma_f32_32x32x16_bf16 v[64:79], v[212:215], v[44:47], v[64:79]
    s_waitcnt lgkmcnt(2)
    ds_read_b128 v[44:47], v16 offset:6144
    v_exp_f32 v145, v145
    v_exp_f32 v130, v130
    v_bfe_u32 v176, v0, 2, 3
    v_mfma_f32_32x32x16_bf16 v[112:127], v[48:51], v[212:215], v[112:127]
    s_waitcnt lgkmcnt(2)
    ds_read_b128 v[48:51], v16 offset:7168
    buffer_load_dwordx4 v20, s[32:35], s85 offen offset:3072 lds
    s_add_u32 s85, s85, 128
    s_and_b32 s85, s85, 2047
    s_add_u32 m0, s51, 0
    v_lshrrev_b32 v178, 5, v0
    v_mfma_f32_32x32x16_bf16 v[64:79], v[216:219], v[36:39], v[64:79]
    s_waitcnt lgkmcnt(2)
    s_waitcnt vmcnt(14)
    s_barrier
    ds_read_b128 v[36:39], v16 offset:8192
    buffer_load_dwordx4 v17, s[32:35], s85 offen lds
    v_mfma_f32_32x32x16_bf16 v[112:127], v[40:43], v[216:219], v[112:127]
    s_waitcnt lgkmcnt(2)
    ds_read_b128 v[40:43], v16 offset:9216
    v_exp_f32 v146, v146
    v_exp_f32 v131, v131
    v_lshl_add_u32 v176, v178, 4, v176
    v_mfma_f32_32x32x16_bf16 v[64:79], v[220:223], v[44:47], v[64:79]
    s_waitcnt lgkmcnt(2)
    ds_read_b128 v[44:47], v16 offset:10240
    s_waitcnt vmcnt(11)
    ds_read_b128 a[96:99], v21 offset:4096
    ds_read_b128 a[100:103], v21 offset:6144
    ds_read_b128 a[104:107], v22 offset:4096
    ds_read_b128 a[108:111], v22 offset:6144
    v_mfma_f32_32x32x16_bf16 v[112:127], v[48:51], v[220:223], v[112:127]
    s_waitcnt lgkmcnt(6)
    ds_read_b128 v[48:51], v16 offset:11264
    buffer_load_dwordx4 v18, s[32:35], s85 offen offset:1024 lds
    v_mul_u32_u24 v176, 144, v176
    v_mfma_f32_32x32x16_bf16 v[64:79], v[224:227], v[36:39], v[64:79]
    s_waitcnt lgkmcnt(6)
    ds_read_b128 v[36:39], v16 offset:12288
    v_exp_f32 v147, v147
    v_exp_f32 v132, v132
    v_and_b32 v34, 15, v0
    v_mfma_f32_32x32x16_bf16 v[112:127], v[40:43], v[224:227], v[112:127]
    s_waitcnt lgkmcnt(6)
    ds_read_b128 v[40:43], v16 offset:13312
    buffer_load_dwordx4 v19, s[32:35], s85 offen offset:2048 lds
    v_exp_f32 v148, v148
    v_mfma_f32_32x32x16_bf16 v[64:79], v[228:231], v[44:47], v[64:79]
    s_waitcnt lgkmcnt(2)
    ds_read_b128 v[44:47], v16 offset:14336
    v_mfma_f32_32x32x16_bf16 v[112:127], v[48:51], v[228:231], v[112:127]
    s_waitcnt lgkmcnt(2)
    ds_read_b128 v[48:51], v16 offset:15360
    buffer_load_dwordx4 v20, s[32:35], s85 offen offset:3072 lds
    s_add_u32 s85, s85, 128
    s_and_b32 s85, s85, 2047
    s_add_u32 m0, s51, 4096
    v_mfma_f32_32x32x16_bf16 v[64:79], v[232:235], v[36:39], v[64:79]
    s_waitcnt lgkmcnt(2)
    s_waitcnt vmcnt(12)
    s_barrier
    ds_read_b128 v[36:39], v16 offset:16384
    buffer_load_dwordx4 v17, s[32:35], s85 offen lds
    v_mfma_f32_32x32x16_bf16 v[112:127], v[40:43], v[232:235], v[112:127]
    s_waitcnt lgkmcnt(2)
    ds_read_b128 v[40:43], v16 offset:17408
    v_exp_f32 v133, v133
    v_exp_f32 v149, v149
    v_lshlrev_b32 v34, 4, v34
    v_mfma_f32_32x32x16_bf16 v[64:79], v[236:239], v[44:47], v[64:79]
    s_waitcnt lgkmcnt(2)
    ds_read_b128 v[44:47], v16 offset:18432
    v_exp_f32 v134, v134
    v_exp_f32 v150, v150
    v_lshl_add_u32 v34, v3, 9, v34
    v_mfma_f32_32x32x16_bf16 v[112:127], v[48:51], v[236:239], v[112:127]
    s_waitcnt lgkmcnt(2)
    ds_read_b128 v[48:51], v16 offset:19456
    buffer_load_dwordx4 v18, s[32:35], s85 offen offset:1024 lds
    v_exp_f32 v135, v135
    v_mfma_f32_32x32x16_bf16 v[64:79], v[240:243], v[36:39], v[64:79]
    s_waitcnt lgkmcnt(2)
    ds_read_b128 v[36:39], v16 offset:20480
    v_exp_f32 v151, v151
    v_exp_f32 v136, v136
    v_and_b32 v178, 1, v0
    v_mfma_f32_32x32x16_bf16 v[112:127], v[40:43], v[240:243], v[112:127]
    s_waitcnt lgkmcnt(2)
    ds_read_b128 v[40:43], v16 offset:21504
    buffer_load_dwordx4 v19, s[32:35], s85 offen offset:2048 lds
    v_exp_f32 v152, v152
    v_mfma_f32_32x32x16_bf16 v[64:79], v[244:247], v[44:47], v[64:79]
    s_waitcnt lgkmcnt(2)
    ds_read_b128 v[44:47], v16 offset:22528
    s_waitcnt vmcnt(11)
    ds_read_b128 a[112:115], v21 offset:8192
    ds_read_b128 a[116:119], v21 offset:10240
    ds_read_b128 a[120:123], v22 offset:8192
    ds_read_b128 a[124:127], v22 offset:10240
    v_mfma_f32_32x32x16_bf16 v[112:127], v[48:51], v[244:247], v[112:127]
    s_waitcnt lgkmcnt(6)
    ds_read_b128 v[48:51], v16 offset:23552
    buffer_load_dwordx4 v20, s[32:35], s85 offen offset:3072 lds
    v_lshl_add_u32 v176, v178, 5, v176
    v_mfma_f32_32x32x16_bf16 v[64:79], v[248:251], v[36:39], v[64:79]
    s_waitcnt lgkmcnt(6)
    v_exp_f32 v137, v137
    v_exp_f32 v153, v153
    v_exp_f32 v138, v138
    v_mfma_f32_32x32x16_bf16 v[112:127], v[40:43], v[248:251], v[112:127]
    s_waitcnt lgkmcnt(5)
    v_exp_f32 v154, v154
    v_exp_f32 v139, v139
    v_exp_f32 v155, v155
    v_mfma_f32_32x32x16_bf16 v[64:79], v[252:255], v[44:47], v[64:79]
    s_waitcnt lgkmcnt(0)
    s_add_u32 s85, s85, 128
    s_and_b32 s85, s85, 2047
    v_mfma_f32_32x32x16_bf16 v[112:127], v[48:51], v[252:255], v[112:127]
    s_add_u32 m0, s51, 8192
    s_nop 0
    buffer_load_dwordx4 v17, s[32:35], s85 offen lds
    buffer_load_dwordx4 v18, s[32:35], s85 offen offset:1024 lds
    buffer_load_dwordx4 v19, s[32:35], s85 offen offset:2048 lds
    v_exp_f32 v140, v140
    v_exp_f32 v156, v156
    v_exp_f32 v141, v141
    v_exp_f32 v157, v157
    v_add_f32 v60, v128, v129
    v_add_f32 v62, v144, v145
    v_add_f32 v60, v60, v130
    v_add_f32 v62, v62, v146
    v_add_f32 v60, v60, v131
    buffer_load_dwordx4 v20, s[32:35], s85 offen offset:3072 lds
    s_waitcnt vmcnt(12)
    ds_read_b128 a[128:131], v21 offset:12288
    ds_read_b128 a[132:135], v21 offset:14336
    ds_read_b128 a[136:139], v22 offset:12288
    ds_read_b128 a[140:143], v22 offset:14336
    v_add_f32 v62, v62, v147
    v_add_f32 v60, v60, v132
    v_add_f32 v62, v62, v148
    v_add_f32 v60, v60, v133
    v_add_f32 v62, v62, v149
    v_add_f32 v60, v60, v134
    v_add_f32 v62, v62, v150
    v_add_f32 v60, v60, v135
    v_add_f32 v62, v62, v151
    v_add_f32 v60, v60, v136
    v_add_f32 v62, v62, v152
    v_add_f32 v60, v60, v137
    v_add_f32 v62, v62, v153
    v_add_f32 v60, v60, v138
    v_add_f32 v62, v62, v154
    v_add_f32 v60, v60, v139
    v_add_f32 v62, v62, v155
    v_add_f32 v60, v60, v140
    v_add_f32 v62, v62, v156
    v_add_f32 v60, v60, v141
    v_add_f32 v62, v62, v157
    s_nop 1
    v_permlane32_swap_b32 v60, v62
    s_add_u32 s85, s85, 128
    s_and_b32 s85, s85, 2047
    s_add_u32 m0, s51, 12288
    s_waitcnt lgkmcnt(0)
    buffer_load_dwordx4 v17, s[32:35], s85 offen lds
    buffer_load_dwordx4 v18, s[32:35], s85 offen offset:1024 lds
    v_add_f32 v60, v60, v62
    v_rcp_f32 v60, v60
    s_nop 0
    v_mov_b32 v62, v60
    s_nop 1
    v_permlane32_swap_b32 v60, v62
    buffer_load_dwordx4 v19, s[32:35], s85 offen offset:2048 lds
    v_mov_b32 v167, 0
    v_mov_b32 v175, 0
    v_bfe_u32 v178, v0, 1, 1
    v_lshl_add_u32 v176, v178, 3, v176
    s_lshr_b32 s45, s36, 1
    s_and_b32 s47, s36, 1
    s_lshl_b32 s45, s45, 6
    s_lshl_b32 s46, s47, 4
    s_add_u32 s45, s45, s46
    s_add_u32 s45, s45, 131072
    buffer_load_dwordx4 v20, s[32:35], s85 offen offset:3072 lds
    v_add_u32 v176, s45, v176
    s_waitcnt vmcnt(12)
    ds_read_b128 a[144:147], v21 offset:0
    ds_read_b128 a[148:151], v21 offset:2048
    ds_read_b128 a[152:155], v22 offset:0
    ds_read_b128 a[156:159], v22 offset:2048
    v_add_u32 v177, s79, v4
    v_add_u32 v178, 136192, v34
    v_mov_b32 v179, 0x3f803f80
    s_mov_b32 s70, 0x10000000
    s_mov_b32 s71, 0x10000000
    s_mul_i32 s45, s40, 133120
    s_mul_i32 s46, s37, 8320
    s_add_u32 s45, s45, s46
    s_lshl_b32 s46, s36, 11
    s_add_u32 s45, s45, s46
    s_add_u32 s45, s45, 2621440
    v_pk_mul_f32 v[128:129], v[128:129], v[60:61] op_sel_hi:[1,0]
    v_pk_mul_f32 v[130:131], v[130:131], v[60:61] op_sel_hi:[1,0]
    v_pk_mul_f32 v[132:133], v[132:133], v[60:61] op_sel_hi:[1,0]
    v_pk_mul_f32 v[134:135], v[134:135], v[60:61] op_sel_hi:[1,0]
    v_cvt_pk_bf16_f32 v160, v128, v129
    v_cvt_pk_bf16_f32 v161, v130, v131
    v_cvt_pk_bf16_f32 v162, v132, v133
    v_cvt_pk_bf16_f32 v163, v134, v135
    ds_write_b128 v23, v[160:163] offset:0
    s_add_u32 s85, s85, 128
    s_and_b32 s85, s85, 2047
    s_add_u32 m0, s51, 0
    s_waitcnt lgkmcnt(1)
    buffer_load_dwordx4 v17, s[32:35], s85 offen lds
    v_pk_mul_f32 v[136:137], v[136:137], v[60:61] op_sel_hi:[1,0]
    v_pk_mul_f32 v[138:139], v[138:139], v[60:61] op_sel_hi:[1,0]
    v_pk_mul_f32 v[140:141], v[140:141], v[60:61] op_sel_hi:[1,0]
    v_cvt_pk_bf16_f32 v164, v136, v137
    v_cvt_pk_bf16_f32 v165, v138, v139
    v_cvt_pk_bf16_f32 v166, v140, v141
    ds_write_b128 v23, v[164:167] offset:16
    buffer_load_dwordx4 v18, s[32:35], s85 offen offset:1024 lds
    v_pk_mul_f32 v[144:145], v[144:145], v[62:63] op_sel_hi:[1,0]
    v_pk_mul_f32 v[146:147], v[146:147], v[62:63] op_sel_hi:[1,0]
    v_pk_mul_f32 v[148:149], v[148:149], v[62:63] op_sel_hi:[1,0]
    v_pk_mul_f32 v[150:151], v[150:151], v[62:63] op_sel_hi:[1,0]
    v_cvt_pk_bf16_f32 v168, v144, v145
    v_cvt_pk_bf16_f32 v169, v146, v147
    v_cvt_pk_bf16_f32 v170, v148, v149
    v_cvt_pk_bf16_f32 v171, v150, v151
    ds_write_b128 v23, v[168:171] offset:64
    s_waitcnt vmcnt(10)
    ds_read_b128 a[160:163], v21 offset:4096
    ds_read_b128 a[164:167], v21 offset:6144
    ds_read_b128 a[168:171], v22 offset:4096
    ds_read_b128 a[172:175], v22 offset:6144
    v_pk_mul_f32 v[152:153], v[152:153], v[62:63] op_sel_hi:[1,0]
    buffer_load_dwordx4 v19, s[32:35], s85 offen offset:2048 lds
    v_pk_mul_f32 v[154:155], v[154:155], v[62:63] op_sel_hi:[1,0]
    v_pk_mul_f32 v[156:157], v[156:157], v[62:63] op_sel_hi:[1,0]
    v_cvt_pk_bf16_f32 v172, v152, v153
    v_cvt_pk_bf16_f32 v173, v154, v155
    v_cvt_pk_bf16_f32 v174, v156, v157
    ds_write_b128 v23, v[172:175] offset:80
    v_cvt_pk_bf16_f32 v232, v64, v65
    buffer_load_dwordx4 v20, s[32:35], s85 offen offset:3072 lds
    v_cvt_pk_bf16_f32 v233, v66, v67
    v_cvt_pk_bf16_f32 v234, v68, v69
    v_cvt_pk_bf16_f32 v235, v70, v71
    s_add_u32 s85, s85, 128
    s_and_b32 s85, s85, 2047
    s_add_u32 m0, s51, 4096
    s_waitcnt lgkmcnt(1)
    buffer_load_dwordx4 v17, s[32:35], s85 offen lds
    v_cvt_pk_bf16_f32 v236, v72, v73
    v_cvt_pk_bf16_f32 v237, v74, v75
    v_cvt_pk_bf16_f32 v238, v76, v77
    v_cvt_pk_bf16_f32 v239, v78, v79
    v_cndmask_b32_e64 v232, v232, v179, s[70:71]
    v_cndmask_b32_e64 v233, v233, v179, s[70:71]
    v_cndmask_b32_e64 v234, v234, v179, s[70:71]
    v_cndmask_b32_e64 v235, v235, v179, s[70:71]
    ds_write_b128 v177, v[232:235] offset:5120
    buffer_load_dwordx4 v18, s[32:35], s85 offen offset:1024 lds
    v_cndmask_b32_e64 v236, v236, v179, s[70:71]
    v_cndmask_b32_e64 v237, v237, v179, s[70:71]
    s_waitcnt vmcnt(10)
    ds_read_b128 a[176:179], v21 offset:8192
    ds_read_b128 a[180:183], v21 offset:10240
    ds_read_b128 a[184:187], v22 offset:8192
    ds_read_b128 a[188:191], v22 offset:10240
    v_cndmask_b32_e64 v238, v238, v179, s[70:71]
    buffer_load_dwordx4 v19, s[32:35], s85 offen offset:2048 lds
    v_cndmask_b32_e64 v239, v239, v179, s[70:71]
    ds_write_b128 v177, v[236:239] offset:6144
    v_mov_b32 v50, v124
    v_mov_b32 v54, v124
    s_nop 1
    v_permlane32_swap_b32 v50, v54
    v_cvt_pk_bf16_f32 v224, v112, v113
    buffer_load_dwordx4 v20, s[32:35], s85 offen offset:3072 lds
    v_cvt_pk_bf16_f32 v225, v114, v115
    v_cvt_pk_bf16_f32 v226, v116, v117
    v_cvt_pk_bf16_f32 v227, v118, v119
    s_add_u32 s85, s85, 128
    s_and_b32 s85, s85, 2047
    s_add_u32 m0, s51, 8192
    s_waitcnt lgkmcnt(1)
    buffer_load_dwordx4 v17, s[32:35], s85 offen lds
    v_cvt_pk_bf16_f32 v228, v120, v121
    v_cvt_pk_bf16_f32 v229, v122, v123
    v_cvt_pk_bf16_f32 v230, v124, v125
    v_cvt_pk_bf16_f32 v231, v126, v127
    v_mfma_f32_32x32x16_bf16 v[112:127], v[96:99], v[224:227], 0
    s_nop 0
    v_mfma_f32_32x32x16_bf16 v[112:127], v[100:103], v[228:231], v[112:127]
    s_waitcnt lgkmcnt(0)
    s_barrier
    ds_read_b64_tr_b16 v[240:241], v176 offset:0
    ds_read_b64_tr_b16 v[242:243], v176 offset:1152
    ds_read_b128 v[128:131], v178 offset:0
    buffer_load_dwordx4 v18, s[32:35], s85 offen offset:1024 lds
    ds_read_b128 v[64:67], v178 offset:256
    s_waitcnt vmcnt(10)
    ds_read_b128 a[192:195], v21 offset:12288
    ds_read_b128 a[196:199], v21 offset:14336
    ds_read_b128 a[200:203], v22 offset:12288
    ds_read_b128 a[204:207], v22 offset:14336
    ds_read_b64_tr_b16 v[244:245], v176 offset:8192
    buffer_load_dwordx4 v19, s[32:35], s85 offen offset:2048 lds
    ds_read_b64_tr_b16 v[246:247], v176 offset:9344
    ds_read_b128 v[132:135], v178 offset:8192
    ds_read_b128 v[68:71], v178 offset:8448
    ds_read_b64_tr_b16 v[248:249], v176 offset:16384
    ds_read_b64_tr_b16 v[250:251], v176 offset:17536
    buffer_load_dwordx4 v20, s[32:35], s85 offen offset:3072 lds
    ds_read_b128 v[136:139], v178 offset:16384
    ds_read_b128 v[72:75], v178 offset:16640
    ds_read_b64_tr_b16 v[252:253], v176 offset:24576
    ds_read_b64_tr_b16 v[254:255], v176 offset:25728
    ds_read_b128 v[140:143], v178 offset:24576
    ds_read_b128 v[76:79], v178 offset:24832
    v_mul_f32 v54, s67, v54
    v_exp_f32 v54, v54
    s_nop 0
    v_add_f32 v54, 1.0, v54
    v_rcp_f32 v54, v54
    s_waitcnt lgkmcnt(15)
    v_mfma_f32_16x16x32_bf16 v[144:147], v[240:243], v[128:131], 0
    v_mfma_f32_16x16x32_bf16 v[148:151], v[240:243], v[64:67], 0
    s_waitcnt lgkmcnt(9)
    v_mfma_f32_16x16x32_bf16 v[144:147], v[244:247], v[132:135], v[144:147]
    s_waitcnt lgkmcnt(8)
    v_mfma_f32_16x16x32_bf16 v[148:151], v[244:247], v[68:71], v[148:151]
    s_waitcnt vmcnt(8)
    ds_read_b128 a[208:211], v21 offset:0
    ds_read_b128 a[212:215], v21 offset:2048
    ds_read_b128 a[216:219], v22 offset:0
    s_waitcnt lgkmcnt(8)
    v_mfma_f32_16x16x32_bf16 v[144:147], v[248:251], v[136:139], v[144:147]
    ds_read_b128 a[220:223], v22 offset:2048
    s_waitcnt lgkmcnt(8)
    v_mfma_f32_16x16x32_bf16 v[148:151], v[248:251], v[72:75], v[148:151]
    s_waitcnt lgkmcnt(5)
    v_mfma_f32_16x16x32_bf16 v[144:147], v[252:255], v[140:143], v[144:147]
    s_waitcnt lgkmcnt(4)
    v_mfma_f32_16x16x32_bf16 v[148:151], v[252:255], v[76:79], v[148:151]
    v_mov_b32 v82, 0
    v_mov_b32 v83, s52
    v_mov_b32 v86, 0
    v_mov_b32 v87, s52
    v_mov_b32 v90, 0
    v_mov_b32 v91, s52
    v_mov_b32 v94, 0
    v_mov_b32 v95, s52
    v_mov_b32 v98, 0
    v_mov_b32 v99, s52
    v_mov_b32 v102, 0
    v_mov_b32 v103, s52
    v_max3_f32 v50, v112, v113, v114
    v_max3_f32 v52, -v112, -v113, -v114
    v_max3_f32 v50, v50, v115, v116
    v_max3_f32 v52, v52, -v115, -v116
    v_max3_f32 v50, v50, v117, v118
    v_max3_f32 v52, v52, -v117, -v118
    v_max3_f32 v50, v50, v119, v120
    v_max3_f32 v52, v52, -v119, -v120
    v_max3_f32 v50, v50, v121, v122
    v_max3_f32 v52, v52, -v121, -v122
    v_max3_f32 v50, v50, v123, v124
    v_max3_f32 v52, v52, -v123, -v124
    v_max3_f32 v50, v50, v125, v125
    v_max3_f32 v52, v52, -v125, -v125
    s_nop 1
    v_permlane32_swap_b32 v50, v52
    v_max_f32 v50, v50, v52
    v_mul_f32 v50, s67, v50
    v_mov_b32 v52, v50
    s_nop 1
    v_permlane32_swap_b32 v50, v52
    v_fma_f32 v36, v112, s67, v52
    v_fma_f32 v112, v112, s66, v50
    v_fma_f32 v37, v113, s67, v52
    v_fma_f32 v113, v113, s66, v50
    v_fma_f32 v38, v114, s67, v52
    v_fma_f32 v114, v114, s66, v50
    v_fma_f32 v39, v115, s67, v52
    s_waitcnt vmcnt(4)
    ds_read_b128 a[224:227], v21 offset:4096
    ds_read_b128 a[228:231], v21 offset:6144
    ds_read_b128 a[232:235], v22 offset:4096
    ds_read_b128 a[236:239], v22 offset:6144
    v_fma_f32 v115, v115, s66, v50
    v_fma_f32 v40, v116, s67, v52
    v_fma_f32 v116, v116, s66, v50
    v_fma_f32 v41, v117, s67, v52
    v_fma_f32 v117, v117, s66, v50
    v_fma_f32 v42, v118, s67, v52
    v_fma_f32 v118, v118, s66, v50
    v_fma_f32 v43, v119, s67, v52
    v_fma_f32 v119, v119, s66, v50
    v_fma_f32 v44, v120, s67, v52
    v_fma_f32 v120, v120, s66, v50
    v_fma_f32 v45, v121, s67, v52
    v_fma_f32 v121, v121, s66, v50
    v_fma_f32 v46, v122, s67, v52
    v_fma_f32 v122, v122, s66, v50
    buffer_load_dword v25, v24, s[16:19], 0 offen offset:0 sc1
    v_fma_f32 v47, v123, s67, v52
    v_fma_f32 v123, v123, s66, v50
    v_fma_f32 v48, v124, s67, v52
    v_fma_f32 v124, v124, s66, v50
    v_fma_f32 v49, v125, s67, v52
    v_fma_f32 v125, v125, s66, v50
    v_exp_f32 v112, v112
    v_exp_f32 v36, v36
    v_exp_f32 v113, v113
    v_exp_f32 v37, v37
    v_exp_f32 v114, v114
    v_exp_f32 v38, v38
    v_exp_f32 v115, v115
    v_exp_f32 v39, v39
    v_exp_f32 v116, v116
    v_exp_f32 v40, v40
    v_exp_f32 v117, v117
    v_exp_f32 v41, v41
    v_exp_f32 v118, v118
    v_exp_f32 v42, v42
    v_exp_f32 v119, v119
    v_exp_f32 v43, v43
    s_waitcnt vmcnt(1)
    ds_read_b128 a[240:243], v21 offset:8192
    ds_read_b128 a[244:247], v21 offset:10240
    ds_read_b128 a[248:251], v22 offset:8192
    ds_read_b128 a[252:255], v22 offset:10240
    v_exp_f32 v120, v120
    v_exp_f32 v44, v44
    v_exp_f32 v121, v121
    v_exp_f32 v45, v45
    v_exp_f32 v122, v122
    v_exp_f32 v46, v46
    v_exp_f32 v123, v123
    v_exp_f32 v47, v47
    v_exp_f32 v124, v124
    v_exp_f32 v48, v48
    v_exp_f32 v125, v125
    v_exp_f32 v49, v49
    s_waitcnt lgkmcnt(0)
    s_barrier
    v_add_f32 v50, v112, v113
    v_add_f32 v52, v36, v37
    v_add_f32 v50, v50, v114
    v_add_f32 v52, v52, v38
    v_add_f32 v50, v50, v115
    v_add_f32 v52, v52, v39
    v_add_f32 v50, v50, v116
    v_add_f32 v52, v52, v40
    v_add_f32 v50, v50, v117
    v_add_f32 v52, v52, v41
    v_add_f32 v50, v50, v118
    v_add_f32 v52, v52, v42
    v_add_f32 v50, v50, v119
    v_add_f32 v52, v52, v43
    v_add_f32 v50, v50, v120
    v_add_f32 v52, v52, v44
    v_add_f32 v50, v50, v121
    v_add_f32 v52, v52, v45
    v_add_f32 v50, v50, v122
    v_add_f32 v52, v52, v46
    v_add_f32 v50, v50, v123
    v_add_f32 v52, v52, v47
    v_add_f32 v50, v50, v124
    v_add_f32 v52, v52, v48
    v_add_f32 v50, v50, v125
    v_add_f32 v52, v52, v49
    s_nop 1
    v_permlane32_swap_b32 v50, v52
    v_add_f32 v50, v50, v52
    v_rcp_f32 v50, v50
    s_nop 0
    v_mov_b32 v52, v50
    s_nop 1
    v_permlane32_swap_b32 v50, v52
    v_mov_b32 v183, 0
    v_mov_b32 v191, 0
    v_mul_f32 v112, v112, v50
    v_mul_f32 v113, v113, v50
    v_mul_f32 v114, v114, v50
    v_mul_f32 v115, v115, v50
    v_mul_f32 v116, v116, v50
    v_mul_f32 v117, v117, v50
    v_mul_f32 v118, v118, v50
    v_mul_f32 v119, v119, v50
    v_cvt_pk_bf16_f32 v176, v112, v113
    v_cvt_pk_bf16_f32 v177, v114, v115
    v_cvt_pk_bf16_f32 v178, v116, v117
    v_cvt_pk_bf16_f32 v179, v118, v119
    v_mul_f32 v120, v120, v50
    v_mul_f32 v121, v121, v50
    v_mul_f32 v122, v122, v50
    v_mul_f32 v123, v123, v50
    v_mul_f32 v124, v124, v50
    v_mul_f32 v125, v125, v50
    v_cvt_pk_bf16_f32 v180, v120, v121
    v_cvt_pk_bf16_f32 v181, v122, v123
    v_cvt_pk_bf16_f32 v182, v124, v125
    v_mul_f32 v36, v36, v52
    v_mul_f32 v37, v37, v52
    v_mul_f32 v38, v38, v52
    v_mul_f32 v39, v39, v52
    v_mul_f32 v40, v40, v52
    v_mul_f32 v41, v41, v52
    v_mul_f32 v42, v42, v52
    v_mul_f32 v43, v43, v52
    v_cvt_pk_bf16_f32 v184, v36, v37
    v_cvt_pk_bf16_f32 v185, v38, v39
    v_cvt_pk_bf16_f32 v186, v40, v41
    v_cvt_pk_bf16_f32 v187, v42, v43
    v_mul_f32 v44, v44, v52
    v_mul_f32 v45, v45, v52
    v_mul_f32 v46, v46, v52
    v_mul_f32 v47, v47, v52
    v_mul_f32 v48, v48, v52
    v_mul_f32 v49, v49, v52
    v_cvt_pk_bf16_f32 v188, v44, v45
    v_cvt_pk_bf16_f32 v189, v46, v47
    v_cvt_pk_bf16_f32 v190, v48, v49
    s_waitcnt vmcnt(0)
    v_cmp_ne_u32 s[54:55], s52, v25
    s_nop 0
    s_cmp_eq_u64 s[54:55], 0
    s_cbranch_scc0 Lslow_31
Lback_32:
    s_nop 0
    s_add_u32 s80, s80, 229376
    s_cmp_eq_u32 s80, 1835008
    s_cselect_b32 s80, 0, s80
    s_add_u32 m0, s76, 65536
    s_nop 0
    buffer_load_dwordx4 v26, s[16:19], s80 offen sc1 lds
    buffer_load_dwordx4 v28, s[16:19], s80 offen offset:1024 sc1 lds
    buffer_load_dwordx4 v30, s[16:19], s80 offen offset:2048 sc1 lds
    s_add_u32 s80, s80, 229376
    s_cmp_eq_u32 s80, 1835008
    s_cselect_b32 s80, 0, s80
    s_add_u32 m0, s76, 77824
    s_nop 0
    buffer_load_dwordx4 v28, s[16:19], s80 offen offset:1024 sc1 lds
    buffer_load_dwordx4 v30, s[16:19], s80 offen offset:2048 sc1 lds
    s_add_u32 s80, s80, 229376
    s_cmp_eq_u32 s80, 1835008
    s_cselect_b32 s80, 0, s80
    s_add_u32 m0, s76, 90112
    s_nop 0
    buffer_load_dwordx4 v28, s[16:19], s80 offen offset:1024 sc1 lds
    buffer_load_dwordx4 v30, s[16:19], s80 offen offset:2048 sc1 lds
    s_add_u32 s80, s80, 229376
    s_cmp_eq_u32 s80, 1835008
    s_cselect_b32 s80, 0, s80
    s_add_u32 m0, s76, 102400
    s_nop 0
    buffer_load_dwordx4 v26, s[16:19], s80 offen sc1 lds
    buffer_load_dwordx4 v30, s[16:19], s80 offen offset:2048 sc1 lds
    s_add_u32 s80, s80, 229376
    s_cmp_eq_u32 s80, 1835008
    s_cselect_b32 s80, 0, s80
    s_add_u32 m0, s76, 114688
    s_nop 0
    buffer_load_dwordx4 v26, s[16:19], s80 offen sc1 lds
    buffer_load_dwordx4 v30, s[16:19], s80 offen offset:2048 sc1 lds
    s_waitcnt vmcnt(8)
    s_barrier
    s_add_u32 s80, s80, 229376
    s_cmp_eq_u32 s80, 1835008
    s_cselect_b32 s80, 0, s80
    s_add_u32 m0, s76, 126976
    s_nop 0
    buffer_load_dwordx4 v26, s[16:19], s80 offen sc1 lds
    ds_read_b128 v[224:227], v16 offset:0
    ds_read_b128 v[228:231], v16 offset:3072
    ds_read_b128 v[232:235], v16 offset:6144
    ds_read_b128 v[236:239], v16 offset:9216
    ds_read_b128 v[240:243], v16 offset:1024
    ds_read_b128 v[244:247], v16 offset:4096
    ds_read_b128 v[248:251], v16 offset:7168
    buffer_load_dwordx4 v28, s[16:19], s80 offen offset:1024 sc1 lds
    s_add_u32 s80, s80, 229376
    s_cmp_eq_u32 s80, 1835008
    s_cselect_b32 s80, 0, s80
    s_add_u32 m0, s76, 139264
    s_nop 0
    buffer_load_dwordx4 v26, s[16:19], s80 offen sc1 lds
    ds_read_b128 v[252:255], v16 offset:10240
    s_waitcnt lgkmcnt(7)
    v_mfma_f32_16x16x32_bf16 v[192:195], v[224:227], a[0:3], 0
    s_waitcnt lgkmcnt(6)
    v_mfma_f32_16x16x32_bf16 v[192:195], v[228:231], a[8:11], v[192:195]
    s_waitcnt lgkmcnt(4)
    v_mfma_f32_16x16x32_bf16 v[192:195], v[232:235], a[16:19], v[192:195]
    v_mfma_f32_16x16x32_bf16 v[192:195], v[236:239], a[24:27], v[192:195]
    buffer_load_dwordx4 v28, s[16:19], s80 offen offset:1024 sc1 lds
    s_add_u32 s80, s80, 229376
    s_mov_b32 s89, 0x07060500
    s_cmp_eq_u32 s80, 1835008
    s_cselect_b32 s80, 0, s80
    v_mfma_f32_16x16x32_bf16 v[196:199], v[224:227], a[4:7], 0
    s_add_u32 m0, s76, 151552
    ds_read_b128 v[224:227], v16 offset:2048
    v_perm_b32 v144, v144, v5, s89
    v_mfma_f32_16x16x32_bf16 v[196:199], v[228:231], a[12:15], v[196:199]
    v_perm_b32 v148, v148, v5, s89
    s_mov_b32 s89, 0x07060501
    v_mfma_f32_16x16x32_bf16 v[196:199], v[232:235], a[20:23], v[196:199]
    ds_read_b128 v[228:231], v16 offset:5120
    v_perm_b32 v145, v145, v5, s89
    v_mfma_f32_16x16x32_bf16 v[196:199], v[236:239], a[28:31], v[196:199]
    s_waitcnt lgkmcnt(4)
    buffer_load_dwordx4 v26, s[16:19], s80 offen sc1 lds
    v_mfma_f32_16x16x32_bf16 v[200:203], v[240:243], a[0:3], 0
    ds_read_b128 v[232:235], v16 offset:8192
    v_perm_b32 v149, v149, v5, s89
    v_mfma_f32_16x16x32_bf16 v[200:203], v[244:247], a[8:11], v[200:203]
    s_waitcnt lgkmcnt(3)
    s_mov_b32 s89, 0x07060502
    v_perm_b32 v146, v146, v5, s89
    v_mfma_f32_16x16x32_bf16 v[200:203], v[248:251], a[16:19], v[200:203]
    ds_read_b128 v[236:239], v16 offset:11264
    v_perm_b32 v150, v150, v5, s89
    v_mfma_f32_16x16x32_bf16 v[200:203], v[252:255], a[24:27], v[200:203]
    s_mov_b32 s89, 0x07060503
    buffer_load_dwordx4 v28, s[16:19], s80 offen offset:1024 sc1 lds
    v_mfma_f32_16x16x32_bf16 v[204:207], v[240:243], a[4:7], 0
    s_waitcnt vmcnt(12)
    s_barrier
    ds_read_b128 v[240:243], v16 offset:13312
    v_mfma_f32_16x16x32_bf16 v[204:207], v[244:247], a[12:15], v[204:207]
    v_perm_b32 v147, v147, v5, s89
    v_perm_b32 v151, v151, v5, s89
    v_mfma_f32_16x16x32_bf16 v[204:207], v[248:251], a[20:23], v[204:207]
    ds_read_b128 v[244:247], v16 offset:16384
    buffer_store_dwordx4 v[144:147], v34, s[16:19], s45 offen offset:0 sc1
    v_mfma_f32_16x16x32_bf16 v[204:207], v[252:255], a[28:31], v[204:207]
    s_waitcnt lgkmcnt(4)
    v_mfma_f32_16x16x32_bf16 v[208:211], v[224:227], a[0:3], 0
    ds_read_b128 v[248:251], v16 offset:19456
    buffer_store_dwordx4 v[148:151], v34, s[16:19], s45 offen offset:256 sc1
    v_mfma_f32_16x16x32_bf16 v[208:211], v[228:231], a[8:11], v[208:211]
    s_waitcnt lgkmcnt(3)
    v_lshrrev_b32 v23, 2, v0
    v_mul_u32_u24 v23, 8320, v23
    v_mfma_f32_16x16x32_bf16 v[208:211], v[232:235], a[16:19], v[208:211]
    ds_read_b128 v[252:255], v16 offset:22528
    buffer_load_dwordx4 v30, s[16:19], s80 offen offset:2048 sc1 lds
    s_add_u32 s80, s80, 229376
    s_cmp_eq_u32 s80, 1835008
    s_cselect_b32 s80, 0, s80
    v_mfma_f32_16x16x32_bf16 v[208:211], v[236:239], a[24:27], v[208:211]
    s_add_u32 m0, s75, 0
    v_and_b32 v35, 3, v0
    v_lshl_add_u32 v23, v35, 4, v23
    v_mfma_f32_16x16x32_bf16 v[212:215], v[224:227], a[4:7], 0
    s_lshr_b32 s88, s37, 2
    ds_read_b128 v[224:227], v16 offset:14336
    s_lshl_b32 s88, s88, 10
    v_mfma_f32_16x16x32_bf16 v[212:215], v[228:231], a[12:15], v[212:215]
    s_lshl_b32 s89, s44, 6
    s_add_u32 s88, s88, s89
    s_mul_i32 s89, s40, 133120
    v_mfma_f32_16x16x32_bf16 v[212:215], v[232:235], a[20:23], v[212:215]
    s_add_u32 s88, s88, s89
    ds_read_b128 v[228:231], v16 offset:17408
    buffer_load_dwordx4 v27, s[16:19], s80 offen sc1 lds
    s_add_u32 s88, s88, 2621440
    v_mfma_f32_16x16x32_bf16 v[212:215], v[236:239], a[28:31], v[212:215]
    s_waitcnt lgkmcnt(4)
    v_and_b32 v58, 3, v0
    v_lshlrev_b32 v58, 4, v58
    v_mfma_f32_16x16x32_bf16 v[200:203], v[240:243], a[32:35], v[200:203]
    ds_read_b128 v[232:235], v16 offset:20480
    v_lshrrev_b32 v35, 5, v0
    v_mfma_f32_16x16x32_bf16 v[200:203], v[244:247], a[40:43], v[200:203]
    s_waitcnt lgkmcnt(3)
    v_lshl_add_u32 v58, v35, 10, v58
    s_lshr_b32 s82, s37, 2
    v_mfma_f32_16x16x32_bf16 v[200:203], v[248:251], a[48:51], v[200:203]
    s_lshl_b32 s82, s82, 10
    ds_read_b128 v[236:239], v16 offset:23552
    buffer_load_dwordx4 v31, s[16:19], s80 offen offset:1024 sc1 lds
    s_add_u32 s80, s80, 229376
    s_lshl_b32 s89, s44, 6
    s_cmp_eq_u32 s80, 1835008
    s_cselect_b32 s80, 0, s80
    v_mfma_f32_16x16x32_bf16 v[200:203], v[252:255], a[56:59], v[200:203]
    s_add_u32 m0, s75, 8192
    s_add_u32 s82, s82, s89
    s_lshl_b32 s89, s40, 13
    v_mfma_f32_16x16x32_bf16 v[204:207], v[252:255], a[60:63], v[204:207]
    s_waitcnt vmcnt(13)
    s_barrier
    buffer_load_dwordx4 v27, s[16:19], s80 offen sc1 lds
    s_add_u32 s82, s82, s89
    s_add_u32 s82, s82, 655360
    ds_read_b128 v[252:255], v16 offset:25600
    v_mfma_f32_16x16x32_bf16 v[204:207], v[248:251], a[52:55], v[204:207]
    s_lshl_b32 s83, s40, 13
    s_lshl_b32 s89, s36, 11
    s_add_u32 s83, s83, s89
    v_mfma_f32_16x16x32_bf16 v[204:207], v[244:247], a[44:47], v[204:207]
    s_add_u32 s83, s83, 655360
    ds_read_b128 v[248:251], v16 offset:28672
    s_mov_b32 s89, 0x0c0c0400
    v_mfma_f32_16x16x32_bf16 v[204:207], v[240:243], a[36:39], v[204:207]
    s_waitcnt lgkmcnt(4)
    v_mfma_f32_16x16x32_bf16 v[208:211], v[224:227], a[32:35], v[208:211]
    ds_read_b128 v[244:247], v16 offset:31744
    buffer_load_dwordx4 v31, s[16:19], s80 offen offset:1024 sc1 lds
    s_add_u32 s80, s80, 229376
    s_cmp_eq_u32 s80, 1835008
    s_cselect_b32 s80, 0, s80
    v_mfma_f32_16x16x32_bf16 v[208:211], v[228:231], a[40:43], v[208:211]
    s_waitcnt lgkmcnt(3)
    s_add_u32 m0, s75, 16384
    v_mfma_f32_16x16x32_bf16 v[208:211], v[232:235], a[48:51], v[208:211]
    ds_read_b128 v[240:243], v16 offset:34816
    v_mfma_f32_16x16x32_bf16 v[208:211], v[236:239], a[56:59], v[208:211]
    v_mfma_f32_16x16x32_bf16 v[212:215], v[236:239], a[60:63], v[212:215]
    ds_read_b128 v[236:239], v16 offset:26624
    buffer_load_dwordx4 v31, s[16:19], s80 offen offset:1024 sc1 lds
    s_add_u32 s80, s80, 229376
    s_cmp_eq_u32 s80, 1835008
    s_cselect_b32 s80, 0, s80
    v_mfma_f32_16x16x32_bf16 v[212:215], v[232:235], a[52:55], v[212:215]
    s_add_u32 m0, s75, 24576
    v_mfma_f32_16x16x32_bf16 v[212:215], v[228:231], a[44:47], v[212:215]
    ds_read_b128 v[232:235], v16 offset:29696
    v_mfma_f32_16x16x32_bf16 v[212:215], v[224:227], a[36:39], v[212:215]
    s_waitcnt lgkmcnt(4)
    v_mfma_f32_16x16x32_bf16 v[200:203], v[252:255], a[64:67], v[200:203]
    ds_read_b128 v[228:231], v16 offset:32768
    buffer_load_dwordx4 v31, s[16:19], s80 offen offset:1024 sc1 lds
    s_add_u32 s80, s80, 229376
    s_cmp_eq_u32 s80, 1835008
    s_cselect_b32 s80, 0, s80
    v_mfma_f32_16x16x32_bf16 v[200:203], v[248:251], a[72:75], v[200:203]
    s_waitcnt lgkmcnt(3)
    s_add_u32 m0, s75, 32768
    v_mfma_f32_16x16x32_bf16 v[200:203], v[244:247], a[80:83], v[200:203]
    ds_read_b128 v[224:227], v16 offset:35840
    v_mfma_f32_16x16x32_bf16 v[200:203], v[240:243], a[88:91], v[200:203]
    v_mfma_f32_16x16x32_bf16 v[204:207], v[240:243], a[92:95], v[204:207]
    ds_read_b128 v[240:243], v16 offset:36864
    buffer_load_dwordx4 v27, s[16:19], s80 offen sc1 lds
    v_mfma_f32_16x16x32_bf16 v[204:207], v[244:247], a[84:87], v[204:207]
    v_mfma_f32_16x16x32_bf16 v[204:207], v[248:251], a[76:79], v[204:207]
    ds_read_b128 v[244:247], v16 offset:39936
    v_mfma_f32_16x16x32_bf16 v[204:207], v[252:255], a[68:71], v[204:207]
    s_waitcnt lgkmcnt(4)
    v_mfma_f32_16x16x32_bf16 v[208:211], v[236:239], a[64:67], v[208:211]
    ds_read_b128 v[248:251], v16 offset:43008
    buffer_load_dwordx4 v31, s[16:19], s80 offen offset:1024 sc1 lds
    s_add_u32 s80, s80, 229376
    s_cmp_eq_u32 s80, 1835008
    s_cselect_b32 s80, 0, s80
    v_mfma_f32_16x16x32_bf16 v[208:211], v[232:235], a[72:75], v[208:211]
    s_waitcnt lgkmcnt(3)
    s_add_u32 m0, s75, 40960
    v_mfma_f32_16x16x32_bf16 v[208:211], v[228:231], a[80:83], v[208:211]
    ds_read_b128 v[252:255], v16 offset:46080
    v_mfma_f32_16x16x32_bf16 v[208:211], v[224:227], a[88:91], v[208:211]
    v_mfma_f32_16x16x32_bf16 v[212:215], v[224:227], a[92:95], v[212:215]
    ds_read_b128 v[224:227], v16 offset:38912
    buffer_load_dwordx4 v27, s[16:19], s80 offen sc1 lds
    v_mfma_f32_16x16x32_bf16 v[212:215], v[228:231], a[84:87], v[212:215]
    v_mfma_f32_16x16x32_bf16 v[212:215], v[232:235], a[76:79], v[212:215]
    ds_read_b128 v[228:231], v16 offset:41984
    v_mfma_f32_16x16x32_bf16 v[212:215], v[236:239], a[68:71], v[212:215]
    s_waitcnt lgkmcnt(4)
    v_mfma_f32_16x16x32_bf16 v[192:195], v[240:243], a[96:99], v[192:195]
    ds_read_b128 v[232:235], v16 offset:45056
    buffer_load_dwordx4 v31, s[16:19], s80 offen offset:1024 sc1 lds
    s_add_u32 s80, s80, 229376
    s_cmp_eq_u32 s80, 1835008
    s_cselect_b32 s80, 0, s80
    v_mfma_f32_16x16x32_bf16 v[192:195], v[244:247], a[104:107], v[192:195]
    s_waitcnt lgkmcnt(3)
    s_add_u32 m0, s75, 49152
    v_mfma_f32_16x16x32_bf16 v[192:195], v[248:251], a[112:115], v[192:195]
    ds_read_b128 v[236:239], v16 offset:48128
    v_mfma_f32_16x16x32_bf16 v[192:195], v[252:255], a[120:123], v[192:195]
    v_mfma_f32_16x16x32_bf16 v[196:199], v[252:255], a[124:127], v[196:199]
    s_waitcnt vmcnt(15)
    s_barrier
    buffer_load_dwordx4 v27, s[16:19], s80 offen sc1 lds
    s_add_u32 s80, s80, 229376
    s_cmp_eq_u32 s80, 1835008
    s_cselect_b32 s80, 0, s80
    s_add_u32 m0, s75, 57344
    s_nop 0
    buffer_load_dwordx4 v27, s[16:19], s80 offen sc1 lds
    s_add_u32 s80, s80, 229376
    s_cmp_eq_u32 s80, 1835008
    s_cselect_b32 s80, 0, s80
    s_add_u32 m0, s75, 65536
    s_nop 0
    buffer_load_dwordx4 v29, s[16:19], s80 offen sc1 lds
    ds_read_b128 v[252:255], v16 offset:49152
    v_mfma_f32_16x16x32_bf16 v[196:199], v[248:251], a[116:119], v[196:199]
    s_add_u32 s80, s80, 229376
    s_cmp_eq_u32 s80, 1835008
    s_cselect_b32 s80, 0, s80
    s_add_u32 m0, s75, 73728
    v_mfma_f32_16x16x32_bf16 v[196:199], v[244:247], a[108:111], v[196:199]
    ds_read_b128 v[248:251], v16 offset:52224
    v_mfma_f32_16x16x32_bf16 v[196:199], v[240:243], a[100:103], v[196:199]
    s_waitcnt lgkmcnt(4)
    v_mfma_f32_16x16x32_bf16 v[208:211], v[224:227], a[96:99], v[208:211]
    ds_read_b128 v[244:247], v16 offset:55296
    buffer_load_dwordx4 v29, s[16:19], s80 offen sc1 lds
    v_mfma_f32_16x16x32_bf16 v[208:211], v[228:231], a[104:107], v[208:211]
    s_waitcnt lgkmcnt(3)
    v_mfma_f32_16x16x32_bf16 v[208:211], v[232:235], a[112:115], v[208:211]
    ds_read_b128 v[240:243], v16 offset:58368
    v_mfma_f32_16x16x32_bf16 v[208:211], v[236:239], a[120:123], v[208:211]
    v_mfma_f32_16x16x32_bf16 v[212:215], v[236:239], a[124:127], v[212:215]
    ds_read_b128 v[236:239], v16 offset:51200
    buffer_load_dwordx4 v[128:131], v23, s[16:19], s88 offen offset:0 sc1
    v_mfma_f32_16x16x32_bf16 v[212:215], v[232:235], a[116:119], v[212:215]
    v_mfma_f32_16x16x32_bf16 v[212:215], v[228:231], a[108:111], v[212:215]
    ds_read_b128 v[232:235], v16 offset:54272
    v_mfma_f32_16x16x32_bf16 v[212:215], v[224:227], a[100:103], v[212:215]
    s_waitcnt lgkmcnt(4)
    v_mfma_f32_16x16x32_bf16 v[192:195], v[252:255], a[128:131], v[192:195]
    ds_read_b128 v[228:231], v16 offset:57344
    buffer_load_dwordx4 v[132:135], v23, s[16:19], s88 offen offset:1024 sc1
    v_mfma_f32_16x16x32_bf16 v[192:195], v[248:251], a[136:139], v[192:195]
    s_waitcnt lgkmcnt(3)
    v_mfma_f32_16x16x32_bf16 v[192:195], v[244:247], a[144:147], v[192:195]
    ds_read_b128 v[224:227], v16 offset:60416
    v_mfma_f32_16x16x32_bf16 v[192:195], v[240:243], a[152:155], v[192:195]
    v_mfma_f32_16x16x32_bf16 v[196:199], v[240:243], a[156:159], v[196:199]
    ds_read_b128 v[240:243], v16 offset:61440
    buffer_load_dwordx4 v32, s[16:19], s80 offen offset:1024 sc1 lds
    s_add_u32 s80, s80, 229376
    s_cmp_eq_u32 s80, 1835008
    s_cselect_b32 s80, 0, s80
    v_mfma_f32_16x16x32_bf16 v[196:199], v[244:247], a[148:151], v[196:199]
    s_add_u32 m0, s75, 81920
    v_mfma_f32_16x16x32_bf16 v[196:199], v[248:251], a[140:143], v[196:199]
    ds_read_b128 v[244:247], v16 offset:64512
    v_mfma_f32_16x16x32_bf16 v[196:199], v[252:255], a[132:135], v[196:199]
    s_waitcnt lgkmcnt(4)
    v_mfma_f32_16x16x32_bf16 v[208:211], v[236:239], a[128:131], v[208:211]
    ds_read_b128 v[248:251], v33 offset:2048
    v_mfma_f32_16x16x32_bf16 v[208:211], v[232:235], a[136:139], v[208:211]
    s_waitcnt lgkmcnt(3)
    v_mfma_f32_16x16x32_bf16 v[208:211], v[228:231], a[144:147], v[208:211]
    ds_read_b128 v[252:255], v33 offset:5120
    buffer_load_dwordx4 v29, s[16:19], s80 offen sc1 lds
    v_mfma_f32_16x16x32_bf16 v[208:211], v[224:227], a[152:155], v[208:211]
    v_mfma_f32_16x16x32_bf16 v[212:215], v[224:227], a[156:159], v[212:215]
    ds_read_b128 v[224:227], v16 offset:62464
    v_mfma_f32_16x16x32_bf16 v[212:215], v[228:231], a[148:151], v[212:215]
    v_mfma_f32_16x16x32_bf16 v[212:215], v[232:235], a[140:143], v[212:215]
    ds_read_b128 v[228:231], v33 offset:0
    v_mfma_f32_16x16x32_bf16 v[212:215], v[236:239], a[132:135], v[212:215]
    s_waitcnt lgkmcnt(4)
    buffer_load_dwordx4 v32, s[16:19], s80 offen offset:1024 sc1 lds
    s_add_u32 s80, s80, 229376
    s_cmp_eq_u32 s80, 1835008
    s_cselect_b32 s80, 0, s80
    v_mfma_f32_16x16x32_bf16 v[192:195], v[240:243], a[160:163], v[192:195]
    s_add_u32 m0, s75, 90112
    ds_read_b128 v[232:235], v33 offset:3072
    v_mfma_f32_16x16x32_bf16 v[192:195], v[244:247], a[168:171], v[192:195]
    s_waitcnt lgkmcnt(3)
    v_mfma_f32_16x16x32_bf16 v[192:195], v[248:251], a[176:179], v[192:195]
    ds_read_b128 v[236:239], v33 offset:6144
    v_mfma_f32_16x16x32_bf16 v[192:195], v[252:255], a[184:187], v[192:195]
    buffer_load_dwordx4 v29, s[16:19], s80 offen sc1 lds
    v_mfma_f32_16x16x32_bf16 v[196:199], v[252:255], a[188:191], v[196:199]
    ds_read_b128 v[252:255], v33 offset:8192
    v_mfma_f32_16x16x32_bf16 v[196:199], v[248:251], a[180:183], v[196:199]
    v_mfma_f32_16x16x32_bf16 v[196:199], v[244:247], a[172:175], v[196:199]
    ds_read_b128 v[248:251], v33 offset:11264
    v_mfma_f32_16x16x32_bf16 v[196:199], v[240:243], a[164:167], v[196:199]
    s_waitcnt lgkmcnt(4)
    buffer_load_dwordx4 v32, s[16:19], s80 offen offset:1024 sc1 lds
    v_mfma_f32_16x16x32_bf16 v[200:203], v[224:227], a[160:163], v[200:203]
    ds_read_b128 v[244:247], v33 offset:14336
    v_mfma_f32_16x16x32_bf16 v[200:203], v[228:231], a[168:171], v[200:203]
    s_waitcnt lgkmcnt(3)
    v_mfma_f32_16x16x32_bf16 v[200:203], v[232:235], a[176:179], v[200:203]
    ds_read_b128 v[240:243], v33 offset:17408
    v_mfma_f32_16x16x32_bf16 v[200:203], v[236:239], a[184:187], v[200:203]
    v_mfma_f32_16x16x32_bf16 v[204:207], v[236:239], a[188:191], v[204:207]
    ds_read_b128 v[236:239], v33 offset:9216
    v_mfma_f32_16x16x32_bf16 v[204:207], v[232:235], a[180:183], v[204:207]
    v_mfma_f32_16x16x32_bf16 v[204:207], v[228:231], a[172:175], v[204:207]
    ds_read_b128 v[232:235], v33 offset:12288
    v_mfma_f32_16x16x32_bf16 v[204:207], v[224:227], a[164:167], v[204:207]
    s_waitcnt lgkmcnt(4)
    v_mfma_f32_16x16x32_bf16 v[192:195], v[252:255], a[192:195], v[192:195]
    ds_read_b128 v[228:231], v33 offset:15360
    v_mfma_f32_16x16x32_bf16 v[192:195], v[248:251], a[200:203], v[192:195]
    s_waitcnt lgkmcnt(3)
    v_mfma_f32_16x16x32_bf16 v[192:195], v[244:247], a[208:211], v[192:195]
    ds_read_b128 v[224:227], v33 offset:18432
    v_mfma_f32_16x16x32_bf16 v[192:195], v[240:243], a[216:219], v[192:195]
    v_mfma_f32_16x16x32_bf16 v[196:199], v[240:243], a[220:223], v[196:199]
    s_waitcnt vmcnt(21)
    s_barrier
    s_add_u32 s80, s80, 229376
    s_cmp_eq_u32 s80, 1835008
    s_cselect_b32 s80, 0, s80
    s_add_u32 m0, s75, 98304
    s_nop 0
    buffer_load_dwordx4 v32, s[16:19], s80 offen offset:1024 sc1 lds
    ds_read_b128 v[240:243], v33 offset:20480
    v_mfma_f32_16x16x32_bf16 v[196:199], v[244:247], a[212:215], v[196:199]
    s_add_u32 s80, s80, 229376
    s_cmp_eq_u32 s80, 1835008
    s_cselect_b32 s80, 0, s80
    s_add_u32 m0, s75, 106496
    v_mfma_f32_16x16x32_bf16 v[196:199], v[248:251], a[204:207], v[196:199]
    ds_read_b128 v[244:247], v33 offset:23552
    v_mfma_f32_16x16x32_bf16 v[196:199], v[252:255], a[196:199], v[196:199]
    s_waitcnt lgkmcnt(4)
    v_mfma_f32_16x16x32_bf16 v[200:203], v[236:239], a[192:195], v[200:203]
    ds_read_b128 v[248:251], v33 offset:26624
    v_mfma_f32_16x16x32_bf16 v[200:203], v[232:235], a[200:203], v[200:203]
    s_waitcnt lgkmcnt(3)
    v_mfma_f32_16x16x32_bf16 v[200:203], v[228:231], a[208:211], v[200:203]
    ds_read_b128 v[252:255], v33 offset:29696
    v_mfma_f32_16x16x32_bf16 v[200:203], v[224:227], a[216:219], v[200:203]
    v_mfma_f32_16x16x32_bf16 v[204:207], v[224:227], a[220:223], v[204:207]
    ds_read_b128 v[224:227], v33 offset:21504
    v_mfma_f32_16x16x32_bf16 v[204:207], v[228:231], a[212:215], v[204:207]
    v_mfma_f32_16x16x32_bf16 v[204:207], v[232:235], a[204:207], v[204:207]
    ds_read_b128 v[228:231], v33 offset:24576
    buffer_load_dwordx4 v32, s[16:19], s80 offen offset:1024 sc1 lds
    s_add_u32 s80, s80, 229376
    s_cmp_eq_u32 s80, 1835008
    s_cselect_b32 s80, 0, s80
    v_mfma_f32_16x16x32_bf16 v[204:207], v[236:239], a[196:199], v[204:207]
    s_waitcnt lgkmcnt(4)
    s_add_u32 m0, s75, 114688
    v_mfma_f32_16x16x32_bf16 v[192:195], v[240:243], a[224:227], v[192:195]
    ds_read_b128 v[232:235], v33 offset:27648
    v_mfma_f32_16x16x32_bf16 v[192:195], v[244:247], a[232:235], v[192:195]
    s_waitcnt lgkmcnt(3)
    v_mfma_f32_16x16x32_bf16 v[192:195], v[248:251], a[240:243], v[192:195]
    ds_read_b128 v[236:239], v33 offset:30720
    buffer_load_dwordx4 v29, s[16:19], s80 offen sc1 lds
    v_mfma_f32_16x16x32_bf16 v[192:195], v[252:255], a[248:251], v[192:195]
    v_mfma_f32_16x16x32_bf16 v[196:199], v[252:255], a[252:255], v[196:199]
    ds_read_b128 v[252:255], v33 offset:22528
    v_mfma_f32_16x16x32_bf16 v[196:199], v[248:251], a[244:247], v[196:199]
    v_mfma_f32_16x16x32_bf16 v[196:199], v[244:247], a[236:239], v[196:199]
    ds_read_b128 v[248:251], v33 offset:25600
    buffer_load_dwordx4 v32, s[16:19], s80 offen offset:1024 sc1 lds
    s_add_u32 s80, s80, 229376
    s_cmp_eq_u32 s80, 1835008
    s_cselect_b32 s80, 0, s80
    v_mfma_f32_16x16x32_bf16 v[196:199], v[240:243], a[228:231], v[196:199]
    s_waitcnt lgkmcnt(4)
    s_add_u32 m0, s75, 122880
    v_mfma_f32_16x16x32_bf16 v[200:203], v[224:227], a[224:227], v[200:203]
    ds_read_b128 v[244:247], v33 offset:28672
    v_mfma_f32_16x16x32_bf16 v[200:203], v[228:231], a[232:235], v[200:203]
    s_waitcnt lgkmcnt(3)
    v_mfma_f32_16x16x32_bf16 v[200:203], v[232:235], a[240:243], v[200:203]
    ds_read_b128 v[240:243], v33 offset:31744
    buffer_load_dwordx4 v29, s[16:19], s80 offen sc1 lds
    s_mul_i32 s93, s63, 12544
    s_mul_i32 s94, s36, 3136
    s_add_u32 s93, s93, s94
    v_mfma_f32_16x16x32_bf16 v[200:203], v[236:239], a[248:251], v[200:203]
    s_lshl_b32 s94, s93, 1
    s_waitcnt vmcnt(11)
    v_perm_b32 v136, v129, v128, s89
    v_mfma_f32_16x16x32_bf16 v[204:207], v[236:239], a[252:255], v[204:207]
    s_barrier
    ds_read_b128 v[236:239], v4 offset:0
    buffer_load_dwordx4 v[104:107], v4, s[24:27], s94 offen offset:0
    v_mfma_f32_16x16x32_bf16 v[204:207], v[232:235], a[244:247], v[204:207]
    v_perm_b32 v137, v131, v130, s89
    v_lshl_or_b32 v136, v137, 16, v136
    v_mfma_f32_16x16x32_bf16 v[204:207], v[228:231], a[236:239], v[204:207]
    ds_read_b128 v[232:235], v4 offset:2048
    s_waitcnt vmcnt(11)
    v_perm_b32 v138, v133, v132, s89
    v_mfma_f32_16x16x32_bf16 v[204:207], v[224:227], a[228:231], v[204:207]
    s_waitcnt lgkmcnt(4)
    v_perm_b32 v139, v135, v134, s89
    v_lshl_or_b32 v138, v139, 16, v138
    v_mfma_f32_16x16x32_bf16 v[208:211], v[252:255], a[224:227], v[208:211]
    ds_read_b128 v[228:231], v4 offset:4096
    buffer_load_dwordx4 v[108:111], v4, s[24:27], s94 offen offset:1056
    v_mfma_f32_16x16x32_bf16 v[208:211], v[248:251], a[232:235], v[208:211]
    s_waitcnt lgkmcnt(3)
    v_min3_u32 v140, v136, v138, v138
    v_max3_u32 v141, v136, v138, v138
    v_mfma_f32_16x16x32_bf16 v[208:211], v[244:247], a[240:243], v[208:211]
    ds_read_b128 v[224:227], v4 offset:6144
    v_xor_b32 v140, s52, v140
    v_mfma_f32_16x16x32_bf16 v[208:211], v[240:243], a[248:251], v[208:211]
    v_xor_b32 v141, s52, v141
    v_or_b32 v140, v140, v141
    v_mfma_f32_16x16x32_bf16 v[212:215], v[240:243], a[252:255], v[212:215]
    ds_read_b128 v[240:243], v4 offset:1024
    buffer_load_dwordx4 v[104:107], v4, s[24:27], s94 offen offset:2112
    s_add_u32 s94, s94, 3136
    v_mfma_f32_16x16x32_bf16 v[212:215], v[244:247], a[244:247], v[212:215]
    v_cmp_ne_u32 s[54:55], 0, v140
    s_nop 0
    s_cmp_eq_u64 s[54:55], 0
    s_cbranch_scc0 Lslow_33
Lback_34:
    s_nop 0
    v_mfma_f32_16x16x32_bf16 v[212:215], v[248:251], a[236:239], v[212:215]
    s_mov_b32 s89, 0xffffff00
    ds_read_b128 v[244:247], v4 offset:3072
    v_and_b32 v128, s89, v128
    v_mfma_f32_16x16x32_bf16 v[212:215], v[252:255], a[228:231], v[212:215]
    s_waitcnt lgkmcnt(4)
    v_cvt_pk_bf16_f32 v80, v192, v193
    v_cvt_pk_bf16_f32 v81, v194, v195
    v_mfma_f32_16x16x32_bf16 v[144:147], v[236:239], a[0:3], 0
    ds_read_b128 v[248:251], v4 offset:5120
    buffer_load_dwordx4 v[108:111], v4, s[24:27], s94 offen offset:0
    v_mfma_f32_16x16x32_bf16 v[144:147], v[232:235], a[8:11], v[144:147]
    s_waitcnt lgkmcnt(3)
    v_cvt_pk_bf16_f32 v84, v196, v197
    v_cvt_pk_bf16_f32 v85, v198, v199
    v_mfma_f32_16x16x32_bf16 v[144:147], v[228:231], a[16:19], v[144:147]
    ds_read_b128 v[252:255], v4 offset:7168
    v_cvt_pk_bf16_f32 v88, v200, v201
    v_mfma_f32_16x16x32_bf16 v[144:147], v[224:227], a[24:27], v[144:147]
    v_cvt_pk_bf16_f32 v89, v202, v203
    v_cvt_pk_bf16_f32 v92, v204, v205
    v_mfma_f32_16x16x32_bf16 v[148:151], v[236:239], a[4:7], 0
    ds_read_b128 v[236:239], v4 offset:8192
    buffer_load_dwordx4 v[104:107], v4, s[24:27], s94 offen offset:1056
    v_mfma_f32_16x16x32_bf16 v[148:151], v[232:235], a[12:15], v[148:151]
    v_cvt_pk_bf16_f32 v93, v206, v207
    v_cvt_pk_bf16_f32 v96, v208, v209
    v_mfma_f32_16x16x32_bf16 v[148:151], v[228:231], a[20:23], v[148:151]
    ds_read_b128 v[232:235], v4 offset:10240
    v_cvt_pk_bf16_f32 v97, v210, v211
    v_mfma_f32_16x16x32_bf16 v[148:151], v[224:227], a[28:31], v[148:151]
    s_waitcnt lgkmcnt(4)
    v_cvt_pk_bf16_f32 v100, v212, v213
    v_cvt_pk_bf16_f32 v101, v214, v215
    v_mfma_f32_16x16x32_bf16 v[160:163], v[240:243], a[0:3], 0
    s_add_u32 s60, s84, 0
    ds_read_b128 v[228:231], v4 offset:12288
    buffer_store_dwordx4 v[80:83], v4, s[16:19], s60 offen offset:0 sc1
    v_mfma_f32_16x16x32_bf16 v[160:163], v[244:247], a[8:11], v[160:163]
    s_waitcnt lgkmcnt(3)
    v_and_b32 v129, s89, v129
    v_and_b32 v130, s89, v130
    v_mfma_f32_16x16x32_bf16 v[160:163], v[248:251], a[16:19], v[160:163]
    ds_read_b128 v[224:227], v4 offset:14336
    buffer_store_dwordx4 v[84:87], v4, s[16:19], s60 offen offset:1024 sc1
    s_add_u32 s60, s84, 57344
    v_mfma_f32_16x16x32_bf16 v[160:163], v[252:255], a[24:27], v[160:163]
    v_and_b32 v131, s89, v131
    v_and_b32 v132, s89, v132
    v_mfma_f32_16x16x32_bf16 v[164:167], v[240:243], a[4:7], 0
    ds_read_b128 v[240:243], v4 offset:9216
    buffer_store_dwordx4 v[88:91], v4, s[16:19], s60 offen offset:0 sc1
    v_mfma_f32_16x16x32_bf16 v[164:167], v[244:247], a[12:15], v[164:167]
    v_and_b32 v133, s89, v133
    v_and_b32 v134, s89, v134
    v_mfma_f32_16x16x32_bf16 v[164:167], v[248:251], a[20:23], v[164:167]
    ds_read_b128 v[244:247], v4 offset:11264
    buffer_store_dwordx4 v[92:95], v4, s[16:19], s60 offen offset:1024 sc1
    s_add_u32 s60, s84, 114688
    v_mfma_f32_16x16x32_bf16 v[164:167], v[252:255], a[28:31], v[164:167]
    s_waitcnt lgkmcnt(4)
    v_and_b32 v135, s89, v135
    v_permlane32_swap_b32 v128, v132
    v_mfma_f32_16x16x32_bf16 v[144:147], v[236:239], a[32:35], v[144:147]
    ds_read_b128 v[248:251], v4 offset:13312
    buffer_store_dwordx4 v[96:99], v4, s[16:19], s60 offen offset:0 sc1
    v_mfma_f32_16x16x32_bf16 v[144:147], v[232:235], a[40:43], v[144:147]
    s_waitcnt lgkmcnt(3)
    v_permlane32_swap_b32 v129, v133
    v_permlane32_swap_b32 v130, v134
    v_mfma_f32_16x16x32_bf16 v[144:147], v[228:231], a[48:51], v[144:147]
    ds_read_b128 v[252:255], v4 offset:15360
    buffer_store_dwordx4 v[100:103], v4, s[16:19], s60 offen offset:1024 sc1
    v_mfma_f32_16x16x32_bf16 v[144:147], v[224:227], a[56:59], v[144:147]
    v_permlane32_swap_b32 v131, v135
    v_add_f32 v128, v128, v132
    v_mfma_f32_16x16x32_bf16 v[148:151], v[224:227], a[60:63], v[148:151]
    s_barrier
    ds_read_b128 v[224:227], v4 offset:17408
    buffer_load_dwordx4 v[108:111], v4, s[24:27], s94 offen offset:2112
    v_mfma_f32_16x16x32_bf16 v[148:151], v[228:231], a[52:55], v[148:151]
    v_add_f32 v129, v129, v133
    v_add_f32 v130, v130, v134
    v_mfma_f32_16x16x32_bf16 v[148:151], v[232:235], a[44:47], v[148:151]
    ds_read_b128 v[228:231], v4 offset:19456
    v_add_f32 v131, v131, v135
    v_mfma_f32_16x16x32_bf16 v[148:151], v[236:239], a[36:39], v[148:151]
    s_waitcnt lgkmcnt(4)
    v_permlane16_swap_b32 v128, v130
    v_permlane16_swap_b32 v129, v131
    v_mfma_f32_16x16x32_bf16 v[160:163], v[240:243], a[32:35], v[160:163]
    ds_read_b128 v[232:235], v4 offset:21504
    v_add_f32 v128, v128, v130
    v_mfma_f32_16x16x32_bf16 v[160:163], v[244:247], a[40:43], v[160:163]
    s_waitcnt lgkmcnt(3)
    v_add_f32 v129, v129, v131
    v_add_f32_dpp v128, v128, v128 row_ror:8 row_mask:0xf bank_mask:0xf
    v_mfma_f32_16x16x32_bf16 v[160:163], v[248:251], a[48:51], v[160:163]
    ds_read_b128 v[236:239], v4 offset:23552
    buffer_load_dwordx4 v[104:107], v4, s[20:23], s93 offen offset:0
    v_mfma_f32_16x16x32_bf16 v[160:163], v[252:255], a[56:59], v[160:163]
    v_add_f32_dpp v129, v129, v129 row_ror:8 row_mask:0xf bank_mask:0xf
    v_add_f32_dpp v128, v128, v128 row_ror:4 row_mask:0xf bank_mask:0xf
    v_mfma_f32_16x16x32_bf16 v[164:167], v[252:255], a[60:63], v[164:167]
    ds_read_b128 v[252:255], v4 offset:25600
    v_add_f32_dpp v129, v129, v129 row_ror:4 row_mask:0xf bank_mask:0xf
    v_mfma_f32_16x16x32_bf16 v[164:167], v[248:251], a[52:55], v[164:167]
    v_cvt_pk_bf16_f32 v128, v128, v129
    v_mov_b32 v129, s52
    v_mfma_f32_16x16x32_bf16 v[164:167], v[244:247], a[44:47], v[164:167]
    ds_read_b128 v[248:251], v4 offset:27648
    buffer_load_dwordx4 v[108:111], v4, s[20:23], s93 offen offset:1056
    v_mfma_f32_16x16x32_bf16 v[164:167], v[240:243], a[36:39], v[164:167]
    s_waitcnt lgkmcnt(4)
    v_mov_b32 v131, s52
    v_permlane16_swap_b32 v128, v130
    v_mfma_f32_16x16x32_bf16 v[160:163], v[224:227], a[64:67], v[160:163]
    ds_read_b128 v[244:247], v4 offset:29696
    v_mfma_f32_16x16x32_bf16 v[160:163], v[228:231], a[72:75], v[160:163]
    s_waitcnt lgkmcnt(3)
    v_mfma_f32_16x16x32_bf16 v[160:163], v[232:235], a[80:83], v[160:163]
    ds_read_b128 v[240:243], v4 offset:31744
    v_mfma_f32_16x16x32_bf16 v[160:163], v[236:239], a[88:91], v[160:163]
    v_mfma_f32_16x16x32_bf16 v[164:167], v[236:239], a[92:95], v[164:167]
    ds_read_b128 v[236:239], v4 offset:32768
    v_mfma_f32_16x16x32_bf16 v[164:167], v[232:235], a[84:87], v[164:167]
    v_mfma_f32_16x16x32_bf16 v[164:167], v[228:231], a[76:79], v[164:167]
    ds_read_b128 v[232:235], v4 offset:34816
    v_mfma_f32_16x16x32_bf16 v[164:167], v[224:227], a[68:71], v[164:167]
    s_waitcnt lgkmcnt(4)
    v_mfma_f32_16x16x32_bf16 v[160:163], v[252:255], a[96:99], v[160:163]
    ds_read_b128 v[228:231], v4 offset:36864
    v_mfma_f32_16x16x32_bf16 v[160:163], v[248:251], a[104:107], v[160:163]
    s_waitcnt lgkmcnt(3)
    v_mfma_f32_16x16x32_bf16 v[160:163], v[244:247], a[112:115], v[160:163]
    ds_read_b128 v[224:227], v4 offset:38912
    v_mfma_f32_16x16x32_bf16 v[160:163], v[240:243], a[120:123], v[160:163]
    v_mfma_f32_16x16x32_bf16 v[164:167], v[240:243], a[124:127], v[164:167]
    ds_read_b128 v[240:243], v4 offset:33792
    v_mfma_f32_16x16x32_bf16 v[164:167], v[244:247], a[116:119], v[164:167]
    v_mfma_f32_16x16x32_bf16 v[164:167], v[248:251], a[108:111], v[164:167]
    ds_read_b128 v[244:247], v4 offset:35840
    v_mfma_f32_16x16x32_bf16 v[164:167], v[252:255], a[100:103], v[164:167]
    s_waitcnt lgkmcnt(4)
    v_mfma_f32_16x16x32_bf16 v[144:147], v[236:239], a[128:131], v[144:147]
    ds_read_b128 v[248:251], v4 offset:37888
    v_mfma_f32_16x16x32_bf16 v[144:147], v[232:235], a[136:139], v[144:147]
    s_waitcnt lgkmcnt(3)
    v_mfma_f32_16x16x32_bf16 v[144:147], v[228:231], a[144:147], v[144:147]
    ds_read_b128 v[252:255], v4 offset:39936
    v_mfma_f32_16x16x32_bf16 v[144:147], v[224:227], a[152:155], v[144:147]
    v_mfma_f32_16x16x32_bf16 v[148:151], v[224:227], a[156:159], v[148:151]
    ds_read_b128 v[224:227], v4 offset:40960
    s_mov_b32 exec_lo, 15
    s_mov_b32 exec_hi, 15
    buffer_store_dwordx4 v[128:131], v58, s[16:19], s82 offen sc1
    s_mov_b64 exec, -1
    s_lshl_b32 s88, s36, 10
    s_add_u32 s88, s88, 131072
    v_mfma_f32_16x16x32_bf16 v[148:151], v[228:231], a[148:151], v[148:151]
    v_add_u32 v23, s88, v4
    v_add_u32 v35, 131072, v4
    v_mfma_f32_16x16x32_bf16 v[148:151], v[232:235], a[140:143], v[148:151]
    ds_read_b128 v[228:231], v4 offset:43008
    v_mfma_f32_16x16x32_bf16 v[148:151], v[236:239], a[132:135], v[148:151]
    s_waitcnt lgkmcnt(4)
    v_mfma_f32_16x16x32_bf16 v[160:163], v[240:243], a[128:131], v[160:163]
    ds_read_b128 v[232:235], v4 offset:45056
    buffer_load_dwordx4 v[104:107], v4, s[20:23], s93 offen offset:2112
    v_mfma_f32_16x16x32_bf16 v[160:163], v[244:247], a[136:139], v[160:163]
    s_waitcnt lgkmcnt(3)
    v_mfma_f32_16x16x32_bf16 v[160:163], v[248:251], a[144:147], v[160:163]
    ds_read_b128 v[236:239], v4 offset:47104
    v_mfma_f32_16x16x32_bf16 v[160:163], v[252:255], a[152:155], v[160:163]
    v_mfma_f32_16x16x32_bf16 v[164:167], v[252:255], a[156:159], v[164:167]
    ds_read_b128 v[252:255], v4 offset:41984
    v_mfma_f32_16x16x32_bf16 v[164:167], v[248:251], a[148:151], v[164:167]
    v_mfma_f32_16x16x32_bf16 v[164:167], v[244:247], a[140:143], v[164:167]
    ds_read_b128 v[248:251], v4 offset:44032
    v_mfma_f32_16x16x32_bf16 v[164:167], v[240:243], a[132:135], v[164:167]
    s_waitcnt lgkmcnt(4)
    v_mfma_f32_16x16x32_bf16 v[144:147], v[224:227], a[160:163], v[144:147]
    ds_read_b128 v[244:247], v4 offset:46080
    v_mfma_f32_16x16x32_bf16 v[144:147], v[228:231], a[168:171], v[144:147]
    s_waitcnt lgkmcnt(3)
    v_mfma_f32_16x16x32_bf16 v[144:147], v[232:235], a[176:179], v[144:147]
    ds_read_b128 v[240:243], v4 offset:48128
    v_mfma_f32_16x16x32_bf16 v[144:147], v[236:239], a[184:187], v[144:147]
    v_mfma_f32_16x16x32_bf16 v[148:151], v[236:239], a[188:191], v[148:151]
    s_waitcnt vmcnt(25)
    s_barrier
    ds_read_b128 v[236:239], v4 offset:49152
    v_mfma_f32_16x16x32_bf16 v[148:151], v[232:235], a[180:183], v[148:151]
    v_mfma_f32_16x16x32_bf16 v[148:151], v[228:231], a[172:175], v[148:151]
    ds_read_b128 v[232:235], v4 offset:51200
    v_mfma_f32_16x16x32_bf16 v[148:151], v[224:227], a[164:167], v[148:151]
    s_waitcnt lgkmcnt(4)
    v_mfma_f32_16x16x32_bf16 v[160:163], v[252:255], a[160:163], v[160:163]
    ds_read_b128 v[228:231], v4 offset:53248
    v_mfma_f32_16x16x32_bf16 v[160:163], v[248:251], a[168:171], v[160:163]
    s_waitcnt lgkmcnt(3)
    v_mfma_f32_16x16x32_bf16 v[160:163], v[244:247], a[176:179], v[160:163]
    ds_read_b128 v[224:227], v4 offset:55296
    v_mfma_f32_16x16x32_bf16 v[160:163], v[240:243], a[184:187], v[160:163]
    v_mfma_f32_16x16x32_bf16 v[164:167], v[240:243], a[188:191], v[164:167]
    ds_read_b128 v[240:243], v4 offset:57344
    v_mfma_f32_16x16x32_bf16 v[164:167], v[244:247], a[180:183], v[164:167]
    v_mfma_f32_16x16x32_bf16 v[164:167], v[248:251], a[172:175], v[164:167]
    ds_read_b128 v[244:247], v4 offset:59392
    v_mfma_f32_16x16x32_bf16 v[164:167], v[252:255], a[164:167], v[164:167]
    s_waitcnt lgkmcnt(4)
    v_mfma_f32_16x16x32_bf16 v[144:147], v[236:239], a[192:195], v[144:147]
    ds_read_b128 v[248:251], v4 offset:61440
    v_mfma_f32_16x16x32_bf16 v[144:147], v[232:235], a[200:203], v[144:147]
    s_waitcnt lgkmcnt(3)
    v_mfma_f32_16x16x32_bf16 v[144:147], v[228:231], a[208:211], v[144:147]
    ds_read_b128 v[252:255], v4 offset:63488
    v_mfma_f32_16x16x32_bf16 v[144:147], v[224:227], a[216:219], v[144:147]
    v_mfma_f32_16x16x32_bf16 v[148:151], v[224:227], a[220:223], v[148:151]
    ds_read_b128 v[224:227], v16 offset:0
    v_mfma_f32_16x16x32_bf16 v[148:151], v[228:231], a[212:215], v[148:151]
    v_mfma_f32_16x16x32_bf16 v[148:151], v[232:235], a[204:207], v[148:151]
    ds_read_b128 v[228:231], v16 offset:2048
    v_mfma_f32_16x16x32_bf16 v[148:151], v[236:239], a[196:199], v[148:151]
    s_waitcnt lgkmcnt(4)
    v_mfma_f32_16x16x32_bf16 v[144:147], v[240:243], a[224:227], v[144:147]
    ds_read_b128 v[232:235], v16 offset:4096
    v_mfma_f32_16x16x32_bf16 v[144:147], v[244:247], a[232:235], v[144:147]
    s_waitcnt lgkmcnt(3)
    v_mfma_f32_16x16x32_bf16 v[144:147], v[248:251], a[240:243], v[144:147]
    ds_read_b128 v[236:239], v16 offset:6144
    v_mfma_f32_16x16x32_bf16 v[144:147], v[252:255], a[248:251], v[144:147]
    v_mfma_f32_16x16x32_bf16 v[148:151], v[252:255], a[252:255], v[148:151]
    ds_read_b128 v[252:255], v16 offset:8192
    v_mfma_f32_16x16x32_bf16 v[148:151], v[248:251], a[244:247], v[148:151]
    v_mfma_f32_16x16x32_bf16 v[148:151], v[244:247], a[236:239], v[148:151]
    ds_read_b128 v[248:251], v16 offset:10240
    v_mfma_f32_16x16x32_bf16 v[148:151], v[240:243], a[228:231], v[148:151]
    s_waitcnt lgkmcnt(4)
    v_mfma_f32_16x16x32_bf16 v[152:155], v[224:227], a[0:3], 0
    ds_read_b128 v[244:247], v16 offset:12288
    v_cvt_pk_bf16_f32 v80, v144, v145
    v_mfma_f32_16x16x32_bf16 v[152:155], v[228:231], a[8:11], v[152:155]
    s_waitcnt lgkmcnt(3)
    v_cvt_pk_bf16_f32 v81, v146, v147
    v_mfma_f32_16x16x32_bf16 v[152:155], v[232:235], a[16:19], v[152:155]
    ds_read_b128 v[240:243], v16 offset:14336
    v_cvt_pk_bf16_f32 v84, v148, v149
    v_mfma_f32_16x16x32_bf16 v[152:155], v[236:239], a[24:27], v[152:155]
    v_cvt_pk_bf16_f32 v85, v150, v151
    v_cvt_pk_bf16_f32 v88, v160, v161
    v_mfma_f32_16x16x32_bf16 v[156:159], v[224:227], a[4:7], 0
    ds_read_b128 v[224:227], v16 offset:9216
    v_cvt_pk_bf16_f32 v89, v162, v163
    v_mfma_f32_16x16x32_bf16 v[156:159], v[228:231], a[12:15], v[156:159]
    v_cvt_pk_bf16_f32 v92, v164, v165
    v_cvt_pk_bf16_f32 v93, v166, v167
    v_mfma_f32_16x16x32_bf16 v[156:159], v[232:235], a[20:23], v[156:159]
    s_add_u32 s60, s84, 28672
    ds_read_b128 v[228:231], v16 offset:11264
    buffer_store_dwordx4 v[80:83], v4, s[16:19], s60 offen offset:0 sc1
    v_mfma_f32_16x16x32_bf16 v[156:159], v[236:239], a[28:31], v[156:159]
    s_waitcnt lgkmcnt(4)
    v_mfma_f32_16x16x32_bf16 v[152:155], v[252:255], a[32:35], v[152:155]
    ds_read_b128 v[232:235], v16 offset:13312
    buffer_store_dwordx4 v[84:87], v4, s[16:19], s60 offen offset:1024 sc1
    s_add_u32 s60, s84, 143360
    v_mfma_f32_16x16x32_bf16 v[152:155], v[248:251], a[40:43], v[152:155]
    s_waitcnt lgkmcnt(3)
    v_mfma_f32_16x16x32_bf16 v[152:155], v[244:247], a[48:51], v[152:155]
    ds_read_b128 v[236:239], v16 offset:15360
    buffer_store_dwordx4 v[88:91], v4, s[16:19], s60 offen offset:0 sc1
    v_mfma_f32_16x16x32_bf16 v[152:155], v[240:243], a[56:59], v[152:155]
    v_mfma_f32_16x16x32_bf16 v[156:159], v[240:243], a[60:63], v[156:159]
    s_waitcnt vmcnt(19)
    s_barrier
    ds_read_b128 v[240:243], v16 offset:16384
    v_mfma_f32_16x16x32_bf16 v[156:159], v[244:247], a[52:55], v[156:159]
    buffer_store_dwordx4 v[92:95], v4, s[16:19], s60 offen offset:1024 sc1
    v_mfma_f32_16x16x32_bf16 v[156:159], v[248:251], a[44:47], v[156:159]
    ds_read_b128 v[244:247], v16 offset:18432
    buffer_load_dwordx4 v[132:135], v4, s[16:19], s83 offen offset:0 sc1
    v_mfma_f32_16x16x32_bf16 v[156:159], v[252:255], a[36:39], v[156:159]
    s_waitcnt lgkmcnt(4)
    v_mfma_f32_16x16x32_bf16 v[168:171], v[224:227], a[32:35], 0
    ds_read_b128 v[248:251], v16 offset:20480
    v_mfma_f32_16x16x32_bf16 v[168:171], v[228:231], a[40:43], v[168:171]
    s_waitcnt lgkmcnt(3)
    v_mfma_f32_16x16x32_bf16 v[168:171], v[232:235], a[48:51], v[168:171]
    ds_read_b128 v[252:255], v16 offset:22528
    buffer_load_dwordx4 v[136:139], v4, s[16:19], s83 offen offset:1024 sc1
    v_mfma_f32_16x16x32_bf16 v[168:171], v[236:239], a[56:59], v[168:171]
    v_mfma_f32_16x16x32_bf16 v[172:175], v[224:227], a[36:39], 0
    ds_read_b128 v[224:227], v16 offset:17408
    v_mfma_f32_16x16x32_bf16 v[172:175], v[228:231], a[44:47], v[172:175]
    v_mfma_f32_16x16x32_bf16 v[172:175], v[232:235], a[52:55], v[172:175]
    ds_read_b128 v[228:231], v16 offset:19456
    v_mfma_f32_16x16x32_bf16 v[172:175], v[236:239], a[60:63], v[172:175]
    s_waitcnt lgkmcnt(4)
    v_mfma_f32_16x16x32_bf16 v[152:155], v[240:243], a[64:67], v[152:155]
    ds_read_b128 v[232:235], v16 offset:21504
    v_mfma_f32_16x16x32_bf16 v[152:155], v[244:247], a[72:75], v[152:155]
    s_waitcnt lgkmcnt(3)
    v_mfma_f32_16x16x32_bf16 v[152:155], v[248:251], a[80:83], v[152:155]
    ds_read_b128 v[236:239], v16 offset:23552
    v_mfma_f32_16x16x32_bf16 v[152:155], v[252:255], a[88:91], v[152:155]
    v_mfma_f32_16x16x32_bf16 v[156:159], v[252:255], a[92:95], v[156:159]
    ds_read_b128 v[252:255], v16 offset:24576
    v_mfma_f32_16x16x32_bf16 v[156:159], v[248:251], a[84:87], v[156:159]
    v_mfma_f32_16x16x32_bf16 v[156:159], v[244:247], a[76:79], v[156:159]
    ds_read_b128 v[248:251], v16 offset:26624
    v_mfma_f32_16x16x32_bf16 v[156:159], v[240:243], a[68:71], v[156:159]
    s_waitcnt lgkmcnt(4)
    v_mfma_f32_16x16x32_bf16 v[168:171], v[224:227], a[64:67], v[168:171]
    ds_read_b128 v[244:247], v16 offset:28672
    v_mfma_f32_16x16x32_bf16 v[168:171], v[228:231], a[72:75], v[168:171]
    s_waitcnt lgkmcnt(3)
    v_mfma_f32_16x16x32_bf16 v[168:171], v[232:235], a[80:83], v[168:171]
    ds_read_b128 v[240:243], v16 offset:30720
    v_mfma_f32_16x16x32_bf16 v[168:171], v[236:239], a[88:91], v[168:171]
    v_mfma_f32_16x16x32_bf16 v[172:175], v[236:239], a[92:95], v[172:175]
    ds_read_b128 v[236:239], v16 offset:25600
    v_mfma_f32_16x16x32_bf16 v[172:175], v[232:235], a[84:87], v[172:175]
    v_mfma_f32_16x16x32_bf16 v[172:175], v[228:231], a[76:79], v[172:175]
    ds_read_b128 v[232:235], v16 offset:27648
    v_mfma_f32_16x16x32_bf16 v[172:175], v[224:227], a[68:71], v[172:175]
    s_waitcnt lgkmcnt(4)
    v_mfma_f32_16x16x32_bf16 v[152:155], v[252:255], a[96:99], v[152:155]
    ds_read_b128 v[228:231], v16 offset:29696
    v_mfma_f32_16x16x32_bf16 v[152:155], v[248:251], a[104:107], v[152:155]
    s_waitcnt lgkmcnt(3)
    v_mfma_f32_16x16x32_bf16 v[152:155], v[244:247], a[112:115], v[152:155]
    ds_read_b128 v[224:227], v16 offset:31744
    v_mfma_f32_16x16x32_bf16 v[152:155], v[240:243], a[120:123], v[152:155]
    v_mfma_f32_16x16x32_bf16 v[156:159], v[240:243], a[124:127], v[156:159]
    ds_read_b128 v[240:243], v16 offset:33792
    v_mfma_f32_16x16x32_bf16 v[156:159], v[244:247], a[116:119], v[156:159]
    v_mfma_f32_16x16x32_bf16 v[156:159], v[248:251], a[108:111], v[156:159]
    ds_read_b128 v[244:247], v16 offset:35840
    v_mfma_f32_16x16x32_bf16 v[156:159], v[252:255], a[100:103], v[156:159]
    s_waitcnt lgkmcnt(4)
    v_mfma_f32_16x16x32_bf16 v[168:171], v[236:239], a[96:99], v[168:171]
    ds_read_b128 v[248:251], v16 offset:37888
    v_mfma_f32_16x16x32_bf16 v[168:171], v[232:235], a[104:107], v[168:171]
    s_waitcnt lgkmcnt(3)
    v_mfma_f32_16x16x32_bf16 v[168:171], v[228:231], a[112:115], v[168:171]
    ds_read_b128 v[252:255], v16 offset:39936
    v_mfma_f32_16x16x32_bf16 v[168:171], v[224:227], a[120:123], v[168:171]
    v_mfma_f32_16x16x32_bf16 v[172:175], v[224:227], a[124:127], v[172:175]
    ds_read_b128 v[224:227], v16 offset:41984
    v_mfma_f32_16x16x32_bf16 v[172:175], v[228:231], a[116:119], v[172:175]
    v_mfma_f32_16x16x32_bf16 v[172:175], v[232:235], a[108:111], v[172:175]
    ds_read_b128 v[228:231], v16 offset:44032
    v_mfma_f32_16x16x32_bf16 v[172:175], v[236:239], a[100:103], v[172:175]
    s_waitcnt lgkmcnt(4)
    v_mfma_f32_16x16x32_bf16 v[168:171], v[240:243], a[128:131], v[168:171]
    ds_read_b128 v[232:235], v16 offset:46080
    v_mfma_f32_16x16x32_bf16 v[168:171], v[244:247], a[136:139], v[168:171]
    s_waitcnt lgkmcnt(3)
    v_mfma_f32_16x16x32_bf16 v[168:171], v[248:251], a[144:147], v[168:171]
    ds_read_b128 v[236:239], v16 offset:48128
    v_mfma_f32_16x16x32_bf16 v[168:171], v[252:255], a[152:155], v[168:171]
    v_mfma_f32_16x16x32_bf16 v[172:175], v[252:255], a[156:159], v[172:175]
    ds_read_b128 v[252:255], v16 offset:49152
    v_mfma_f32_16x16x32_bf16 v[172:175], v[248:251], a[148:151], v[172:175]
    v_mfma_f32_16x16x32_bf16 v[172:175], v[244:247], a[140:143], v[172:175]
    ds_read_b128 v[248:251], v16 offset:51200
    v_mfma_f32_16x16x32_bf16 v[172:175], v[240:243], a[132:135], v[172:175]
    s_waitcnt lgkmcnt(4)
    v_mfma_f32_16x16x32_bf16 v[168:171], v[224:227], a[160:163], v[168:171]
    ds_read_b128 v[244:247], v16 offset:53248
    v_mfma_f32_16x16x32_bf16 v[168:171], v[228:231], a[168:171], v[168:171]
    s_waitcnt lgkmcnt(3)
    v_mfma_f32_16x16x32_bf16 v[168:171], v[232:235], a[176:179], v[168:171]
    ds_read_b128 v[240:243], v16 offset:55296
    v_mfma_f32_16x16x32_bf16 v[168:171], v[236:239], a[184:187], v[168:171]
    v_mfma_f32_16x16x32_bf16 v[172:175], v[236:239], a[188:191], v[172:175]
    ds_read_b128 v[236:239], v16 offset:50176
    v_mfma_f32_16x16x32_bf16 v[172:175], v[232:235], a[180:183], v[172:175]
    v_mfma_f32_16x16x32_bf16 v[172:175], v[228:231], a[172:175], v[172:175]
    ds_read_b128 v[232:235], v16 offset:52224
    v_mfma_f32_16x16x32_bf16 v[172:175], v[224:227], a[164:167], v[172:175]
    s_waitcnt lgkmcnt(4)
    v_mfma_f32_16x16x32_bf16 v[152:155], v[252:255], a[192:195], v[152:155]
    ds_read_b128 v[228:231], v16 offset:54272
    v_mfma_f32_16x16x32_bf16 v[152:155], v[248:251], a[200:203], v[152:155]
    s_waitcnt lgkmcnt(3)
    v_mfma_f32_16x16x32_bf16 v[152:155], v[244:247], a[208:211], v[152:155]
    ds_read_b128 v[224:227], v16 offset:56320
    v_mfma_f32_16x16x32_bf16 v[152:155], v[240:243], a[216:219], v[152:155]
    v_mfma_f32_16x16x32_bf16 v[156:159], v[240:243], a[220:223], v[156:159]
    ds_read_b128 v[240:243], v16 offset:57344
    v_mfma_f32_16x16x32_bf16 v[156:159], v[244:247], a[212:215], v[156:159]
    v_mfma_f32_16x16x32_bf16 v[156:159], v[248:251], a[204:207], v[156:159]
    ds_read_b128 v[244:247], v16 offset:59392
    v_mfma_f32_16x16x32_bf16 v[156:159], v[252:255], a[196:199], v[156:159]
    s_waitcnt lgkmcnt(4)
    v_mfma_f32_16x16x32_bf16 v[168:171], v[236:239], a[192:195], v[168:171]
    ds_read_b128 v[248:251], v16 offset:61440
    v_mfma_f32_16x16x32_bf16 v[168:171], v[232:235], a[200:203], v[168:171]
    s_waitcnt lgkmcnt(3)
    v_mfma_f32_16x16x32_bf16 v[168:171], v[228:231], a[208:211], v[168:171]
    ds_read_b128 v[252:255], v16 offset:63488
    v_mfma_f32_16x16x32_bf16 v[168:171], v[224:227], a[216:219], v[168:171]
    v_mfma_f32_16x16x32_bf16 v[172:175], v[224:227], a[220:223], v[172:175]
    v_mfma_f32_16x16x32_bf16 v[172:175], v[228:231], a[212:215], v[172:175]
    v_mfma_f32_16x16x32_bf16 v[172:175], v[232:235], a[204:207], v[172:175]
    s_waitcnt vmcnt(0)
    v_min3_u32 v140, v133, v135, v137
    v_max3_u32 v141, v133, v135, v137
    v_mfma_f32_16x16x32_bf16 v[172:175], v[236:239], a[196:199], v[172:175]
    s_waitcnt lgkmcnt(2)
    v_min3_u32 v140, v140, v139, v139
    v_max3_u32 v141, v141, v139, v139
    v_mfma_f32_16x16x32_bf16 v[152:155], v[240:243], a[224:227], v[152:155]
    v_xor_b32 v140, s52, v140
    v_xor_b32 v141, s52, v141
    v_mfma_f32_16x16x32_bf16 v[152:155], v[244:247], a[232:235], v[152:155]
    s_waitcnt lgkmcnt(0)
    v_or_b32 v140, v140, v141
    v_mfma_f32_16x16x32_bf16 v[152:155], v[248:251], a[240:243], v[152:155]
    v_cmp_ne_u32 s[54:55], 0, v140
    s_nop 0
    s_cmp_eq_u64 s[54:55], 0
    s_cbranch_scc0 Lslow_35
Lback_36:
    s_nop 0
    v_mfma_f32_16x16x32_bf16 v[152:155], v[252:255], a[248:251], v[152:155]
    ds_write2_b32 v23, v132, v134 offset0:0 offset1:1
    v_mfma_f32_16x16x32_bf16 v[156:159], v[252:255], a[252:255], v[156:159]
    ds_write2_b32 v23, v136, v138 offset0:2 offset1:3
    v_mfma_f32_16x16x32_bf16 v[156:159], v[248:251], a[244:247], v[156:159]
    v_mfma_f32_16x16x32_bf16 v[156:159], v[244:247], a[236:239], v[156:159]
    v_mfma_f32_16x16x32_bf16 v[156:159], v[240:243], a[228:231], v[156:159]
    s_nop 1
    v_cvt_pk_bf16_f32 v80, v152, v153
    v_cvt_pk_bf16_f32 v81, v154, v155
    s_nop 3
    v_cvt_pk_bf16_f32 v84, v156, v157
    v_cvt_pk_bf16_f32 v85, v158, v159
    v_cvt_pk_bf16_f32 v88, v168, v169
    v_cvt_pk_bf16_f32 v89, v170, v171
    v_cvt_pk_bf16_f32 v92, v172, v173
    v_cvt_pk_bf16_f32 v93, v174, v175
    s_add_u32 s60, s84, 86016
    buffer_store_dwordx4 v[80:83], v4, s[16:19], s60 offen offset:0 sc1
    buffer_store_dwordx4 v[84:87], v4, s[16:19], s60 offen offset:1024 sc1
    s_add_u32 s60, s84, 172032
    buffer_store_dwordx4 v[88:91], v4, s[16:19], s60 offen offset:0 sc1
    buffer_store_dwordx4 v[92:95], v4, s[16:19], s60 offen offset:1024 sc1
    s_waitcnt lgkmcnt(0)
    s_barrier
    ds_read_b128 v[128:131], v35 offset:0
    ds_read_b128 v[132:135], v35 offset:1024
    ds_read_b128 v[136:139], v35 offset:2048
    ds_read_b128 v[140:143], v35 offset:3072
    v_bfe_u32 v23, v0, 4, 1
    v_lshlrev_b32 v23, 14, v23
    v_lshrrev_b32 v35, 5, v0
    v_lshl_add_u32 v23, v35, 8, v23
    v_and_b32 v35, 15, v0
    v_lshl_add_u32 v23, v35, 4, v23
    s_lshl_b32 s88, s44, 15
    s_lshl_b32 s89, s40, 10
    s_add_u32 s88, s88, s89
    s_add_u32 s88, s88, 15204352
    s_waitcnt lgkmcnt(3)
    v_mfma_f32_32x32x16_bf16 v[112:127], v[128:131], v[176:179], 0
    s_waitcnt lgkmcnt(2)
    v_mfma_f32_32x32x16_bf16 v[112:127], v[132:135], v[180:183], v[112:127]
    s_waitcnt lgkmcnt(1)
    v_mfma_f32_32x32x16_bf16 v[112:127], v[136:139], v[184:187], v[112:127]
    s_waitcnt lgkmcnt(0)
    v_mfma_f32_32x32x16_bf16 v[112:127], v[140:143], v[188:191], v[112:127]
    s_nop 11
    v_mov_b32 v59, v124
    v_mov_b32 v58, v124
    s_nop 1
    v_permlane32_swap_b32 v59, v58
    v_add_f32 v58, 0x358637bd, v58
    v_rcp_f32 v58, v58
    s_nop 0
    v_mul_f32 v58, v58, v54
    v_mul_f32 v112, v112, v58
    v_mul_f32 v113, v113, v58
    v_mul_f32 v114, v114, v58
    v_mul_f32 v115, v115, v58
    v_mul_f32 v116, v116, v58
    v_mul_f32 v117, v117, v58
    v_mul_f32 v118, v118, v58
    v_mul_f32 v119, v119, v58
    v_mul_f32 v120, v120, v58
    v_mul_f32 v121, v121, v58
    v_mul_f32 v122, v122, v58
    v_mul_f32 v123, v123, v58
    v_mul_f32 v124, v124, v58
    v_mul_f32 v125, v125, v58
    v_mul_f32 v126, v126, v58
    v_mul_f32 v127, v127, v58
    v_cvt_pk_bf16_f32 v128, v112, v113
    v_cvt_pk_bf16_f32 v129, v114, v115
    v_cvt_pk_bf16_f32 v130, v116, v117
    v_cvt_pk_bf16_f32 v131, v118, v119
    v_cvt_pk_bf16_f32 v132, v120, v121
    v_cvt_pk_bf16_f32 v133, v122, v123
    v_cvt_pk_bf16_f32 v134, v124, v125
    v_cvt_pk_bf16_f32 v135, v126, v127
    v_cndmask_b32_e64 v134, v134, 0, s[68:69]
    v_cndmask_b32_e64 v135, v135, 0, s[68:69]
    buffer_store_dwordx4 v[128:131], v23, s[16:19], s88 offen offset:0 sc1
    buffer_store_dwordx4 v[132:135], v23, s[16:19], s88 offen offset:512 sc1
    s_waitcnt vmcnt(0)
    s_buffer_atomic_swap s52, s[16:19], s91
    s_endpgm
Lslow_1:
    s_waitcnt lgkmcnt(0)
    s_cmp_eq_u64 s[4:5], s[52:53]
    s_cbranch_scc0 Lpoll_3
    s_cmp_eq_u64 s[6:7], s[52:53]
    s_cbranch_scc0 Lpoll_3
    s_cmp_eq_u64 s[8:9], s[52:53]
    s_cbranch_scc0 Lpoll_3
    s_cmp_eq_u64 s[10:11], s[52:53]
    s_cbranch_scc0 Lpoll_3
    s_branch Lback_2
Lpoll_3:
    s_sub_u32 s43, s43, 1
    s_cbranch_scc1 Lend
    s_sleep 1
    v_min_u32 v30, 7, v0
    v_lshlrev_b32 v30, 2, v30
    buffer_load_dword v31, v30, s[16:19], s70 offen offset:0 sc1
    s_waitcnt vmcnt(0)
    v_cmp_ne_u32 s[54:55], s52, v31
    s_nop 0
    s_cmp_eq_u64 s[54:55], 0
    s_cbranch_scc0 Lpoll_3
    s_branch Lback_2
Lslow_5:
    s_nop 7
    s_sub_u32 s43, s43, 1
    s_cbranch_scc1 Lend
    buffer_load_dwordx4 v[52:55], v4, s[16:19], s82 offen offset:0 sc1
    buffer_load_dwordx4 v[56:59], v4, s[16:19], s82 offen offset:1024 sc1
    buffer_load_dwordx4 v[60:63], v4, s[16:19], s82 offen offset:2048 sc1
    buffer_load_dwordx4 v[64:67], v4, s[16:19], s82 offen offset:3072 sc1
    buffer_load_dwordx4 v[68:71], v4, s[16:19], s83 offen offset:0 sc1
    buffer_load_dwordx4 v[72:75], v4, s[16:19], s83 offen offset:1024 sc1
    buffer_load_dwordx4 v[76:79], v4, s[16:19], s83 offen offset:2048 sc1
    s_waitcnt vmcnt(0)
    v_min3_u32 v36, v55, v59, v63
    v_max3_u32 v37, v55, v59, v63
    v_min3_u32 v36, v36, v67, v71
    v_max3_u32 v37, v37, v67, v71
    v_min3_u32 v36, v36, v75, v79
    v_max3_u32 v37, v37, v75, v79
    v_xor_b32 v36, s52, v36
    v_xor_b32 v37, s52, v37
    v_or_b32 v36, v36, v37
    v_cmp_ne_u32 s[54:55], 0, v36
    s_nop 0
    s_cmp_eq_u64 s[54:55], 0
    s_cbranch_scc0 Lslow_5
    s_branch Lback_6
Lslow_7:
    s_nop 7
    s_sub_u32 s43, s43, 1
    s_cbranch_scc1 Lend
    s_sleep 1
    buffer_load_dword v31, v30, s[16:19], 0 offen offset:0 sc1
    s_waitcnt vmcnt(0)
    v_cmp_ne_u32 s[54:55], s52, v31
    s_nop 0
    s_cmp_eq_u64 s[54:55], 0
    s_cbranch_scc0 Lslow_7
    s_branch Lback_8
Lslow_9:
    s_nop 7
    s_sub_u32 s43, s43, 1
    s_cbranch_scc1 Lend
    buffer_load_dwordx4 v[128:131], v29, s[16:19], s88 offen offset:0 sc1
    buffer_load_dwordx4 v[132:135], v29, s[16:19], s88 offen offset:1024 sc1
    s_waitcnt vmcnt(0)
    v_perm_b32 v136, v129, v128, s89
    v_perm_b32 v137, v131, v130, s89
    v_lshl_or_b32 v136, v137, 16, v136
    v_perm_b32 v138, v133, v132, s89
    v_perm_b32 v139, v135, v134, s89
    v_lshl_or_b32 v138, v139, 16, v138
    v_min3_u32 v140, v136, v138, v138
    v_max3_u32 v141, v136, v138, v138
    v_xor_b32 v140, s52, v140
    v_xor_b32 v141, s52, v141
    v_or_b32 v140, v140, v141
    v_cmp_ne_u32 s[54:55], 0, v140
    s_nop 0
    s_cmp_eq_u64 s[54:55], 0
    s_cbranch_scc0 Lslow_9
    s_branch Lback_10
Lslow_11:
    s_nop 7
    s_sub_u32 s43, s43, 1
    s_cbranch_scc1 Lend
    buffer_load_dwordx4 v[132:135], v4, s[16:19], s83 offen offset:0 sc1
    buffer_load_dwordx4 v[136:139], v4, s[16:19], s83 offen offset:1024 sc1
    s_waitcnt vmcnt(0)
    v_min3_u32 v140, v133, v135, v137
    v_max3_u32 v141, v133, v135, v137
    v_min3_u32 v140, v140, v139, v139
    v_max3_u32 v141, v141, v139, v139
    v_xor_b32 v140, s52, v140
    v_xor_b32 v141, s52, v141
    v_or_b32 v140, v140, v141
    v_cmp_ne_u32 s[54:55], 0, v140
    s_nop 0
    s_cmp_eq_u64 s[54:55], 0
    s_cbranch_scc0 Lslow_11
    s_branch Lback_12
Lslow_13:
    s_nop 7
    s_sub_u32 s43, s43, 1
    s_cbranch_scc1 Lend
    buffer_load_dwordx4 v[192:195], v4, s[16:19], s86 offen offset:0 sc1
    buffer_load_dwordx4 v[196:199], v4, s[16:19], s86 offen offset:1024 sc1
    buffer_load_dwordx4 v[200:203], v4, s[16:19], s86 offen offset:2048 sc1
    buffer_load_dwordx4 v[204:207], v4, s[16:19], s86 offen offset:3072 sc1
    s_waitcnt vmcnt(0)
    v_min3_u32 v220, v195, v199, v203
    v_max3_u32 v221, v195, v199, v203
    v_min3_u32 v220, v220, v207, v207
    v_max3_u32 v221, v221, v207, v207
    v_xor_b32 v220, s52, v220
    v_xor_b32 v221, s52, v221
    v_or_b32 v220, v220, v221
    v_cmp_ne_u32 s[54:55], 0, v220
    s_nop 0
    s_cmp_eq_u64 s[54:55], 0
    s_cbranch_scc0 Lslow_13
    s_branch Lback_14
Lslow_15:
    s_nop 7
    s_sub_u32 s43, s43, 1
    s_cbranch_scc1 Lend
    buffer_load_dwordx4 v[208:211], v4, s[16:19], s87 offen offset:0 sc1
    buffer_load_dwordx4 v[212:215], v4, s[16:19], s87 offen offset:1024 sc1
    s_waitcnt vmcnt(0)
    v_min3_u32 v192, v211, v215, v215
    v_max3_u32 v193, v211, v215, v215
    v_xor_b32 v192, s52, v192
    v_xor_b32 v193, s52, v193
    v_or_b32 v192, v192, v193
    v_cmp_ne_u32 s[54:55], 0, v192
    s_nop 0
    s_cmp_eq_u64 s[54:55], 0
    s_cbranch_scc0 Lslow_15
    s_branch Lback_16
Lslow_17:
    s_waitcnt lgkmcnt(0)
    s_cmp_eq_u64 s[0:1], s[52:53]
    s_cbranch_scc0 Lpoll_19
    s_cmp_eq_u64 s[2:3], s[52:53]
    s_cbranch_scc0 Lpoll_19
    s_cmp_eq_u64 s[4:5], s[52:53]
    s_cbranch_scc0 Lpoll_19
    s_cmp_eq_u64 s[6:7], s[52:53]
    s_cbranch_scc0 Lpoll_19
    s_cmp_eq_u64 s[8:9], s[52:53]
    s_cbranch_scc0 Lpoll_19
    s_cmp_eq_u64 s[10:11], s[52:53]
    s_cbranch_scc0 Lpoll_19
    s_cmp_eq_u64 s[12:13], s[52:53]
    s_cbranch_scc0 Lpoll_19
    s_cmp_eq_u64 s[14:15], s[52:53]
    s_cbranch_scc0 Lpoll_19
    s_branch Lback_18
Lpoll_19:
    s_sub_u32 s43, s43, 1
    s_cbranch_scc1 Lend
    s_sleep 1
    v_min_u32 v30, 15, v0
    v_lshlrev_b32 v30, 2, v30
    buffer_load_dword v31, v30, s[16:19], s58 offen offset:0 sc1
    s_waitcnt vmcnt(0)
    v_cmp_ne_u32 s[54:55], s52, v31
    s_nop 0
    s_cmp_eq_u64 s[54:55], 0
    s_cbranch_scc0 Lpoll_19
    s_branch Lback_18
Lslow_21:
    s_waitcnt lgkmcnt(0)
    s_cmp_eq_u64 s[0:1], s[52:53]
    s_cbranch_scc0 Lpoll_23
    s_cmp_eq_u64 s[2:3], s[52:53]
    s_cbranch_scc0 Lpoll_23
    s_cmp_eq_u64 s[4:5], s[52:53]
    s_cbranch_scc0 Lpoll_23
    s_cmp_eq_u64 s[6:7], s[52:53]
    s_cbranch_scc0 Lpoll_23
    s_cmp_eq_u64 s[8:9], s[52:53]
    s_cbranch_scc0 Lpoll_23
    s_cmp_eq_u64 s[10:11], s[52:53]
    s_cbranch_scc0 Lpoll_23
    s_cmp_eq_u64 s[12:13], s[52:53]
    s_cbranch_scc0 Lpoll_23
    s_branch Lback_22
Lpoll_23:
    s_sub_u32 s43, s43, 1
    s_cbranch_scc1 Lend
    s_sleep 1
    v_min_u32 v30, 13, v0
    v_lshlrev_b32 v30, 2, v30
    buffer_load_dword v31, v30, s[16:19], s58 offen offset:128 sc1
    s_waitcnt vmcnt(0)
    v_cmp_ne_u32 s[54:55], s52, v31
    s_nop 0
    s_cmp_eq_u64 s[54:55], 0
    s_cbranch_scc0 Lpoll_23
    s_branch Lback_22
Lslow_26:
    s_waitcnt lgkmcnt(0)
    s_cmp_eq_u64 s[4:5], s[52:53]
    s_cbranch_scc0 Lpoll_28
    s_cmp_eq_u64 s[6:7], s[52:53]
    s_cbranch_scc0 Lpoll_28
    s_cmp_eq_u64 s[8:9], s[52:53]
    s_cbranch_scc0 Lpoll_28
    s_cmp_eq_u64 s[10:11], s[52:53]
    s_cbranch_scc0 Lpoll_28
    s_branch Lback_27
Lpoll_28:
    s_sub_u32 s43, s43, 1
    s_cbranch_scc1 Lend
    s_sleep 1
    v_min_u32 v24, 7, v0
    v_lshlrev_b32 v24, 2, v24
    buffer_load_dword v25, v24, s[16:19], s70 offen offset:0 sc1
    s_waitcnt vmcnt(0)
    v_cmp_ne_u32 s[54:55], s52, v25
    s_nop 0
    s_cmp_eq_u64 s[54:55], 0
    s_cbranch_scc0 Lpoll_28
    s_branch Lback_27
Lslow_31:
    s_nop 7
    s_sub_u32 s43, s43, 1
    s_cbranch_scc1 Lend
    s_sleep 1
    buffer_load_dword v25, v24, s[16:19], 0 offen offset:0 sc1
    s_waitcnt vmcnt(0)
    v_cmp_ne_u32 s[54:55], s52, v25
    s_nop 0
    s_cmp_eq_u64 s[54:55], 0
    s_cbranch_scc0 Lslow_31
    s_branch Lback_32
Lslow_33:
    s_nop 7
    s_sub_u32 s43, s43, 1
    s_cbranch_scc1 Lend
    buffer_load_dwordx4 v[128:131], v23, s[16:19], s88 offen offset:0 sc1
    buffer_load_dwordx4 v[132:135], v23, s[16:19], s88 offen offset:1024 sc1
    s_waitcnt vmcnt(0)
    v_perm_b32 v136, v129, v128, s89
    v_perm_b32 v137, v131, v130, s89
    v_lshl_or_b32 v136, v137, 16, v136
    v_perm_b32 v138, v133, v132, s89
    v_perm_b32 v139, v135, v134, s89
    v_lshl_or_b32 v138, v139, 16, v138
    v_min3_u32 v140, v136, v138, v138
    v_max3_u32 v141, v136, v138, v138
    v_xor_b32 v140, s52, v140
    v_xor_b32 v141, s52, v141
    v_or_b32 v140, v140, v141
    v_cmp_ne_u32 s[54:55], 0, v140
    s_nop 0
    s_cmp_eq_u64 s[54:55], 0
    s_cbranch_scc0 Lslow_33
    s_branch Lback_34
Lslow_35:
    s_nop 7
    s_sub_u32 s43, s43, 1
    s_cbranch_scc1 Lend
    buffer_load_dwordx4 v[132:135], v4, s[16:19], s83 offen offset:0 sc1
    buffer_load_dwordx4 v[136:139], v4, s[16:19], s83 offen offset:1024 sc1
    s_waitcnt vmcnt(0)
    v_min3_u32 v140, v133, v135, v137
    v_max3_u32 v141, v133, v135, v137
    v_min3_u32 v140, v140, v139, v139
    v_max3_u32 v141, v141, v139, v139
    v_xor_b32 v140, s52, v140
    v_xor_b32 v141, s52, v141
    v_or_b32 v140, v140, v141
    v_cmp_ne_u32 s[54:55], 0, v140
    s_nop 0
    s_cmp_eq_u64 s[54:55], 0
    s_cbranch_scc0 Lslow_35
    s_branch Lback_36
Lend:
    s_endpgm
Lcode_end:
.section .rodata,"a"
.p2align 6
.amdhsa_kernel gated_mix__linear_kernel_hedgehog__mixer_gmlp__prompt_kernel
  .amdhsa_next_free_vgpr 512
  .amdhsa_next_free_sgpr 102
  .amdhsa_accum_offset 256
  .amdhsa_group_segment_fixed_size 0
  .amdhsa_kernarg_size 104
  .amdhsa_user_sgpr_count 2
  .amdhsa_user_sgpr_kernarg_segment_ptr 1
  .amdhsa_system_sgpr_workgroup_id_x 1
.end_amdhsa_kernel
```
